```python
import torch

def _softmax(x, axis=-1):
    return torch.softmax(x, dim=axis)

def _gelu(x):
    return torch.nn.functional.gelu(x, approximate='tanh')

def _silu(x):
    return torch.nn.functional.silu(x)

def _sigmoid(x):
    return torch.sigmoid(x)

def _layernorm(x, axis=-1, eps=1e-05):
    m = x.mean(dim=axis, keepdim=True)
    v = x.var(dim=axis, keepdim=True, unbiased=False)
    return (x - m) / torch.sqrt(v + eps)

def _scatter_add(tgt, idx, src, axis=0):
    return tgt.clone().index_add_(axis, idx, src)

def _segment_sum(src, seg, n):
    out = torch.zeros((n,) + src.shape[1:], dtype=src.dtype)
    return out.index_add_(0, seg, src)

def _pad(x, pw):
    flat = tuple((v for pair in reversed(pw) for v in pair))
    return torch.nn.functional.pad(x, flat)
kernel_name = 'gated_mix__memory_aug_recurrent_mem_tr__ssm_conv_s4__prompt'

def setup_inputs():

    _w = lambda a: (lambda t: t.to(torch.bfloat16) if t.is_floating_point() else t)(torch.as_tensor(a))

    def _A_setup():
        B, S, Dm = (1, 2048, 640)
        H, Dh = (32, 128)
        M, seg = (8, 32)
        seg = min(seg, S)
        S = S // seg * seg
        return {'x': _w((lambda *s: torch.randn(*s, dtype=torch.bfloat16) * 0.05)(B, S, Dm)), 'mem0': _w((lambda *s: torch.randn(*s, dtype=torch.bfloat16) * 0.4)(B, M, Dm)), 'Wq': _w((lambda *s: torch.randn(*s, dtype=torch.bfloat16) * 6.4)(Dm, H, Dh) * Dm ** (-0.5)), 'Wk': _w((lambda *s: torch.randn(*s, dtype=torch.bfloat16) * 6.4)(Dm, H, Dh) * Dm ** (-0.5)), 'Wv': _w((lambda *s: torch.randn(*s, dtype=torch.bfloat16) * 0.4)(Dm, H, Dh) * Dm ** (-0.5)), 'Wo': _w((lambda *s: torch.randn(*s, dtype=torch.bfloat16) * 0.4)(H, Dh, Dm) * (H * Dh) ** (-0.5)), 'seg_len': seg}
    _A_in = _A_setup()

    def _B_setup():
        B, L, D, N = (1, 2048, 640, 128)
        A_re = -(lambda _x: torch.exp(torch.as_tensor(_x)))((lambda *s: torch.randn(*s, dtype=torch.bfloat16) * 6.4)(D, N))
        A_im = torch.pi * (lambda *s: torch.randn(*s, dtype=torch.bfloat16) * 0.05)(D, N)
        B_re = (lambda *s: torch.randn(*s, dtype=torch.bfloat16) * 0.1)(D, N)
        B_im = (lambda *s: torch.randn(*s, dtype=torch.bfloat16) * 0.1)(D, N)
        C_re = (lambda *s: torch.randn(*s, dtype=torch.bfloat16) * 0.1)(D, N)
        C_im = (lambda *s: torch.randn(*s, dtype=torch.bfloat16) * 0.1)(D, N)
        log_dt = (lambda *s: torch.randn(*s, dtype=torch.bfloat16) * 0.05)(D) * 0.5 - 4.0
        Dskip = (lambda *s: torch.randn(*s, dtype=torch.bfloat16) * 0.05)(D)
        return {'u': _w((lambda *s: torch.randn(*s, dtype=torch.bfloat16) * 0.05)(B, L, D)), 'A_re': _w(A_re), 'A_im': _w(A_im), 'B_re': _w(B_re), 'B_im': _w(B_im), 'C_re': _w(C_re), 'C_im': _w(C_im), 'log_dt': _w(log_dt), 'Dskip': _w(Dskip)}
    _B_in = _B_setup()
    return {'A_x': _A_in['x'], 'A_mem0': _A_in['mem0'], 'A_Wq': _A_in['Wq'], 'A_Wk': _A_in['Wk'], 'A_Wv': _A_in['Wv'], 'A_Wo': _A_in['Wo'], 'A_seg_len': _A_in['seg_len'], 'B_u': _B_in['u'], 'B_A_re': _B_in['A_re'], 'B_A_im': _B_in['A_im'], 'B_B_re': _B_in['B_re'], 'B_B_im': _B_in['B_im'], 'B_C_re': _B_in['C_re'], 'B_C_im': _B_in['C_im'], 'B_log_dt': _B_in['log_dt'], 'B_Dskip': _B_in['Dskip'], 'gate_w': _w((lambda *s: torch.randn(*s, dtype=torch.bfloat16) * 0.05)(640) * 16.0)}

def reference(A_x, A_mem0, A_Wq, A_Wk, A_Wv, A_Wo, A_seg_len, B_u, B_A_re, B_A_im, B_B_re, B_B_im, B_C_re, B_C_im, B_log_dt, B_Dskip, gate_w):

    def _A_ref(x, mem0, Wq, Wk, Wv, Wo, seg_len):
        B, S, Dm = x.shape
        H, Dh = (Wq.shape[1], Wq.shape[2])
        M = mem0.shape[1]
        scale = Dh ** (-0.5)
        n_seg = S // seg_len
        L = M + seg_len
        idx = torch.arange(L)
        mask = (idx[:, None] < M) | (idx[:, None] >= idx[None, :])
        mem = mem0
        outs = []
        for s in range(n_seg):
            xs = x[:, s * seg_len:(s + 1) * seg_len, :].clone()
            h = torch.concatenate([mem, xs], axis=1)
            q = torch.einsum('btd,dhe->bhte', h, Wq)
            k = torch.einsum('btd,dhe->bhte', h, Wk)
            v = torch.einsum('btd,dhe->bhte', h, Wv)
            scores = torch.einsum('bhqe,bhke->bhqk', q, k) * scale
            scores = torch.where(mask[None, None], scores, -1000000000.0)
            p = _softmax(scores, axis=-1)
            o = torch.einsum('bhqk,bhke->bhqe', p, v)
            o = torch.einsum('bhte,hed->btd', o, Wo)
            mem = o[:, :M, :].clone()
            outs.append(o[:, M:, :])
        return torch.concatenate(outs, axis=1)

    def _B_ref(u, A_re, A_im, B_re, B_im, C_re, C_im, log_dt, Dskip):
        Bsz, L, D = u.shape
        dt = torch.exp(log_dt)[:, None]
        A = A_re + 1j * A_im
        Bc = B_re + 1j * B_im
        Cc = C_re + 1j * C_im
        logdA = dt * A
        dB = dt * Bc
        l = (lambda x, dt: x.to(dt))(torch.arange(L), A_re.dtype)
        P = torch.exp(logdA[:, :, None] * l[None, None, :])
        K = torch.einsum('dn,dnl,dn->dl', Cc, P, dB).real
        L2 = 2 * L
        Kp = _pad(K, ((0, 0), (0, L)))
        up = (lambda x, *d: x.permute(*d))(u, 0, 2, 1)
        up = _pad(up, ((0, 0), (0, 0), (0, L)))
        Kf = (lambda x, axes=(-2, -1): torch.fft.rfft2(x.float(), dim=axes))(Kp[:, None, :], axes=(-2, -1))
        Uf = (lambda x, axes=(-2, -1): torch.fft.rfft2(x.float(), dim=axes))(up[:, :, None, :], axes=(-2, -1))
        Yf = Uf * Kf[None, :, :, :]
        y = (lambda x, s, axes=(-2, -1): torch.fft.irfft2(x, s=s, dim=axes).to(torch.bfloat16))(Yf, (1, L2), axes=(-2, -1))[:, :, 0, :L]
        y = (lambda x, *d: x.permute(*d))(y, 0, 2, 1) + u * Dskip[None, None, :]
        return y
    x = A_x
    g = _sigmoid((x * gate_w).sum(-1, keepdims=True))
    a = _A_ref(x, A_mem0, A_Wq, A_Wk, A_Wv, A_Wo, A_seg_len)
    b = _B_ref(x, B_A_re, B_A_im, B_B_re, B_B_im, B_C_re, B_C_im, B_log_dt, B_Dskip)
    return g * a + (1 - g) * b
```

```asm
; @launch kernel=gated_mix__memory_aug_recurrent_mem_tr__ssm_conv_s4__prompt_kernel grid=(256,1,1) block=(512,1,1) lds=163840
.amdgcn_target "amdgcn-amd-amdhsa--gfx950"
.text
.globl gated_mix__memory_aug_recurrent_mem_tr__ssm_conv_s4__prompt_kernel
.p2align 8
.type gated_mix__memory_aug_recurrent_mem_tr__ssm_conv_s4__prompt_kernel,@function
gated_mix__memory_aug_recurrent_mem_tr__ssm_conv_s4__prompt_kernel:
    s_cmp_ge_u32 s2, 256
    s_cbranch_scc1 Lmain_end0
    s_getpc_b64 s[90:91]
    s_lshr_b32 s92, s2, 3
    s_and_b32 s92, s92, 31
    s_lshl_b32 s92, s92, 12
    v_lshlrev_b32 v2, 3, v0
    v_add_u32 v2, s92, v2
    v_min_u32 v2, CODE_BYTES, v2
    global_load_dword v3, v2, s[90:91]
    s_load_dwordx2 s[4:5], s[0:1], 152
    s_load_dwordx2 s[88:89], s[0:1], 144
    v_and_b32 v1, 63, v0
    v_lshrrev_b32 v11, 6, v0
    v_mov_b32 v6, 0
    v_mov_b32 v16, 1
    v_readfirstlane_b32 s28, v11
    s_waitcnt lgkmcnt(0)
    s_mov_b32 s8, s4
    s_and_b32 s9, s5, 0xffff
    s_mov_b32 s10, 268435456
    s_mov_b32 s11, 0x00020000
    s_mov_b32 s4, s88
    s_and_b32 s5, s89, 0xffff
    s_mov_b32 s6, 256
    s_mov_b32 s7, 0x00020000
    s_mov_b32 s87, s28
    s_cmp_lg_u32 s28, 0
    s_cbranch_scc1 Lm_norole
    s_getreg_b32 s86, hwreg(HW_REG_XCC_ID)
    s_and_b32 s86, s86, 7
    s_lshl_b32 s85, s86, 2
    v_mov_b32 v11, 1
    s_mov_b64 exec, 1
    buffer_atomic_add v11, v6, s[4:7], s85 offen sc0
    s_mov_b64 exec, -1
Lm_norole:
    s_load_dwordx2 s[12:13], s[0:1], 0
    s_load_dwordx2 s[14:15], s[0:1], 128
    v_mov_b32 v24, -1
    v_mov_b32 v25, -1
    v_mov_b32 v26, -1
    v_mov_b32 v27, -1
    v_lshlrev_b32 v20, 4, v0
    s_lshl_b32 s20, s2, 13
    v_add_u32 v21, s20, v20
    s_mov_b32 s21, 134217728
    buffer_store_dwordx4 v[24:27], v21, s[8:11], s21 offen sc1
    s_lshl_b32 s20, s2, 12
    v_add_u32 v21, s20, v20
    s_mov_b32 s22, 950272
    v_cmp_gt_u32 vcc, s22, v21
    s_movk_i32 s23, 0x100
    v_cmp_gt_u32 s[24:25], s23, v0
    s_and_b64 vcc, vcc, s[24:25]
    s_mov_b32 s21, 67108864
    s_and_saveexec_b64 s[26:27], vcc
    s_cbranch_execz Lis_1
    buffer_store_dwordx4 v[24:27], v21, s[8:11], s21 offen sc1
Lis_1:
    s_mov_b64 exec, s[26:27]
    s_cmp_lg_u32 s28, 7
    s_cbranch_scc1 Lis_2
    s_cmp_ge_u32 s2, 138
    s_cbranch_scc1 Lis_2
    v_mov_b32 v28, 0
    v_mov_b32 v29, 0
    v_mov_b32 v30, 0
    v_mov_b32 v31, 0
    s_lshl_b32 s20, s2, 10
    s_add_u32 s20, s20, 125829120
    v_lshlrev_b32 v21, 4, v1
    buffer_store_dwordx4 v[28:31], v21, s[8:11], s20 offen sc1
Lis_2:
    s_sub_u32 s20, s28, 1
    s_cmp_ge_u32 s20, 2
    s_cbranch_scc1 Lis_3
    v_subrev_u32 v21, 64, v0
    v_lshrrev_b32 v21, 4, v21
    s_lshl_b32 s20, s2, 3
    v_add_u32 v21, s20, v21
    v_and_b32 v22, 15, v0
    v_lshlrev_b32 v22, 4, v22
    v_mul_u32_u24 v23, 1280, v21
    v_add_u32 v23, v23, v22
    s_waitcnt lgkmcnt(0)
    s_mov_b32 s16, s12
    s_and_b32 s17, s13, 0xffff
    s_mov_b32 s18, 2621440
    s_mov_b32 s19, 0x00020000
    s_mov_b32 s28, s14
    s_and_b32 s29, s15, 0xffff
    s_mov_b32 s30, 1280
    s_mov_b32 s31, 0x00020000
    buffer_load_dwordx4 v[32:35], v23, s[16:19], 0 offen offset:0
    buffer_load_dwordx4 v[52:55], v22, s[28:31], 0 offen offset:0
    buffer_load_dwordx4 v[36:39], v23, s[16:19], 0 offen offset:256
    buffer_load_dwordx4 v[56:59], v22, s[28:31], 0 offen offset:256
    buffer_load_dwordx4 v[40:43], v23, s[16:19], 0 offen offset:512
    buffer_load_dwordx4 v[60:63], v22, s[28:31], 0 offen offset:512
    buffer_load_dwordx4 v[44:47], v23, s[16:19], 0 offen offset:768
    buffer_load_dwordx4 v[64:67], v22, s[28:31], 0 offen offset:768
    buffer_load_dwordx4 v[48:51], v23, s[16:19], 0 offen offset:1024
    buffer_load_dwordx4 v[68:71], v22, s[28:31], 0 offen offset:1024
    v_lshrrev_b32 v72, 4, v21
    v_mul_u32_u24 v72, 20, v72
    v_bfe_u32 v73, v0, 2, 2
    v_add_u32 v72, v72, v73
    v_lshlrev_b32 v72, 10, v72
    v_and_b32 v73, 3, v0
    v_lshl_add_u32 v72, v73, 8, v72
    v_and_b32 v73, 15, v21
    v_lshl_add_u32 v76, v73, 4, v72
    v_mov_b32 v24, 0
    s_waitcnt vmcnt(0)
    s_mov_b32 s20, 121634816
    buffer_store_dwordx4 v[32:35], v76, s[8:11], s20 offen sc1
    s_mov_b32 s20, 121638912
    buffer_store_dwordx4 v[36:39], v76, s[8:11], s20 offen sc1
    s_mov_b32 s20, 121643008
    buffer_store_dwordx4 v[40:43], v76, s[8:11], s20 offen sc1
    s_mov_b32 s20, 121647104
    buffer_store_dwordx4 v[44:47], v76, s[8:11], s20 offen sc1
    s_mov_b32 s20, 121651200
    buffer_store_dwordx4 v[48:51], v76, s[8:11], s20 offen sc1
    v_lshlrev_b32 v72, 16, v32
    v_and_b32 v73, 0xffff0000, v32
    v_lshlrev_b32 v74, 16, v52
    v_and_b32 v75, 0xffff0000, v52
    v_mul_f32 v72, v72, v74
    v_mul_f32 v73, v73, v75
    v_cvt_pk_bf16_f32 v72, v72, v73
    v_and_b32 v73, 0xffff0000, v72
    v_lshlrev_b32 v72, 16, v72
    v_add_f32 v24, v24, v72
    v_add_f32 v24, v24, v73
    v_lshlrev_b32 v72, 16, v33
    v_and_b32 v73, 0xffff0000, v33
    v_lshlrev_b32 v74, 16, v53
    v_and_b32 v75, 0xffff0000, v53
    v_mul_f32 v72, v72, v74
    v_mul_f32 v73, v73, v75
    v_cvt_pk_bf16_f32 v72, v72, v73
    v_and_b32 v73, 0xffff0000, v72
    v_lshlrev_b32 v72, 16, v72
    v_add_f32 v24, v24, v72
    v_add_f32 v24, v24, v73
    v_lshlrev_b32 v72, 16, v34
    v_and_b32 v73, 0xffff0000, v34
    v_lshlrev_b32 v74, 16, v54
    v_and_b32 v75, 0xffff0000, v54
    v_mul_f32 v72, v72, v74
    v_mul_f32 v73, v73, v75
    v_cvt_pk_bf16_f32 v72, v72, v73
    v_and_b32 v73, 0xffff0000, v72
    v_lshlrev_b32 v72, 16, v72
    v_add_f32 v24, v24, v72
    v_add_f32 v24, v24, v73
    v_lshlrev_b32 v72, 16, v35
    v_and_b32 v73, 0xffff0000, v35
    v_lshlrev_b32 v74, 16, v55
    v_and_b32 v75, 0xffff0000, v55
    v_mul_f32 v72, v72, v74
    v_mul_f32 v73, v73, v75
    v_cvt_pk_bf16_f32 v72, v72, v73
    v_and_b32 v73, 0xffff0000, v72
    v_lshlrev_b32 v72, 16, v72
    v_add_f32 v24, v24, v72
    v_add_f32 v24, v24, v73
    v_lshlrev_b32 v72, 16, v36
    v_and_b32 v73, 0xffff0000, v36
    v_lshlrev_b32 v74, 16, v56
    v_and_b32 v75, 0xffff0000, v56
    v_mul_f32 v72, v72, v74
    v_mul_f32 v73, v73, v75
    v_cvt_pk_bf16_f32 v72, v72, v73
    v_and_b32 v73, 0xffff0000, v72
    v_lshlrev_b32 v72, 16, v72
    v_add_f32 v24, v24, v72
    v_add_f32 v24, v24, v73
    v_lshlrev_b32 v72, 16, v37
    v_and_b32 v73, 0xffff0000, v37
    v_lshlrev_b32 v74, 16, v57
    v_and_b32 v75, 0xffff0000, v57
    v_mul_f32 v72, v72, v74
    v_mul_f32 v73, v73, v75
    v_cvt_pk_bf16_f32 v72, v72, v73
    v_and_b32 v73, 0xffff0000, v72
    v_lshlrev_b32 v72, 16, v72
    v_add_f32 v24, v24, v72
    v_add_f32 v24, v24, v73
    v_lshlrev_b32 v72, 16, v38
    v_and_b32 v73, 0xffff0000, v38
    v_lshlrev_b32 v74, 16, v58
    v_and_b32 v75, 0xffff0000, v58
    v_mul_f32 v72, v72, v74
    v_mul_f32 v73, v73, v75
    v_cvt_pk_bf16_f32 v72, v72, v73
    v_and_b32 v73, 0xffff0000, v72
    v_lshlrev_b32 v72, 16, v72
    v_add_f32 v24, v24, v72
    v_add_f32 v24, v24, v73
    v_lshlrev_b32 v72, 16, v39
    v_and_b32 v73, 0xffff0000, v39
    v_lshlrev_b32 v74, 16, v59
    v_and_b32 v75, 0xffff0000, v59
    v_mul_f32 v72, v72, v74
    v_mul_f32 v73, v73, v75
    v_cvt_pk_bf16_f32 v72, v72, v73
    v_and_b32 v73, 0xffff0000, v72
    v_lshlrev_b32 v72, 16, v72
    v_add_f32 v24, v24, v72
    v_add_f32 v24, v24, v73
    v_lshlrev_b32 v72, 16, v40
    v_and_b32 v73, 0xffff0000, v40
    v_lshlrev_b32 v74, 16, v60
    v_and_b32 v75, 0xffff0000, v60
    v_mul_f32 v72, v72, v74
    v_mul_f32 v73, v73, v75
    v_cvt_pk_bf16_f32 v72, v72, v73
    v_and_b32 v73, 0xffff0000, v72
    v_lshlrev_b32 v72, 16, v72
    v_add_f32 v24, v24, v72
    v_add_f32 v24, v24, v73
    v_lshlrev_b32 v72, 16, v41
    v_and_b32 v73, 0xffff0000, v41
    v_lshlrev_b32 v74, 16, v61
    v_and_b32 v75, 0xffff0000, v61
    v_mul_f32 v72, v72, v74
    v_mul_f32 v73, v73, v75
    v_cvt_pk_bf16_f32 v72, v72, v73
    v_and_b32 v73, 0xffff0000, v72
    v_lshlrev_b32 v72, 16, v72
    v_add_f32 v24, v24, v72
    v_add_f32 v24, v24, v73
    v_lshlrev_b32 v72, 16, v42
    v_and_b32 v73, 0xffff0000, v42
    v_lshlrev_b32 v74, 16, v62
    v_and_b32 v75, 0xffff0000, v62
    v_mul_f32 v72, v72, v74
    v_mul_f32 v73, v73, v75
    v_cvt_pk_bf16_f32 v72, v72, v73
    v_and_b32 v73, 0xffff0000, v72
    v_lshlrev_b32 v72, 16, v72
    v_add_f32 v24, v24, v72
    v_add_f32 v24, v24, v73
    v_lshlrev_b32 v72, 16, v43
    v_and_b32 v73, 0xffff0000, v43
    v_lshlrev_b32 v74, 16, v63
    v_and_b32 v75, 0xffff0000, v63
    v_mul_f32 v72, v72, v74
    v_mul_f32 v73, v73, v75
    v_cvt_pk_bf16_f32 v72, v72, v73
    v_and_b32 v73, 0xffff0000, v72
    v_lshlrev_b32 v72, 16, v72
    v_add_f32 v24, v24, v72
    v_add_f32 v24, v24, v73
    v_lshlrev_b32 v72, 16, v44
    v_and_b32 v73, 0xffff0000, v44
    v_lshlrev_b32 v74, 16, v64
    v_and_b32 v75, 0xffff0000, v64
    v_mul_f32 v72, v72, v74
    v_mul_f32 v73, v73, v75
    v_cvt_pk_bf16_f32 v72, v72, v73
    v_and_b32 v73, 0xffff0000, v72
    v_lshlrev_b32 v72, 16, v72
    v_add_f32 v24, v24, v72
    v_add_f32 v24, v24, v73
    v_lshlrev_b32 v72, 16, v45
    v_and_b32 v73, 0xffff0000, v45
    v_lshlrev_b32 v74, 16, v65
    v_and_b32 v75, 0xffff0000, v65
    v_mul_f32 v72, v72, v74
    v_mul_f32 v73, v73, v75
    v_cvt_pk_bf16_f32 v72, v72, v73
    v_and_b32 v73, 0xffff0000, v72
    v_lshlrev_b32 v72, 16, v72
    v_add_f32 v24, v24, v72
    v_add_f32 v24, v24, v73
    v_lshlrev_b32 v72, 16, v46
    v_and_b32 v73, 0xffff0000, v46
    v_lshlrev_b32 v74, 16, v66
    v_and_b32 v75, 0xffff0000, v66
    v_mul_f32 v72, v72, v74
    v_mul_f32 v73, v73, v75
    v_cvt_pk_bf16_f32 v72, v72, v73
    v_and_b32 v73, 0xffff0000, v72
    v_lshlrev_b32 v72, 16, v72
    v_add_f32 v24, v24, v72
    v_add_f32 v24, v24, v73
    v_lshlrev_b32 v72, 16, v47
    v_and_b32 v73, 0xffff0000, v47
    v_lshlrev_b32 v74, 16, v67
    v_and_b32 v75, 0xffff0000, v67
    v_mul_f32 v72, v72, v74
    v_mul_f32 v73, v73, v75
    v_cvt_pk_bf16_f32 v72, v72, v73
    v_and_b32 v73, 0xffff0000, v72
    v_lshlrev_b32 v72, 16, v72
    v_add_f32 v24, v24, v72
    v_add_f32 v24, v24, v73
    v_lshlrev_b32 v72, 16, v48
    v_and_b32 v73, 0xffff0000, v48
    v_lshlrev_b32 v74, 16, v68
    v_and_b32 v75, 0xffff0000, v68
    v_mul_f32 v72, v72, v74
    v_mul_f32 v73, v73, v75
    v_cvt_pk_bf16_f32 v72, v72, v73
    v_and_b32 v73, 0xffff0000, v72
    v_lshlrev_b32 v72, 16, v72
    v_add_f32 v24, v24, v72
    v_add_f32 v24, v24, v73
    v_lshlrev_b32 v72, 16, v49
    v_and_b32 v73, 0xffff0000, v49
    v_lshlrev_b32 v74, 16, v69
    v_and_b32 v75, 0xffff0000, v69
    v_mul_f32 v72, v72, v74
    v_mul_f32 v73, v73, v75
    v_cvt_pk_bf16_f32 v72, v72, v73
    v_and_b32 v73, 0xffff0000, v72
    v_lshlrev_b32 v72, 16, v72
    v_add_f32 v24, v24, v72
    v_add_f32 v24, v24, v73
    v_lshlrev_b32 v72, 16, v50
    v_and_b32 v73, 0xffff0000, v50
    v_lshlrev_b32 v74, 16, v70
    v_and_b32 v75, 0xffff0000, v70
    v_mul_f32 v72, v72, v74
    v_mul_f32 v73, v73, v75
    v_cvt_pk_bf16_f32 v72, v72, v73
    v_and_b32 v73, 0xffff0000, v72
    v_lshlrev_b32 v72, 16, v72
    v_add_f32 v24, v24, v72
    v_add_f32 v24, v24, v73
    v_lshlrev_b32 v72, 16, v51
    v_and_b32 v73, 0xffff0000, v51
    v_lshlrev_b32 v74, 16, v71
    v_and_b32 v75, 0xffff0000, v71
    v_mul_f32 v72, v72, v74
    v_mul_f32 v73, v73, v75
    v_cvt_pk_bf16_f32 v72, v72, v73
    v_and_b32 v73, 0xffff0000, v72
    v_lshlrev_b32 v72, 16, v72
    v_add_f32 v24, v24, v72
    v_add_f32 v24, v24, v73
    s_nop 1
    v_add_f32_dpp v24, v24, v24 row_ror:8 row_mask:0xf bank_mask:0xf
    s_nop 1
    v_add_f32_dpp v24, v24, v24 row_ror:4 row_mask:0xf bank_mask:0xf
    s_nop 1
    v_add_f32_dpp v24, v24, v24 row_ror:2 row_mask:0xf bank_mask:0xf
    s_nop 1
    v_add_f32_dpp v24, v24, v24 row_ror:1 row_mask:0xf bank_mask:0xf
    v_cvt_pk_bf16_f32 v24, v24, v24
    v_lshlrev_b32 v24, 16, v24
    v_mul_f32 v24, 0xbfb8aa3b, v24
    v_exp_f32 v24, v24
    s_nop 0
    v_add_f32 v24, 1.0, v24
    v_rcp_f32 v24, v24
    s_nop 0
    v_cvt_pk_bf16_f32 v24, v24, v24
    v_lshlrev_b32 v24, 16, v24
    v_sub_f32 v25, 1.0, v24
    v_cvt_pk_bf16_f32 v25, v25, v25
    v_lshlrev_b32 v25, 16, v25
    v_lshlrev_b32 v21, 3, v21
    s_mov_b32 s20, 88080384
    v_cmp_eq_u32 vcc, 0, v22
    s_and_saveexec_b64 s[26:27], vcc
    buffer_store_dwordx2 v[24:25], v21, s[8:11], s20 offen sc1
    s_mov_b64 exec, s[26:27]
Lis_3:
    s_waitcnt lgkmcnt(0)
    s_mov_b32 s28, s87
    s_waitcnt vmcnt(0)
    s_cmp_lg_u32 s28, 0
    s_cbranch_scc1 Lm_role_wait
    s_mov_b64 exec, 1
    v_mov_b32 v12, s86
    ds_write_b32 v6, v11
    ds_write_b32 v6, v12 offset:4
    s_waitcnt lgkmcnt(0)
    s_mov_b64 exec, -1
Lm_role_wait:
    s_barrier
    ds_read_b64 v[20:21], v6
    s_waitcnt lgkmcnt(0)
    v_readfirstlane_b32 s25, v20
    v_readfirstlane_b32 s24, v21
    s_mov_b32 s59, 0
    s_barrier
    s_cmp_lg_u32 s28, 6
    s_cbranch_scc1 Lm_noarr
    s_and_b32 s85, s2, 7
    s_lshl_b32 s85, s85, 2
    s_mov_b64 exec, 1
    buffer_atomic_add v16, v6, s[4:7], s85 offen offset:128
    s_mov_b64 exec, -1
Lm_noarr:
    s_min_u32 s3, s25, 31
    s_mov_b32 s84, s25
    s_mov_b32 s83, s24
    s_mov_b32 s25, s3
    s_branch Lm_dispatch
Lm_restart:
    s_waitcnt vmcnt(0) lgkmcnt(0)
    s_barrier
    s_mov_b32 s28, s87
    s_bfe_u32 s24, s91, 0x30005
    s_and_b32 s25, s91, 31
    s_mov_b32 s59, 1
    v_and_b32 v1, 63, v0
    v_mov_b32 v6, 0
    v_mov_b32 v16, 1
    s_setprio 0
Lm_dispatch:
    s_cmp_ge_u32 s24, 4
    s_cbranch_scc1 Lm_b
    ds_write_b32 v6, v6 offset:32
    ds_write_b32 v6, v6 offset:36
    s_setprio 3
    s_lshr_b32 s38, s25, 2
    s_lshl_b32 s26, s24, 3
    s_add_u32 s26, s26, s38
    s_and_b32 s27, s25, 3
    v_lshlrev_b32 v4, 4, v1
    v_lshlrev_b32 v14, 3, v1
    v_lshrrev_b32 v36, 4, v1
    v_and_b32 v37, 15, v1
    v_lshrrev_b32 v42, 2, v37
    v_and_b32 v43, 3, v37
    s_load_dwordx8 s[64:71], s[0:1], 16
    s_load_dwordx2 s[72:73], s[0:1], 8
    v_lshrrev_b32 v44, 2, v1
    v_lshlrev_b32 v44, 13, v44
    v_and_b32 v39, 3, v1
    v_lshl_add_u32 v44, v39, 4, v44
    s_lshl_b32 s74, s26, 8
    s_and_b32 s38, s28, 3
    s_lshl_b32 s38, s38, 6
    s_add_u32 s74, s74, s38
    s_lshl_b32 s49, s28, 13
    s_add_u32 s49, s49, 16384
    s_waitcnt lgkmcnt(0)
    s_cmp_ge_u32 s28, 4
    s_cselect_b64 s[76:77], s[66:67], s[64:65]
    s_mov_b32 s12, s76
    s_and_b32 s13, s77, 0xffff
    s_mov_b32 s14, 5242880
    s_mov_b32 s15, 0x00020000
    s_add_u32 m0, s49, 0
    s_add_u32 s39, s74, 0
    buffer_load_dwordx4 v44, s[12:15], s39 offen lds
    s_add_u32 m0, s49, 1024
    s_add_u32 s39, s74, 131072
    buffer_load_dwordx4 v44, s[12:15], s39 offen lds
    s_add_u32 m0, s49, 2048
    s_add_u32 s39, s74, 262144
    buffer_load_dwordx4 v44, s[12:15], s39 offen lds
    s_add_u32 m0, s49, 3072
    s_add_u32 s39, s74, 393216
    buffer_load_dwordx4 v44, s[12:15], s39 offen lds
    s_add_u32 m0, s49, 4096
    s_add_u32 s39, s74, 524288
    buffer_load_dwordx4 v44, s[12:15], s39 offen lds
    s_add_u32 m0, s49, 5120
    s_add_u32 s39, s74, 655360
    buffer_load_dwordx4 v44, s[12:15], s39 offen lds
    s_add_u32 m0, s49, 6144
    s_add_u32 s39, s74, 786432
    buffer_load_dwordx4 v44, s[12:15], s39 offen lds
    s_add_u32 m0, s49, 7168
    s_add_u32 s39, s74, 917504
    buffer_load_dwordx4 v44, s[12:15], s39 offen lds
    s_add_u32 m0, s49, 65536
    s_add_u32 s39, s74, 1048576
    buffer_load_dwordx4 v44, s[12:15], s39 offen lds
    s_add_u32 m0, s49, 66560
    s_add_u32 s39, s74, 1179648
    buffer_load_dwordx4 v44, s[12:15], s39 offen lds
    s_add_u32 m0, s49, 67584
    s_add_u32 s39, s74, 1310720
    buffer_load_dwordx4 v44, s[12:15], s39 offen lds
    s_add_u32 m0, s49, 68608
    s_add_u32 s39, s74, 1441792
    buffer_load_dwordx4 v44, s[12:15], s39 offen lds
    s_add_u32 m0, s49, 69632
    s_add_u32 s39, s74, 1572864
    buffer_load_dwordx4 v44, s[12:15], s39 offen lds
    s_add_u32 m0, s49, 70656
    s_add_u32 s39, s74, 1703936
    buffer_load_dwordx4 v44, s[12:15], s39 offen lds
    s_add_u32 m0, s49, 71680
    s_add_u32 s39, s74, 1835008
    buffer_load_dwordx4 v44, s[12:15], s39 offen lds
    s_add_u32 m0, s49, 72704
    s_add_u32 s39, s74, 1966080
    buffer_load_dwordx4 v44, s[12:15], s39 offen lds
    s_mov_b32 s56, -1
    s_mov_b32 s57, 0xff
    s_mul_i32 s50, s24, 10240
    s_add_u32 s50, s50, 67108864
    s_lshr_b32 s38, s25, 1
    s_lshl_b32 s42, s38, 15
    s_and_b32 s38, s25, 1
    s_mul_i32 s38, s38, 640
    s_add_u32 s42, s42, s38
    s_and_b32 s38, s25, 15
    s_lshl_b32 s43, s38, 15
    s_lshr_b32 s38, s24, 1
    s_lshl_b32 s38, s38, 14
    s_add_u32 s43, s43, s38
    s_and_b32 s38, s24, 1
    s_lshl_b32 s38, s38, 1
    s_lshr_b32 s39, s25, 4
    s_add_u32 s38, s38, s39
    s_mul_i32 s38, s38, 1280
    s_add_u32 s43, s43, s38
    s_lshl_b32 s52, s24, 14
    s_add_u32 s52, s52, 67796992
    s_mov_b32 s29, 0
    s_lshl_b32 s44, s26, 12
    s_lshl_b32 s38, s27, 10
    s_add_u32 s45, s44, s38
    s_add_u32 s44, s44, 50331648
    s_add_u32 s45, s45, 58720256
    s_mov_b32 s48, 30720
    s_mov_b32 s54, 30720
    s_lshl_b32 s46, s26, 13
    s_lshl_b32 s38, s27, 11
    s_add_u32 s47, s46, s38
    s_add_u32 s46, s46, 16777216
    s_add_u32 s47, s47, 33554432
    s_lshl_b32 s58, s26, 6
    s_add_u32 s58, s58, 125839360
    s_lshl_b32 s55, s27, 2
    s_add_u32 s55, s55, s58
    s_add_u32 s55, s55, 32
    s_mov_b32 s41, 0x3e0293ee
    v_and_b32 v40, 7, v37
    v_lshl_add_u32 v40, v36, 3, v40
    v_lshlrev_b32 v40, 4, v40
    v_lshrrev_b32 v41, 3, v37
    v_mov_b32 v10, 0x4444
    v_mov_b32 v39, 0xeeee
    v_cmp_le_u32 vcc, 8, v37
    s_nop 1
    v_cndmask_b32 v10, v10, v39, vcc
    s_lshl_b32 s38, s28, 11
    v_add_u32 v2, s38, v4
    v_lshrrev_b32 v39, 9, v2
    v_lshl_add_u32 v5, v39, 6, v2
    v_add_u32 v5, 6144, v5
    v_lshl_add_u32 v7, v36, 3, v42
    v_lshlrev_b32 v7, 4, v7
    v_and_b32 v39, 1, v43
    v_lshl_add_u32 v7, v39, 3, v7
    v_lshrrev_b32 v39, 1, v43
    v_mul_u32_u24 v39, 576, v39
    v_add3_u32 v7, v7, v39, s29
    v_add_u32 v7, 6144, v7
    v_lshrrev_b32 v39, 5, v1
    v_lshl_add_u32 v9, v39, 4, v37
    v_lshlrev_b32 v9, 5, v9
    v_and_b32 v39, 1, v36
    v_lshl_add_u32 v9, v39, 3, v9
    s_and_b32 s38, s28, 3
    s_lshl_b32 s38, s38, 10
    s_lshr_b32 s39, s28, 2
    s_lshl_b32 s39, s39, 4
    s_add_u32 s38, s38, s39
    s_add_u32 s38, s38, 2048
    v_add_u32 v9, s38, v9
    v_lshl_add_u32 v18, v36, 2, v42
    v_lshlrev_b32 v18, 5, v18
    v_lshl_add_u32 v18, v43, 3, v18
    v_add_u32 v18, 2048, v18
    s_lshr_b32 s38, s25, 4
    s_lshl_b32 s38, s38, 2
    s_add_u32 s38, s38, s28
    s_lshl_b32 s38, s38, 11
    v_lshl_add_u32 v3, v41, 9, v40
    v_add_u32 v3, s38, v3
    s_cmp_lg_u32 s28, 6
    s_cbranch_scc1 L6_4
    s_lshl_b32 s38, s25, 9
    v_add_u32 v3, s38, v40
L6_4:
    s_mul_i32 s38, s28, 3072
    s_add_u32 s38, s38, 18432
    v_add_u32 v17, s38, v4
    s_and_b32 s38, s28, 1
    s_mul_i32 s39, s38, 640
    v_add_u32 v15, s39, v4
    s_mul_i32 s38, s38, 20
    v_lshrrev_b32 v39, 1, v1
    v_add_u32 v39, s38, v39
    v_and_b32 v8, 15, v39
    v_and_b32 v38, 1, v1
    v_lshl_add_u32 v8, v38, 4, v8
    v_lshlrev_b32 v8, 4, v8
    v_lshrrev_b32 v39, 4, v39
    v_lshl_add_u32 v8, v39, 10, v8
    v_add_u32 v8, 18432, v8
    s_mul_i32 s38, s25, 320
    v_add_u32 v19, s38, v14
    v_lshl_add_u32 v38, v36, 2, v42
    v_lshlrev_b32 v38, 6, v38
    v_lshl_add_u32 v38, v43, 3, v38
    v_add_u32 v38, s49, v38
    v_add_u32 v47, 65536, v38
    s_mov_b32 s16, s70
    s_and_b32 s17, s71, 0xffff
    s_mov_b32 s18, 5242880
    s_mov_b32 s19, 0x00020000
    s_mov_b32 s88, s68
    s_and_b32 s89, s69, 0xffff
    s_mov_b32 s90, 5242880
    s_mov_b32 s91, 0x00020000
    s_lshl_b32 s78, s26, 8
    s_lshl_b32 s38, s27, 6
    s_add_u32 s78, s78, s38
    s_min_u32 s38, s28, 4
    s_lshl_b32 s38, s38, 20
    s_add_u32 s78, s78, s38
    v_lshrrev_b32 v45, 3, v1
    v_mul_u32_u24 v45, 1280, v45
    v_and_b32 v39, 7, v1
    v_lshl_add_u32 v45, v39, 4, v45
    s_lshl_b32 s38, s24, 1
    s_lshr_b32 s39, s25, 4
    s_add_u32 s38, s38, s39
    s_lshl_b32 s38, s38, 2
    s_and_b32 s39, s28, 3
    s_add_u32 s38, s38, s39
    s_mul_i32 s75, s38, 163840
    s_and_b32 s39, s25, 15
    s_mul_i32 s39, s39, 80
    s_add_u32 s75, s75, s39
    s_waitcnt vmcnt(8)
    ds_read_b64_tr_b16 v[48:49], v38 offset:0
    ds_read_b64_tr_b16 v[50:51], v38 offset:1024
    ds_read_b64_tr_b16 v[52:53], v38 offset:2048
    ds_read_b64_tr_b16 v[54:55], v38 offset:3072
    ds_read_b64_tr_b16 v[56:57], v38 offset:32
    ds_read_b64_tr_b16 v[58:59], v38 offset:1056
    ds_read_b64_tr_b16 v[60:61], v38 offset:2080
    ds_read_b64_tr_b16 v[62:63], v38 offset:3104
    ds_read_b64_tr_b16 v[64:65], v38 offset:4096
    ds_read_b64_tr_b16 v[66:67], v38 offset:5120
    ds_read_b64_tr_b16 v[68:69], v38 offset:6144
    ds_read_b64_tr_b16 v[70:71], v38 offset:7168
    ds_read_b64_tr_b16 v[72:73], v38 offset:4128
    ds_read_b64_tr_b16 v[74:75], v38 offset:5152
    ds_read_b64_tr_b16 v[76:77], v38 offset:6176
    ds_read_b64_tr_b16 v[78:79], v38 offset:7200
    s_waitcnt lgkmcnt(0)
    v_mov_b32 v96, v48
    v_mov_b32 v98, v49
    v_mov_b32 v100, v50
    v_mov_b32 v102, v51
    v_mov_b32 v97, v52
    v_mov_b32 v99, v53
    v_mov_b32 v101, v54
    v_mov_b32 v103, v55
    v_mov_b32 v104, v56
    v_mov_b32 v106, v57
    v_mov_b32 v108, v58
    v_mov_b32 v110, v59
    v_mov_b32 v105, v60
    v_mov_b32 v107, v61
    v_mov_b32 v109, v62
    v_mov_b32 v111, v63
    v_mov_b32 v112, v64
    v_mov_b32 v114, v65
    v_mov_b32 v116, v66
    v_mov_b32 v118, v67
    v_mov_b32 v113, v68
    v_mov_b32 v115, v69
    v_mov_b32 v117, v70
    v_mov_b32 v119, v71
    v_mov_b32 v120, v72
    v_mov_b32 v122, v73
    v_mov_b32 v124, v74
    v_mov_b32 v126, v75
    v_mov_b32 v121, v76
    v_mov_b32 v123, v77
    v_mov_b32 v125, v78
    v_mov_b32 v127, v79
    s_add_u32 m0, s49, 0
    s_add_u32 s39, s74, 2097152
    buffer_load_dwordx4 v44, s[12:15], s39 offen lds
    s_add_u32 m0, s49, 1024
    s_add_u32 s39, s74, 2228224
    buffer_load_dwordx4 v44, s[12:15], s39 offen lds
    s_add_u32 m0, s49, 2048
    s_add_u32 s39, s74, 2359296
    buffer_load_dwordx4 v44, s[12:15], s39 offen lds
    s_add_u32 m0, s49, 3072
    s_add_u32 s39, s74, 2490368
    buffer_load_dwordx4 v44, s[12:15], s39 offen lds
    s_add_u32 m0, s49, 4096
    s_add_u32 s39, s74, 2621440
    buffer_load_dwordx4 v44, s[12:15], s39 offen lds
    s_add_u32 m0, s49, 5120
    s_add_u32 s39, s74, 2752512
    buffer_load_dwordx4 v44, s[12:15], s39 offen lds
    s_add_u32 m0, s49, 6144
    s_add_u32 s39, s74, 2883584
    buffer_load_dwordx4 v44, s[12:15], s39 offen lds
    s_add_u32 m0, s49, 7168
    s_add_u32 s39, s74, 3014656
    buffer_load_dwordx4 v44, s[12:15], s39 offen lds
    s_waitcnt vmcnt(8)
    ds_read_b64_tr_b16 v[48:49], v47 offset:0
    ds_read_b64_tr_b16 v[50:51], v47 offset:1024
    ds_read_b64_tr_b16 v[52:53], v47 offset:2048
    ds_read_b64_tr_b16 v[54:55], v47 offset:3072
    ds_read_b64_tr_b16 v[56:57], v47 offset:32
    ds_read_b64_tr_b16 v[58:59], v47 offset:1056
    ds_read_b64_tr_b16 v[60:61], v47 offset:2080
    ds_read_b64_tr_b16 v[62:63], v47 offset:3104
    ds_read_b64_tr_b16 v[64:65], v47 offset:4096
    ds_read_b64_tr_b16 v[66:67], v47 offset:5120
    ds_read_b64_tr_b16 v[68:69], v47 offset:6144
    ds_read_b64_tr_b16 v[70:71], v47 offset:7168
    ds_read_b64_tr_b16 v[72:73], v47 offset:4128
    ds_read_b64_tr_b16 v[74:75], v47 offset:5152
    ds_read_b64_tr_b16 v[76:77], v47 offset:6176
    ds_read_b64_tr_b16 v[78:79], v47 offset:7200
    s_waitcnt lgkmcnt(0)
    v_mov_b32 v128, v48
    v_mov_b32 v130, v49
    v_mov_b32 v132, v50
    v_mov_b32 v134, v51
    v_mov_b32 v129, v52
    v_mov_b32 v131, v53
    v_mov_b32 v133, v54
    v_mov_b32 v135, v55
    v_mov_b32 v136, v56
    v_mov_b32 v138, v57
    v_mov_b32 v140, v58
    v_mov_b32 v142, v59
    v_mov_b32 v137, v60
    v_mov_b32 v139, v61
    v_mov_b32 v141, v62
    v_mov_b32 v143, v63
    v_mov_b32 v144, v64
    v_mov_b32 v146, v65
    v_mov_b32 v148, v66
    v_mov_b32 v150, v67
    v_mov_b32 v145, v68
    v_mov_b32 v147, v69
    v_mov_b32 v149, v70
    v_mov_b32 v151, v71
    v_mov_b32 v152, v72
    v_mov_b32 v154, v73
    v_mov_b32 v156, v74
    v_mov_b32 v158, v75
    v_mov_b32 v153, v76
    v_mov_b32 v155, v77
    v_mov_b32 v157, v78
    v_mov_b32 v159, v79
    s_add_u32 m0, s49, 65536
    s_add_u32 s39, s74, 3145728
    buffer_load_dwordx4 v44, s[12:15], s39 offen lds
    s_add_u32 m0, s49, 66560
    s_add_u32 s39, s74, 3276800
    buffer_load_dwordx4 v44, s[12:15], s39 offen lds
    s_add_u32 m0, s49, 67584
    s_add_u32 s39, s74, 3407872
    buffer_load_dwordx4 v44, s[12:15], s39 offen lds
    s_add_u32 m0, s49, 68608
    s_add_u32 s39, s74, 3538944
    buffer_load_dwordx4 v44, s[12:15], s39 offen lds
    s_add_u32 m0, s49, 69632
    s_add_u32 s39, s74, 3670016
    buffer_load_dwordx4 v44, s[12:15], s39 offen lds
    s_add_u32 m0, s49, 70656
    s_add_u32 s39, s74, 3801088
    buffer_load_dwordx4 v44, s[12:15], s39 offen lds
    s_add_u32 m0, s49, 71680
    s_add_u32 s39, s74, 3932160
    buffer_load_dwordx4 v44, s[12:15], s39 offen lds
    s_add_u32 m0, s49, 72704
    s_add_u32 s39, s74, 4063232
    buffer_load_dwordx4 v44, s[12:15], s39 offen lds
    s_waitcnt vmcnt(8)
    ds_read_b64_tr_b16 v[48:49], v38 offset:0
    ds_read_b64_tr_b16 v[50:51], v38 offset:1024
    ds_read_b64_tr_b16 v[52:53], v38 offset:2048
    ds_read_b64_tr_b16 v[54:55], v38 offset:3072
    ds_read_b64_tr_b16 v[56:57], v38 offset:32
    ds_read_b64_tr_b16 v[58:59], v38 offset:1056
    ds_read_b64_tr_b16 v[60:61], v38 offset:2080
    ds_read_b64_tr_b16 v[62:63], v38 offset:3104
    ds_read_b64_tr_b16 v[64:65], v38 offset:4096
    ds_read_b64_tr_b16 v[66:67], v38 offset:5120
    ds_read_b64_tr_b16 v[68:69], v38 offset:6144
    ds_read_b64_tr_b16 v[70:71], v38 offset:7168
    ds_read_b64_tr_b16 v[72:73], v38 offset:4128
    ds_read_b64_tr_b16 v[74:75], v38 offset:5152
    ds_read_b64_tr_b16 v[76:77], v38 offset:6176
    ds_read_b64_tr_b16 v[78:79], v38 offset:7200
    s_waitcnt lgkmcnt(0)
    v_mov_b32 v160, v48
    v_mov_b32 v162, v49
    v_mov_b32 v164, v50
    v_mov_b32 v166, v51
    v_mov_b32 v161, v52
    v_mov_b32 v163, v53
    v_mov_b32 v165, v54
    v_mov_b32 v167, v55
    v_mov_b32 v168, v56
    v_mov_b32 v170, v57
    v_mov_b32 v172, v58
    v_mov_b32 v174, v59
    v_mov_b32 v169, v60
    v_mov_b32 v171, v61
    v_mov_b32 v173, v62
    v_mov_b32 v175, v63
    v_mov_b32 v176, v64
    v_mov_b32 v178, v65
    v_mov_b32 v180, v66
    v_mov_b32 v182, v67
    v_mov_b32 v177, v68
    v_mov_b32 v179, v69
    v_mov_b32 v181, v70
    v_mov_b32 v183, v71
    v_mov_b32 v184, v72
    v_mov_b32 v186, v73
    v_mov_b32 v188, v74
    v_mov_b32 v190, v75
    v_mov_b32 v185, v76
    v_mov_b32 v187, v77
    v_mov_b32 v189, v78
    v_mov_b32 v191, v79
    s_add_u32 m0, s49, 0
    s_add_u32 s39, s74, 4194304
    buffer_load_dwordx4 v44, s[12:15], s39 offen lds
    s_add_u32 m0, s49, 1024
    s_add_u32 s39, s74, 4325376
    buffer_load_dwordx4 v44, s[12:15], s39 offen lds
    s_add_u32 m0, s49, 2048
    s_add_u32 s39, s74, 4456448
    buffer_load_dwordx4 v44, s[12:15], s39 offen lds
    s_add_u32 m0, s49, 3072
    s_add_u32 s39, s74, 4587520
    buffer_load_dwordx4 v44, s[12:15], s39 offen lds
    s_add_u32 m0, s49, 4096
    s_add_u32 s39, s74, 4718592
    buffer_load_dwordx4 v44, s[12:15], s39 offen lds
    s_add_u32 m0, s49, 5120
    s_add_u32 s39, s74, 4849664
    buffer_load_dwordx4 v44, s[12:15], s39 offen lds
    s_add_u32 m0, s49, 6144
    s_add_u32 s39, s74, 4980736
    buffer_load_dwordx4 v44, s[12:15], s39 offen lds
    s_add_u32 m0, s49, 7168
    s_add_u32 s39, s74, 5111808
    buffer_load_dwordx4 v44, s[12:15], s39 offen lds
    s_waitcnt vmcnt(8)
    ds_read_b64_tr_b16 v[48:49], v47 offset:0
    ds_read_b64_tr_b16 v[50:51], v47 offset:1024
    ds_read_b64_tr_b16 v[52:53], v47 offset:2048
    ds_read_b64_tr_b16 v[54:55], v47 offset:3072
    ds_read_b64_tr_b16 v[56:57], v47 offset:32
    ds_read_b64_tr_b16 v[58:59], v47 offset:1056
    ds_read_b64_tr_b16 v[60:61], v47 offset:2080
    ds_read_b64_tr_b16 v[62:63], v47 offset:3104
    ds_read_b64_tr_b16 v[64:65], v47 offset:4096
    ds_read_b64_tr_b16 v[66:67], v47 offset:5120
    ds_read_b64_tr_b16 v[68:69], v47 offset:6144
    ds_read_b64_tr_b16 v[70:71], v47 offset:7168
    ds_read_b64_tr_b16 v[72:73], v47 offset:4128
    ds_read_b64_tr_b16 v[74:75], v47 offset:5152
    ds_read_b64_tr_b16 v[76:77], v47 offset:6176
    ds_read_b64_tr_b16 v[78:79], v47 offset:7200
    s_waitcnt lgkmcnt(0)
    v_mov_b32 v192, v48
    v_mov_b32 v194, v49
    v_mov_b32 v196, v50
    v_mov_b32 v198, v51
    v_mov_b32 v193, v52
    v_mov_b32 v195, v53
    v_mov_b32 v197, v54
    v_mov_b32 v199, v55
    v_mov_b32 v200, v56
    v_mov_b32 v202, v57
    v_mov_b32 v204, v58
    v_mov_b32 v206, v59
    v_mov_b32 v201, v60
    v_mov_b32 v203, v61
    v_mov_b32 v205, v62
    v_mov_b32 v207, v63
    v_mov_b32 v208, v64
    v_mov_b32 v210, v65
    v_mov_b32 v212, v66
    v_mov_b32 v214, v67
    v_mov_b32 v209, v68
    v_mov_b32 v211, v69
    v_mov_b32 v213, v70
    v_mov_b32 v215, v71
    v_mov_b32 v216, v72
    v_mov_b32 v218, v73
    v_mov_b32 v220, v74
    v_mov_b32 v222, v75
    v_mov_b32 v217, v76
    v_mov_b32 v219, v77
    v_mov_b32 v221, v78
    v_mov_b32 v223, v79
    s_cmp_lt_u32 s28, 5
    s_cbranch_scc1 L6ab_6
    s_waitcnt vmcnt(0)
    ds_read_b64_tr_b16 v[48:49], v38 offset:0
    ds_read_b64_tr_b16 v[50:51], v38 offset:1024
    ds_read_b64_tr_b16 v[52:53], v38 offset:2048
    ds_read_b64_tr_b16 v[54:55], v38 offset:3072
    ds_read_b64_tr_b16 v[56:57], v38 offset:32
    ds_read_b64_tr_b16 v[58:59], v38 offset:1056
    ds_read_b64_tr_b16 v[60:61], v38 offset:2080
    ds_read_b64_tr_b16 v[62:63], v38 offset:3104
    ds_read_b64_tr_b16 v[64:65], v38 offset:4096
    ds_read_b64_tr_b16 v[66:67], v38 offset:5120
    ds_read_b64_tr_b16 v[68:69], v38 offset:6144
    ds_read_b64_tr_b16 v[70:71], v38 offset:7168
    ds_read_b64_tr_b16 v[72:73], v38 offset:4128
    ds_read_b64_tr_b16 v[74:75], v38 offset:5152
    ds_read_b64_tr_b16 v[76:77], v38 offset:6176
    ds_read_b64_tr_b16 v[78:79], v38 offset:7200
    s_waitcnt lgkmcnt(0)
    v_mov_b32 v224, v48
    v_mov_b32 v226, v49
    v_mov_b32 v228, v50
    v_mov_b32 v230, v51
    v_mov_b32 v225, v52
    v_mov_b32 v227, v53
    v_mov_b32 v229, v54
    v_mov_b32 v231, v55
    v_mov_b32 v232, v56
    v_mov_b32 v234, v57
    v_mov_b32 v236, v58
    v_mov_b32 v238, v59
    v_mov_b32 v233, v60
    v_mov_b32 v235, v61
    v_mov_b32 v237, v62
    v_mov_b32 v239, v63
    v_mov_b32 v240, v64
    v_mov_b32 v242, v65
    v_mov_b32 v244, v66
    v_mov_b32 v246, v67
    v_mov_b32 v241, v68
    v_mov_b32 v243, v69
    v_mov_b32 v245, v70
    v_mov_b32 v247, v71
    v_mov_b32 v248, v72
    v_mov_b32 v250, v73
    v_mov_b32 v252, v74
    v_mov_b32 v254, v75
    v_mov_b32 v249, v76
    v_mov_b32 v251, v77
    v_mov_b32 v253, v78
    v_mov_b32 v255, v79
    s_branch L6e_5
L6ab_6:
    s_add_u32 m0, s49, 65536
    s_add_u32 s39, s78, 0
    buffer_load_dwordx4 v44, s[88:91], s39 offen lds
    s_add_u32 m0, s49, 66560
    s_add_u32 s39, s78, 131072
    buffer_load_dwordx4 v44, s[88:91], s39 offen lds
    s_add_u32 m0, s49, 67584
    s_add_u32 s39, s78, 262144
    buffer_load_dwordx4 v44, s[88:91], s39 offen lds
    s_add_u32 m0, s49, 68608
    s_add_u32 s39, s78, 393216
    buffer_load_dwordx4 v44, s[88:91], s39 offen lds
    s_add_u32 m0, s49, 69632
    s_add_u32 s39, s78, 524288
    buffer_load_dwordx4 v44, s[88:91], s39 offen lds
    s_add_u32 m0, s49, 70656
    s_add_u32 s39, s78, 655360
    buffer_load_dwordx4 v44, s[88:91], s39 offen lds
    s_add_u32 m0, s49, 71680
    s_add_u32 s39, s78, 786432
    buffer_load_dwordx4 v44, s[88:91], s39 offen lds
    s_add_u32 m0, s49, 72704
    s_add_u32 s39, s78, 917504
    buffer_load_dwordx4 v44, s[88:91], s39 offen lds
    s_waitcnt vmcnt(8)
    ds_read_b64_tr_b16 v[48:49], v38 offset:0
    ds_read_b64_tr_b16 v[50:51], v38 offset:1024
    ds_read_b64_tr_b16 v[52:53], v38 offset:2048
    ds_read_b64_tr_b16 v[54:55], v38 offset:3072
    ds_read_b64_tr_b16 v[56:57], v38 offset:32
    ds_read_b64_tr_b16 v[58:59], v38 offset:1056
    ds_read_b64_tr_b16 v[60:61], v38 offset:2080
    ds_read_b64_tr_b16 v[62:63], v38 offset:3104
    ds_read_b64_tr_b16 v[64:65], v38 offset:4096
    ds_read_b64_tr_b16 v[66:67], v38 offset:5120
    ds_read_b64_tr_b16 v[68:69], v38 offset:6144
    ds_read_b64_tr_b16 v[70:71], v38 offset:7168
    ds_read_b64_tr_b16 v[72:73], v38 offset:4128
    ds_read_b64_tr_b16 v[74:75], v38 offset:5152
    ds_read_b64_tr_b16 v[76:77], v38 offset:6176
    ds_read_b64_tr_b16 v[78:79], v38 offset:7200
    s_waitcnt lgkmcnt(0)
    v_mov_b32 v224, v48
    v_mov_b32 v226, v49
    v_mov_b32 v228, v50
    v_mov_b32 v230, v51
    v_mov_b32 v225, v52
    v_mov_b32 v227, v53
    v_mov_b32 v229, v54
    v_mov_b32 v231, v55
    v_mov_b32 v232, v56
    v_mov_b32 v234, v57
    v_mov_b32 v236, v58
    v_mov_b32 v238, v59
    v_mov_b32 v233, v60
    v_mov_b32 v235, v61
    v_mov_b32 v237, v62
    v_mov_b32 v239, v63
    v_mov_b32 v240, v64
    v_mov_b32 v242, v65
    v_mov_b32 v244, v66
    v_mov_b32 v246, v67
    v_mov_b32 v241, v68
    v_mov_b32 v243, v69
    v_mov_b32 v245, v70
    v_mov_b32 v247, v71
    v_mov_b32 v248, v72
    v_mov_b32 v250, v73
    v_mov_b32 v252, v74
    v_mov_b32 v254, v75
    v_mov_b32 v249, v76
    v_mov_b32 v251, v77
    v_mov_b32 v253, v78
    v_mov_b32 v255, v79
    s_cmp_eq_u32 s28, 4
    s_cbranch_scc1 L6b_7
    s_add_u32 m0, s49, 0
    s_add_u32 s39, s75, 0
    buffer_load_dwordx4 v45, s[16:19], s39 offen lds
    s_add_u32 m0, s49, 1024
    s_add_u32 s39, s75, 10240
    buffer_load_dwordx4 v45, s[16:19], s39 offen lds
    s_add_u32 m0, s49, 2048
    s_add_u32 s39, s75, 20480
    buffer_load_dwordx4 v45, s[16:19], s39 offen lds
    s_add_u32 m0, s49, 3072
    s_add_u32 s39, s75, 30720
    buffer_load_dwordx4 v45, s[16:19], s39 offen lds
    s_add_u32 m0, s49, 4096
    s_add_u32 s39, s75, 40960
    buffer_load_dwordx4 v45, s[16:19], s39 offen lds
    s_add_u32 m0, s49, 5120
    s_add_u32 s39, s75, 51200
    buffer_load_dwordx4 v45, s[16:19], s39 offen lds
    s_add_u32 m0, s49, 6144
    s_add_u32 s39, s75, 61440
    buffer_load_dwordx4 v45, s[16:19], s39 offen lds
    s_add_u32 m0, s49, 7168
    s_add_u32 s39, s75, 71680
    buffer_load_dwordx4 v45, s[16:19], s39 offen lds
    s_waitcnt vmcnt(8)
    s_branch L6b2_8
L6b_7:
    s_waitcnt vmcnt(0)
L6b2_8:
    ds_read_b64_tr_b16 v[48:49], v47 offset:0
    ds_read_b64_tr_b16 v[50:51], v47 offset:1024
    ds_read_b64_tr_b16 v[52:53], v47 offset:2048
    ds_read_b64_tr_b16 v[54:55], v47 offset:3072
    ds_read_b64_tr_b16 v[56:57], v47 offset:32
    ds_read_b64_tr_b16 v[58:59], v47 offset:1056
    ds_read_b64_tr_b16 v[60:61], v47 offset:2080
    ds_read_b64_tr_b16 v[62:63], v47 offset:3104
    ds_read_b64_tr_b16 v[64:65], v47 offset:4096
    ds_read_b64_tr_b16 v[66:67], v47 offset:5120
    ds_read_b64_tr_b16 v[68:69], v47 offset:6144
    ds_read_b64_tr_b16 v[70:71], v47 offset:7168
    ds_read_b64_tr_b16 v[72:73], v47 offset:4128
    ds_read_b64_tr_b16 v[74:75], v47 offset:5152
    ds_read_b64_tr_b16 v[76:77], v47 offset:6176
    ds_read_b64_tr_b16 v[78:79], v47 offset:7200
    s_waitcnt lgkmcnt(0)
    v_add_u32 v46, s49, v4
    v_add_u32 v46, 65536, v46
    ds_write_b32 v46, v48 offset:0
    ds_write_b32 v46, v49 offset:8
    ds_write_b32 v46, v50 offset:1024
    ds_write_b32 v46, v51 offset:1032
    ds_write_b32 v46, v52 offset:4
    ds_write_b32 v46, v53 offset:12
    ds_write_b32 v46, v54 offset:1028
    ds_write_b32 v46, v55 offset:1036
    ds_write_b32 v46, v56 offset:2048
    ds_write_b32 v46, v57 offset:2056
    ds_write_b32 v46, v58 offset:3072
    ds_write_b32 v46, v59 offset:3080
    ds_write_b32 v46, v60 offset:2052
    ds_write_b32 v46, v61 offset:2060
    ds_write_b32 v46, v62 offset:3076
    ds_write_b32 v46, v63 offset:3084
    ds_write_b32 v46, v64 offset:4096
    ds_write_b32 v46, v65 offset:4104
    ds_write_b32 v46, v66 offset:5120
    ds_write_b32 v46, v67 offset:5128
    ds_write_b32 v46, v68 offset:4100
    ds_write_b32 v46, v69 offset:4108
    ds_write_b32 v46, v70 offset:5124
    ds_write_b32 v46, v71 offset:5132
    ds_write_b32 v46, v72 offset:6144
    ds_write_b32 v46, v73 offset:6152
    ds_write_b32 v46, v74 offset:7168
    ds_write_b32 v46, v75 offset:7176
    ds_write_b32 v46, v76 offset:6148
    ds_write_b32 v46, v77 offset:6156
    ds_write_b32 v46, v78 offset:7172
    ds_write_b32 v46, v79 offset:7180
    s_cmp_eq_u32 s28, 4
    s_cbranch_scc1 L6e_5
    v_and_b32 v39, 1, v36
    v_lshlrev_b32 v39, 4, v39
    v_lshrrev_b32 v46, 1, v36
    v_lshl_add_u32 v39, v46, 2, v39
    v_add_u32 v39, v39, v42
    v_lshlrev_b32 v39, 7, v39
    v_lshl_add_u32 v39, v43, 3, v39
    v_add_u32 v39, s49, v39
    s_waitcnt vmcnt(0) lgkmcnt(0)
    ds_read_b64_tr_b16 v[20:21], v39 offset:0
    ds_read_b64_tr_b16 v[22:23], v39 offset:1024
    ds_read_b64_tr_b16 v[24:25], v39 offset:4096
    ds_read_b64_tr_b16 v[26:27], v39 offset:5120
    s_waitcnt lgkmcnt(0)
    v_mov_b32 v48, v20
    v_mov_b32 v50, v21
    v_mov_b32 v52, v22
    v_mov_b32 v54, v23
    v_mov_b32 v49, v24
    v_mov_b32 v51, v25
    v_mov_b32 v53, v26
    v_mov_b32 v55, v27
    ds_read_b64_tr_b16 v[20:21], v39 offset:32
    ds_read_b64_tr_b16 v[22:23], v39 offset:1056
    ds_read_b64_tr_b16 v[24:25], v39 offset:4128
    ds_read_b64_tr_b16 v[26:27], v39 offset:5152
    s_waitcnt lgkmcnt(0)
    v_mov_b32 v56, v20
    v_mov_b32 v58, v21
    v_mov_b32 v60, v22
    v_mov_b32 v62, v23
    v_mov_b32 v57, v24
    v_mov_b32 v59, v25
    v_mov_b32 v61, v26
    v_mov_b32 v63, v27
    ds_read_b64_tr_b16 v[20:21], v39 offset:64
    ds_read_b64_tr_b16 v[22:23], v39 offset:1088
    ds_read_b64_tr_b16 v[24:25], v39 offset:4160
    ds_read_b64_tr_b16 v[26:27], v39 offset:5184
    s_waitcnt lgkmcnt(0)
    v_mov_b32 v64, v20
    v_mov_b32 v66, v21
    v_mov_b32 v68, v22
    v_mov_b32 v70, v23
    v_mov_b32 v65, v24
    v_mov_b32 v67, v25
    v_mov_b32 v69, v26
    v_mov_b32 v71, v27
    s_add_u32 m0, s49, 0
    s_add_u32 s39, s75, 81920
    buffer_load_dwordx4 v45, s[16:19], s39 offen lds
    s_add_u32 m0, s49, 1024
    s_add_u32 s39, s75, 92160
    buffer_load_dwordx4 v45, s[16:19], s39 offen lds
    s_add_u32 m0, s49, 2048
    s_add_u32 s39, s75, 102400
    buffer_load_dwordx4 v45, s[16:19], s39 offen lds
    s_add_u32 m0, s49, 3072
    s_add_u32 s39, s75, 112640
    buffer_load_dwordx4 v45, s[16:19], s39 offen lds
    s_add_u32 m0, s49, 4096
    s_add_u32 s39, s75, 122880
    buffer_load_dwordx4 v45, s[16:19], s39 offen lds
    s_add_u32 m0, s49, 5120
    s_add_u32 s39, s75, 133120
    buffer_load_dwordx4 v45, s[16:19], s39 offen lds
    s_add_u32 m0, s49, 6144
    s_add_u32 s39, s75, 143360
    buffer_load_dwordx4 v45, s[16:19], s39 offen lds
    s_add_u32 m0, s49, 7168
    s_add_u32 s39, s75, 153600
    buffer_load_dwordx4 v45, s[16:19], s39 offen lds
    s_waitcnt vmcnt(0)
    ds_read_b64_tr_b16 v[20:21], v39 offset:0
    ds_read_b64_tr_b16 v[22:23], v39 offset:1024
    ds_read_b64_tr_b16 v[24:25], v39 offset:4096
    ds_read_b64_tr_b16 v[26:27], v39 offset:5120
    s_waitcnt lgkmcnt(0)
    v_mov_b32 v72, v20
    v_mov_b32 v74, v21
    v_mov_b32 v76, v22
    v_mov_b32 v78, v23
    v_mov_b32 v73, v24
    v_mov_b32 v75, v25
    v_mov_b32 v77, v26
    v_mov_b32 v79, v27
    ds_read_b64_tr_b16 v[20:21], v39 offset:32
    ds_read_b64_tr_b16 v[22:23], v39 offset:1056
    ds_read_b64_tr_b16 v[24:25], v39 offset:4128
    ds_read_b64_tr_b16 v[26:27], v39 offset:5152
    s_waitcnt lgkmcnt(0)
    v_mov_b32 v80, v20
    v_mov_b32 v82, v21
    v_mov_b32 v84, v22
    v_mov_b32 v86, v23
    v_mov_b32 v81, v24
    v_mov_b32 v83, v25
    v_mov_b32 v85, v26
    v_mov_b32 v87, v27
    ds_read_b64_tr_b16 v[20:21], v39 offset:64
    ds_read_b64_tr_b16 v[22:23], v39 offset:1088
    ds_read_b64_tr_b16 v[24:25], v39 offset:4160
    ds_read_b64_tr_b16 v[26:27], v39 offset:5184
    s_waitcnt lgkmcnt(0)
    v_mov_b32 v88, v20
    v_mov_b32 v90, v21
    v_mov_b32 v92, v22
    v_mov_b32 v94, v23
    v_mov_b32 v89, v24
    v_mov_b32 v91, v25
    v_mov_b32 v93, v26
    v_mov_b32 v95, v27
L6e_5:
    s_mov_b32 s12, s72
    s_and_b32 s13, s73, 0xffff
    s_mov_b32 s14, 10240
    s_mov_b32 s15, 0x00020000
    v_lshlrev_b32 v46, 1, v0
    s_mov_b32 s38, 0
    buffer_load_ushort v20, v46, s[12:15], s38 offen
    buffer_load_ushort v28, v46, s[12:15], s38 offen offset:1024
    s_mov_b32 s38, 1280
    buffer_load_ushort v21, v46, s[12:15], s38 offen
    buffer_load_ushort v29, v46, s[12:15], s38 offen offset:1024
    s_mov_b32 s38, 2560
    buffer_load_ushort v22, v46, s[12:15], s38 offen
    buffer_load_ushort v30, v46, s[12:15], s38 offen offset:1024
    s_mov_b32 s38, 3840
    buffer_load_ushort v23, v46, s[12:15], s38 offen
    buffer_load_ushort v31, v46, s[12:15], s38 offen offset:1024
    s_mov_b32 s38, 5120
    buffer_load_ushort v24, v46, s[12:15], s38 offen
    buffer_load_ushort v32, v46, s[12:15], s38 offen offset:1024
    s_mov_b32 s38, 6400
    buffer_load_ushort v25, v46, s[12:15], s38 offen
    buffer_load_ushort v33, v46, s[12:15], s38 offen offset:1024
    s_mov_b32 s38, 7680
    buffer_load_ushort v26, v46, s[12:15], s38 offen
    buffer_load_ushort v34, v46, s[12:15], s38 offen offset:1024
    s_mov_b32 s38, 8960
    buffer_load_ushort v27, v46, s[12:15], s38 offen
    buffer_load_ushort v35, v46, s[12:15], s38 offen offset:1024
    s_waitcnt vmcnt(0) lgkmcnt(0)
    s_cmp_lg_u32 s28, 7
    s_cbranch_scc1 L6_9
    s_cmp_lg_u32 s59, 0
    s_cbranch_scc1 L6_9
    s_load_dwordx2 s[88:89], s[0:1], 144
    v_and_b32 v80, 63, v0
    v_and_b32 v81, 7, v80
    v_lshlrev_b32 v81, 2, v81
    s_waitcnt lgkmcnt(0)
    s_mov_b32 s4, s88
    s_and_b32 s5, s89, 0xffff
    s_mov_b32 s6, 256
    s_mov_b32 s7, 0x00020000
    s_mov_b32 s90, 0
    s_mov_b64 exec, 0xffff
Lv_10:
    buffer_load_dword v83, v81, s[4:7], 0 offen offset:128 sc1
    buffer_load_dword v82, v81, s[4:7], 0 offen sc1
    s_waitcnt vmcnt(0)
    s_nop 1
    v_add_u32_dpp v83, v83, v83 row_ror:4 row_mask:0xf bank_mask:0xf
    s_nop 1
    v_add_u32_dpp v83, v83, v83 row_ror:2 row_mask:0xf bank_mask:0xf
    s_nop 1
    v_add_u32_dpp v83, v83, v83 row_ror:1 row_mask:0xf bank_mask:0xf
    s_nop 0
    v_readlane_b32 s91, v83, 0
    s_add_u32 s90, s90, 1
    s_cmp_ge_u32 s91, 256
    s_cbranch_scc1 Lvd_11
    s_sleep 2
    s_cmp_lt_u32 s90, 4194304
    s_cbranch_scc1 Lv_10
Lvd_11:
    v_cmp_ne_u32 vcc, 32, v82
    s_mov_b32 s92, 0
    s_cbranch_vccz Lvo_12
    buffer_load_dword v82, v81, s[4:7], 0 offen sc1
    s_waitcnt vmcnt(0)
    v_cmp_ne_u32 vcc, 32, v82
    s_cbranch_vccz Lvo_12
    s_mov_b32 s92, 1
Lvo_12:
    v_cmp_gt_u32 vcc, s83, v80
    s_nop 1
    v_cndmask_b32 v83, 0, v82, vcc
    s_nop 1
    v_add_u32_dpp v83, v83, v83 row_ror:8 row_mask:0xf bank_mask:0xf
    s_nop 1
    v_add_u32_dpp v83, v83, v83 row_ror:4 row_mask:0xf bank_mask:0xf
    s_nop 1
    v_add_u32_dpp v83, v83, v83 row_ror:2 row_mask:0xf bank_mask:0xf
    s_nop 1
    v_add_u32_dpp v83, v83, v83 row_ror:1 row_mask:0xf bank_mask:0xf
    s_nop 0
    v_readlane_b32 s91, v83, 0
    s_nop 3
    s_add_u32 s91, s91, s84
    s_mov_b64 exec, 1
    v_mov_b32 v84, s92
    v_mov_b32 v85, s91
    v_mov_b32 v86, 0
    v_mov_b32 v80, 163776
    ds_write_b96 v80, v[84:86]
    s_waitcnt lgkmcnt(0)
    s_mov_b64 exec, -1
L6_9:
    s_barrier
    s_cmp_lg_u32 s59, 0
    s_cbranch_scc1 Lhv_13
    v_mov_b32 v46, 163776
    ds_read_b64 v[44:45], v46
    s_waitcnt lgkmcnt(0)
    v_readfirstlane_b32 s92, v44
    v_readfirstlane_b32 s91, v45
    s_nop 3
    s_cmp_lg_u32 s92, 0
    s_cbranch_scc1 Lm_restart
Lhv_13:
    v_lshl_or_b32 v36, v21, 16, v20
    v_lshl_or_b32 v37, v23, 16, v22
    v_lshl_or_b32 v38, v25, 16, v24
    v_lshl_or_b32 v39, v27, 16, v26
    v_add_u32 v40, 0, v0
    v_lshrrev_b32 v41, 5, v40
    v_lshlrev_b32 v41, 6, v41
    v_lshl_add_u32 v41, v40, 4, v41
    ds_write_b128 v41, v[36:39] offset:6144
    v_lshl_or_b32 v36, v29, 16, v28
    v_lshl_or_b32 v37, v31, 16, v30
    v_lshl_or_b32 v38, v33, 16, v32
    v_lshl_or_b32 v39, v35, 16, v34
    v_add_u32 v40, 512, v0
    v_lshrrev_b32 v41, 5, v40
    v_lshlrev_b32 v41, 6, v41
    v_lshl_add_u32 v41, v40, 4, v41
    s_cmp_ge_u32 s28, 2
    s_cbranch_scc1 L6_15
    ds_write_b128 v41, v[36:39] offset:6144
L6_15:
    ds_write_b32 v6, v6 offset:36
    s_cmp_lg_u32 s28, 4
    s_cbranch_scc1 L6_16
    s_and_b32 s38, s25, 15
    s_lshl_b32 s39, s38, 21
    s_lshl_b32 s80, s38, 3
    s_lshl_b32 s38, s24, 1
    s_lshr_b32 s81, s25, 4
    s_add_u32 s38, s38, s81
    s_add_u32 s80, s80, s38
    s_lshl_b32 s80, s80, 3
    s_add_u32 s80, s80, 125829120
    s_lshl_b32 s38, s38, 14
    s_add_u32 s39, s39, s38
    s_add_u32 s39, s39, 134225408
    s_add_u32 s38, s39, 8192
    s_mov_b64 exec, 1
    buffer_store_dword v16, v6, s[8:11], s39 offen sc1
    buffer_store_dword v16, v6, s[8:11], s38 offen sc1
    s_waitcnt vmcnt(0)
    s_memtime s[74:75]
    s_waitcnt lgkmcnt(0)
    buffer_load_dword v11, v6, s[8:11], s39 offen sc1
    s_waitcnt vmcnt(0)
    s_memtime s[78:79]
    s_waitcnt lgkmcnt(0)
    s_sub_u32 s78, s78, s74
    s_or_b32 s76, s78, 1
    s_memtime s[74:75]
    s_waitcnt lgkmcnt(0)
    buffer_load_dword v11, v6, s[8:11], s38 offen sc1
    s_waitcnt vmcnt(0)
    s_memtime s[78:79]
    s_waitcnt lgkmcnt(0)
    s_sub_u32 s78, s78, s74
    s_or_b32 s77, s78, 1
    v_mov_b32 v40, s76
    v_mov_b32 v41, s77
    buffer_store_dwordx2 v[40:41], v6, s[8:11], s80 offen sc1
    s_mov_b64 exec, -1
L6_16:
    s_cmp_lg_u32 s28, 5
    s_cbranch_scc1 L6_17
    s_buffer_load_dwordx4 s[64:67], s[8:11], s58 glc
    s_mov_b32 s40, 0
Lkvw_18:
    s_waitcnt lgkmcnt(0)
    s_and_b32 s38, s64, s65
    s_and_b32 s39, s66, s67
    s_and_b32 s38, s38, s39
    s_add_u32 s40, s40, 1
    s_cmp_ge_u32 s38, 1
    s_cbranch_scc1 Lkvd_19
    s_sleep 4
    s_buffer_load_dwordx4 s[64:67], s[8:11], s58 glc
    s_cmp_lt_u32 s40, 200000
    s_cbranch_scc1 Lkvw_18
Lkvd_19:
    s_add_u32 s58, s58, 2048
    s_add_u32 m0, s54, 0
    s_add_u32 s38, s46, 0
    buffer_load_dwordx4 v4, s[8:11], s38 offen lds
    s_add_u32 m0, s54, 1024
    s_add_u32 s38, s46, 1024
    buffer_load_dwordx4 v4, s[8:11], s38 offen lds
    s_add_u32 m0, s54, 2048
    s_add_u32 s38, s46, 2048
    buffer_load_dwordx4 v4, s[8:11], s38 offen lds
    s_add_u32 m0, s54, 3072
    s_add_u32 s38, s46, 3072
    buffer_load_dwordx4 v4, s[8:11], s38 offen lds
    s_add_u32 m0, s54, 4096
    s_add_u32 s38, s46, 4096
    buffer_load_dwordx4 v4, s[8:11], s38 offen lds
    s_add_u32 m0, s54, 5120
    s_add_u32 s38, s46, 5120
    buffer_load_dwordx4 v4, s[8:11], s38 offen lds
    s_add_u32 m0, s54, 6144
    s_add_u32 s38, s46, 6144
    buffer_load_dwordx4 v4, s[8:11], s38 offen lds
    s_add_u32 m0, s54, 7168
    s_add_u32 s38, s46, 7168
    buffer_load_dwordx4 v4, s[8:11], s38 offen lds
    s_add_u32 m0, s54, 8192
    s_add_u32 s38, s47, 0
    buffer_load_dwordx4 v4, s[8:11], s38 offen lds
    s_add_u32 m0, s54, 9216
    s_add_u32 s38, s47, 1024
    buffer_load_dwordx4 v4, s[8:11], s38 offen lds
    s_add_u32 s46, s46, 262144
    s_add_u32 s47, s47, 262144
    s_add_u32 s54, s54, 10240
    s_cmp_eq_u32 s54, 61440
    s_cselect_b32 s54, 30720, s54
    s_buffer_load_dwordx4 s[64:67], s[8:11], s58 glc
    s_mov_b32 s40, 0
Lkvw_20:
    s_waitcnt lgkmcnt(0)
    s_and_b32 s38, s64, s65
    s_and_b32 s39, s66, s67
    s_and_b32 s38, s38, s39
    s_add_u32 s40, s40, 1
    s_cmp_ge_u32 s38, 1
    s_cbranch_scc1 Lkvd_21
    s_sleep 4
    s_buffer_load_dwordx4 s[64:67], s[8:11], s58 glc
    s_cmp_lt_u32 s40, 200000
    s_cbranch_scc1 Lkvw_20
Lkvd_21:
    s_add_u32 s58, s58, 2048
    s_add_u32 m0, s54, 0
    s_add_u32 s38, s46, 0
    buffer_load_dwordx4 v4, s[8:11], s38 offen lds
    s_add_u32 m0, s54, 1024
    s_add_u32 s38, s46, 1024
    buffer_load_dwordx4 v4, s[8:11], s38 offen lds
    s_add_u32 m0, s54, 2048
    s_add_u32 s38, s46, 2048
    buffer_load_dwordx4 v4, s[8:11], s38 offen lds
    s_add_u32 m0, s54, 3072
    s_add_u32 s38, s46, 3072
    buffer_load_dwordx4 v4, s[8:11], s38 offen lds
    s_add_u32 m0, s54, 4096
    s_add_u32 s38, s46, 4096
    buffer_load_dwordx4 v4, s[8:11], s38 offen lds
    s_add_u32 m0, s54, 5120
    s_add_u32 s38, s46, 5120
    buffer_load_dwordx4 v4, s[8:11], s38 offen lds
    s_add_u32 m0, s54, 6144
    s_add_u32 s38, s46, 6144
    buffer_load_dwordx4 v4, s[8:11], s38 offen lds
    s_add_u32 m0, s54, 7168
    s_add_u32 s38, s46, 7168
    buffer_load_dwordx4 v4, s[8:11], s38 offen lds
    s_add_u32 m0, s54, 8192
    s_add_u32 s38, s47, 0
    buffer_load_dwordx4 v4, s[8:11], s38 offen lds
    s_add_u32 m0, s54, 9216
    s_add_u32 s38, s47, 1024
    buffer_load_dwordx4 v4, s[8:11], s38 offen lds
    s_add_u32 s46, s46, 262144
    s_add_u32 s47, s47, 262144
    s_add_u32 s54, s54, 10240
    s_cmp_eq_u32 s54, 61440
    s_cselect_b32 s54, 30720, s54
    s_waitcnt vmcnt(10)
L6_17:
    s_cmp_lg_u32 s28, 7
    s_cbranch_scc1 L6_22
    s_lshl_b32 s38, s27, 11
    s_add_u32 s20, s46, s38
    s_add_u32 s20, s20, 524288
    s_add_u32 s21, s47, 524288
    s_add_u32 s58, s58, 4096
    s_buffer_load_dwordx4 s[64:67], s[8:11], s58 glc
    s_mov_b32 s40, 0
Lkvw_23:
    s_waitcnt lgkmcnt(0)
    s_and_b32 s38, s64, s65
    s_and_b32 s39, s66, s67
    s_and_b32 s38, s38, s39
    s_add_u32 s40, s40, 1
    s_cmp_ge_u32 s38, 1
    s_cbranch_scc1 Lkvd_24
    s_sleep 4
    s_buffer_load_dwordx4 s[64:67], s[8:11], s58 glc
    s_cmp_lt_u32 s40, 200000
    s_cbranch_scc1 Lkvw_23
Lkvd_24:
    s_add_u32 s58, s58, 2048
    s_add_u32 s38, s20, 0
    s_buffer_load_dword s68, s[8:11], s38 glc
    s_add_u32 s39, s21, 0
    s_buffer_load_dword s76, s[8:11], s39 glc
    s_add_u32 s38, s20, 128
    s_buffer_load_dword s69, s[8:11], s38 glc
    s_add_u32 s39, s21, 128
    s_buffer_load_dword s77, s[8:11], s39 glc
    s_add_u32 s38, s20, 256
    s_buffer_load_dword s70, s[8:11], s38 glc
    s_add_u32 s39, s21, 256
    s_buffer_load_dword s78, s[8:11], s39 glc
    s_add_u32 s38, s20, 384
    s_buffer_load_dword s71, s[8:11], s38 glc
    s_add_u32 s39, s21, 384
    s_buffer_load_dword s79, s[8:11], s39 glc
    s_add_u32 s38, s20, 512
    s_buffer_load_dword s72, s[8:11], s38 glc
    s_add_u32 s39, s21, 512
    s_buffer_load_dword s80, s[8:11], s39 glc
    s_add_u32 s38, s20, 640
    s_buffer_load_dword s73, s[8:11], s38 glc
    s_add_u32 s39, s21, 640
    s_buffer_load_dword s81, s[8:11], s39 glc
    s_add_u32 s38, s20, 768
    s_buffer_load_dword s74, s[8:11], s38 glc
    s_add_u32 s39, s21, 768
    s_buffer_load_dword s82, s[8:11], s39 glc
    s_add_u32 s38, s20, 896
    s_buffer_load_dword s75, s[8:11], s38 glc
    s_add_u32 s39, s21, 896
    s_buffer_load_dword s83, s[8:11], s39 glc
    s_add_u32 s38, s20, 1024
    s_buffer_load_dword s68, s[8:11], s38 glc
    s_add_u32 s39, s21, 1024
    s_buffer_load_dword s76, s[8:11], s39 glc
    s_add_u32 s38, s20, 1152
    s_buffer_load_dword s69, s[8:11], s38 glc
    s_add_u32 s39, s21, 1152
    s_buffer_load_dword s77, s[8:11], s39 glc
    s_add_u32 s38, s20, 1280
    s_buffer_load_dword s70, s[8:11], s38 glc
    s_add_u32 s39, s21, 1280
    s_buffer_load_dword s78, s[8:11], s39 glc
    s_add_u32 s38, s20, 1408
    s_buffer_load_dword s71, s[8:11], s38 glc
    s_add_u32 s39, s21, 1408
    s_buffer_load_dword s79, s[8:11], s39 glc
    s_add_u32 s38, s20, 1536
    s_buffer_load_dword s72, s[8:11], s38 glc
    s_add_u32 s39, s21, 1536
    s_buffer_load_dword s80, s[8:11], s39 glc
    s_add_u32 s38, s20, 1664
    s_buffer_load_dword s73, s[8:11], s38 glc
    s_add_u32 s39, s21, 1664
    s_buffer_load_dword s81, s[8:11], s39 glc
    s_add_u32 s38, s20, 1792
    s_buffer_load_dword s74, s[8:11], s38 glc
    s_add_u32 s39, s21, 1792
    s_buffer_load_dword s82, s[8:11], s39 glc
    s_add_u32 s38, s20, 1920
    s_buffer_load_dword s75, s[8:11], s38 glc
    s_add_u32 s39, s21, 1920
    s_buffer_load_dword s83, s[8:11], s39 glc
    s_add_u32 s20, s20, 262144
    s_add_u32 s21, s21, 262144
    s_buffer_load_dwordx4 s[64:67], s[8:11], s58 glc
L6_22:
    s_waitcnt lgkmcnt(0)
    s_cmp_lg_u32 s59, 0
    s_cbranch_scc1 L6_safe
    s_cmp_eq_u32 s28, 4
    s_cbranch_scc1 L6f_w4
    s_cmp_eq_u32 s28, 5
    s_cbranch_scc1 L6f_w5
    s_cmp_eq_u32 s28, 6
    s_cbranch_scc1 L6f_w6
    s_cmp_eq_u32 s28, 7
    s_cbranch_scc1 L6f_w7
    s_lshl_b32 s38, s27, 11
    s_lshl_b32 s39, s28, 9
    s_add_u32 s20, s46, s38
    s_add_u32 s20, s20, s39
    s_add_u32 s20, s20, 786432
    s_add_u32 s21, s47, s39
    s_add_u32 s21, s21, 786432
    v_mov_b32 v36, 0
    v_mov_b32 v37, 0
    v_mov_b32 v38, 0
    v_mov_b32 v39, 0
    v_mov_b32 v40, 0
    v_mov_b32 v41, 0
    v_mov_b32 v42, 0
    v_mov_b32 v43, 0
    s_branch L6f_c_bm
L6f_c:
    s_sleep 3
    s_mov_b32 s40, 0
    buffer_load_dwordx4 v[20:23], v2, s[8:11], s30 offen offset:0 sc1
    buffer_load_dwordx4 v[24:27], v2, s[8:11], s30 offen offset:1024 sc1
Lpchk_25:
    s_waitcnt vmcnt(0)
    v_max3_u32 v11, v20, v21, v22
    v_max_u32 v11, v11, v23
    v_cmp_eq_u32 s[84:85], -1, v11
    v_max3_u32 v13, v24, v25, v26
    v_max_u32 v13, v13, v27
    v_cmp_eq_u32 s[86:87], -1, v13
    s_or_b64 vcc, s[84:85], s[86:87]
    s_cbranch_scc0 Lpd_26
    s_mov_b64 exec, s[84:85]
    s_cbranch_execz Lpsk_27
    buffer_load_dwordx4 v[20:23], v2, s[8:11], s30 offen offset:0 sc1
Lpsk_27:
    s_mov_b64 exec, s[86:87]
    s_cbranch_execz Lpsk_28
    buffer_load_dwordx4 v[24:27], v2, s[8:11], s30 offen offset:1024 sc1
Lpsk_28:
    s_mov_b64 exec, -1
    s_add_u32 s40, s40, 1
    s_cmp_lt_u32 s40, 200000
    s_cbranch_scc1 Lpchk_25
    s_waitcnt vmcnt(0)
Lpd_26:
    ds_write_b128 v5, v[20:23]
    ds_write_b128 v5, v[24:27] offset:1152
    s_waitcnt lgkmcnt(0)
L6f_c_bm:
    s_barrier
    ds_read_b64_tr_b16 v[20:21], v7 offset:0
    ds_read_b64_tr_b16 v[22:23], v7 offset:64
    ds_read_b64_tr_b16 v[24:25], v7 offset:1152
    ds_read_b64_tr_b16 v[26:27], v7 offset:1216
    ds_read_b64_tr_b16 v[28:29], v7 offset:2304
    ds_read_b64_tr_b16 v[30:31], v7 offset:2368
    ds_read_b64_tr_b16 v[32:33], v7 offset:3456
    ds_read_b64_tr_b16 v[34:35], v7 offset:3520
    s_waitcnt lgkmcnt(6)
    v_smfmac_f32_16x16x64_bf16 v[36:39], v[20:23], v[96:103], v10
    v_smfmac_f32_16x16x64_bf16 v[40:43], v[20:23], v[104:111], v10
    ds_read_b64_tr_b16 v[20:21], v7 offset:4608
    ds_read_b64_tr_b16 v[22:23], v7 offset:4672
    s_waitcnt lgkmcnt(6)
    v_smfmac_f32_16x16x64_bf16 v[36:39], v[24:27], v[112:119], v10
    v_smfmac_f32_16x16x64_bf16 v[40:43], v[24:27], v[120:127], v10
    ds_read_b64_tr_b16 v[24:25], v7 offset:5760
    ds_read_b64_tr_b16 v[26:27], v7 offset:5824
    s_waitcnt lgkmcnt(6)
    v_smfmac_f32_16x16x64_bf16 v[36:39], v[28:31], v[128:135], v10
    v_smfmac_f32_16x16x64_bf16 v[40:43], v[28:31], v[136:143], v10
    ds_read_b64_tr_b16 v[28:29], v7 offset:6912
    ds_read_b64_tr_b16 v[30:31], v7 offset:6976
    s_waitcnt lgkmcnt(6)
    v_smfmac_f32_16x16x64_bf16 v[36:39], v[32:35], v[144:151], v10
    v_smfmac_f32_16x16x64_bf16 v[40:43], v[32:35], v[152:159], v10
    ds_read_b64_tr_b16 v[32:33], v7 offset:8064
    ds_read_b64_tr_b16 v[34:35], v7 offset:8128
    s_waitcnt lgkmcnt(6)
    v_smfmac_f32_16x16x64_bf16 v[36:39], v[20:23], v[160:167], v10
    v_smfmac_f32_16x16x64_bf16 v[40:43], v[20:23], v[168:175], v10
    ds_read_b64_tr_b16 v[20:21], v7 offset:9216
    ds_read_b64_tr_b16 v[22:23], v7 offset:9280
    s_waitcnt lgkmcnt(6)
    v_smfmac_f32_16x16x64_bf16 v[36:39], v[24:27], v[176:183], v10
    v_smfmac_f32_16x16x64_bf16 v[40:43], v[24:27], v[184:191], v10
    ds_read_b64_tr_b16 v[24:25], v7 offset:10368
    ds_read_b64_tr_b16 v[26:27], v7 offset:10432
    s_waitcnt lgkmcnt(6)
    v_smfmac_f32_16x16x64_bf16 v[36:39], v[28:31], v[192:199], v10
    v_smfmac_f32_16x16x64_bf16 v[40:43], v[28:31], v[200:207], v10
    s_waitcnt lgkmcnt(4)
    v_smfmac_f32_16x16x64_bf16 v[36:39], v[32:35], v[208:215], v10
    v_smfmac_f32_16x16x64_bf16 v[40:43], v[32:35], v[216:223], v10
    s_waitcnt lgkmcnt(2)
    v_smfmac_f32_16x16x64_bf16 v[36:39], v[20:23], v[224:231], v10
    v_smfmac_f32_16x16x64_bf16 v[40:43], v[20:23], v[232:239], v10
    s_waitcnt lgkmcnt(0)
    v_smfmac_f32_16x16x64_bf16 v[36:39], v[24:27], v[240:247], v10
    v_smfmac_f32_16x16x64_bf16 v[40:43], v[24:27], v[248:255], v10
    s_nop 7
    v_permlane32_swap_b32 v36, v40
    v_permlane32_swap_b32 v37, v41
    v_permlane32_swap_b32 v38, v42
    v_permlane32_swap_b32 v39, v43
    v_add_f32 v36, v36, v40
    v_add_f32 v37, v37, v41
    v_add_f32 v38, v38, v42
    v_add_f32 v39, v39, v43
    v_cvt_pk_bf16_f32 v44, v36, v37
    v_cvt_pk_bf16_f32 v45, v38, v39
    ds_write_b64 v9, v[44:45]
    s_waitcnt lgkmcnt(0)
    s_barrier
    s_cmp_eq_u32 s29, 63
    s_cbranch_scc1 L6_last
    s_and_b32 s38, s29, 3
    s_add_u32 s39, s29, 2
    s_and_b32 s39, s39, 3
    s_lshl_b32 s32, s38, 16
    s_add_u32 s32, s32, s52
    s_lshl_b32 s36, s39, 16
    s_add_u32 s36, s36, s52
    s_add_u32 s38, s29, 1
    s_and_b32 s38, s38, 3
    s_mul_i32 s30, s38, 40960
    s_add_u32 s30, s30, s50
    s_add_u32 s39, s29, 3
    s_and_b32 s39, s39, 3
    s_mul_i32 s34, s39, 40960
    s_add_u32 s34, s34, s50
    s_add_u32 s29, s29, 1
    v_mov_b32 v36, 0
    v_mov_b32 v37, 0
    v_mov_b32 v38, 0
    v_mov_b32 v39, 0
    v_mov_b32 v40, 0
    v_mov_b32 v41, 0
    v_mov_b32 v42, 0
    v_mov_b32 v43, 0
    v_mov_b32 v44, 0
    v_mov_b32 v45, 0
    v_mov_b32 v46, 0
    v_mov_b32 v47, 0
    s_barrier
    s_sleep 3
    s_mov_b32 s40, 0
    buffer_load_dwordx4 v[20:23], v3, s[8:11], s32 offen offset:0 sc1
    buffer_load_dwordx4 v[24:27], v3, s[8:11], s32 offen offset:1024 sc1
Lpchk_29:
    s_waitcnt vmcnt(0)
    v_max3_u32 v11, v20, v21, v22
    v_max_u32 v11, v11, v23
    v_cmp_eq_u32 s[84:85], -1, v11
    v_max3_u32 v13, v24, v25, v26
    v_max_u32 v13, v13, v27
    v_cmp_eq_u32 s[86:87], -1, v13
    s_or_b64 vcc, s[84:85], s[86:87]
    s_cbranch_scc0 Lpd_30
    s_mov_b64 exec, s[84:85]
    s_cbranch_execz Lpsk_31
    buffer_load_dwordx4 v[20:23], v3, s[8:11], s32 offen offset:0 sc1
Lpsk_31:
    s_mov_b64 exec, s[86:87]
    s_cbranch_execz Lpsk_32
    buffer_load_dwordx4 v[24:27], v3, s[8:11], s32 offen offset:1024 sc1
Lpsk_32:
    s_mov_b64 exec, -1
    s_add_u32 s40, s40, 1
    s_cmp_lt_u32 s40, 200000
    s_cbranch_scc1 Lpchk_29
    s_waitcnt vmcnt(0)
Lpd_30:
    v_smfmac_f32_16x16x64_bf16 v[36:39], v[20:23], v[48:55], v10
    v_smfmac_f32_16x16x64_bf16 v[36:39], v[24:27], v[72:79], v10
    v_smfmac_f32_16x16x64_bf16 v[40:43], v[20:23], v[56:63], v10
    v_smfmac_f32_16x16x64_bf16 v[40:43], v[24:27], v[80:87], v10
    v_smfmac_f32_16x16x64_bf16 v[44:47], v[20:23], v[64:71], v10
    v_smfmac_f32_16x16x64_bf16 v[44:47], v[24:27], v[88:95], v10
    s_nop 3
    ds_write_b128 v17, v[36:39]
    s_nop 0
    ds_write_b128 v17, v[40:43] offset:1024
    s_nop 0
    ds_write_b128 v17, v[44:47] offset:2048
    s_waitcnt lgkmcnt(0)
    s_barrier
    v_mov_b32 v36, 0
    v_mov_b32 v37, 0
    v_mov_b32 v38, 0
    v_mov_b32 v39, 0
    v_mov_b32 v40, 0
    v_mov_b32 v41, 0
    v_mov_b32 v42, 0
    v_mov_b32 v43, 0
    s_cmp_ge_u32 s29, 61
    s_cbranch_scc1 L6f_cnp
    s_add_u32 s38, s20, 0
    s_buffer_load_dword s92, s[8:11], s38 glc
    s_add_u32 s39, s21, 0
    s_buffer_load_dword s96, s[8:11], s39 glc
    s_add_u32 s38, s20, 128
    s_buffer_load_dword s93, s[8:11], s38 glc
    s_add_u32 s39, s21, 128
    s_buffer_load_dword s97, s[8:11], s39 glc
    s_add_u32 s38, s20, 256
    s_buffer_load_dword s94, s[8:11], s38 glc
    s_add_u32 s39, s21, 256
    s_buffer_load_dword s98, s[8:11], s39 glc
    s_add_u32 s38, s20, 384
    s_buffer_load_dword s95, s[8:11], s38 glc
    s_add_u32 s39, s21, 384
    s_buffer_load_dword s99, s[8:11], s39 glc
    s_add_u32 s20, s20, 262144
    s_add_u32 s21, s21, 262144
L6f_cnp:
    s_barrier
    s_branch L6f_c
L6f_w4:
    v_mov_b32 v92, -1
    v_mov_b32 v93, -1
    v_mov_b32 v94, -1
    v_mov_b32 v95, -1
    v_mov_b32 v36, 0
    v_mov_b32 v37, 0
    v_mov_b32 v38, 0
    v_mov_b32 v39, 0
    v_mov_b32 v40, 0
    v_mov_b32 v41, 0
    v_mov_b32 v42, 0
    v_mov_b32 v43, 0
    s_branch L6f_w4_bm
L6f_w4l:
    s_sleep 3
    s_mov_b32 s40, 0
    buffer_load_dwordx4 v[20:23], v2, s[8:11], s30 offen offset:0 sc1
    buffer_load_dwordx4 v[24:27], v2, s[8:11], s30 offen offset:1024 sc1
Lpchk_33:
    s_waitcnt vmcnt(0)
    v_max3_u32 v11, v20, v21, v22
    v_max_u32 v11, v11, v23
    v_cmp_eq_u32 s[84:85], -1, v11
    v_max3_u32 v13, v24, v25, v26
    v_max_u32 v13, v13, v27
    v_cmp_eq_u32 s[86:87], -1, v13
    s_or_b64 vcc, s[84:85], s[86:87]
    s_cbranch_scc0 Lpd_34
    s_mov_b64 exec, s[84:85]
    s_cbranch_execz Lpsk_35
    buffer_load_dwordx4 v[20:23], v2, s[8:11], s30 offen offset:0 sc1
Lpsk_35:
    s_mov_b64 exec, s[86:87]
    s_cbranch_execz Lpsk_36
    buffer_load_dwordx4 v[24:27], v2, s[8:11], s30 offen offset:1024 sc1
Lpsk_36:
    s_mov_b64 exec, -1
    s_add_u32 s40, s40, 1
    s_cmp_lt_u32 s40, 200000
    s_cbranch_scc1 Lpchk_33
    s_waitcnt vmcnt(0)
Lpd_34:
    ds_write_b128 v5, v[20:23]
    ds_write_b128 v5, v[24:27] offset:1152
    s_waitcnt lgkmcnt(0)
L6f_w4_bm:
    s_barrier
    ds_read_b64_tr_b16 v[20:21], v7 offset:0
    ds_read_b64_tr_b16 v[22:23], v7 offset:64
    ds_read_b64_tr_b16 v[24:25], v7 offset:1152
    ds_read_b64_tr_b16 v[26:27], v7 offset:1216
    ds_read_b64_tr_b16 v[28:29], v7 offset:2304
    ds_read_b64_tr_b16 v[30:31], v7 offset:2368
    ds_read_b64_tr_b16 v[32:33], v7 offset:3456
    ds_read_b64_tr_b16 v[34:35], v7 offset:3520
    s_waitcnt lgkmcnt(6)
    v_smfmac_f32_16x16x64_bf16 v[36:39], v[20:23], v[96:103], v10
    v_smfmac_f32_16x16x64_bf16 v[40:43], v[20:23], v[104:111], v10
    ds_read_b64_tr_b16 v[20:21], v7 offset:4608
    ds_read_b64_tr_b16 v[22:23], v7 offset:4672
    s_waitcnt lgkmcnt(6)
    v_smfmac_f32_16x16x64_bf16 v[36:39], v[24:27], v[112:119], v10
    v_smfmac_f32_16x16x64_bf16 v[40:43], v[24:27], v[120:127], v10
    ds_read_b64_tr_b16 v[24:25], v7 offset:5760
    ds_read_b64_tr_b16 v[26:27], v7 offset:5824
    s_waitcnt lgkmcnt(6)
    v_smfmac_f32_16x16x64_bf16 v[36:39], v[28:31], v[128:135], v10
    v_smfmac_f32_16x16x64_bf16 v[40:43], v[28:31], v[136:143], v10
    ds_read_b64_tr_b16 v[28:29], v7 offset:6912
    ds_read_b64_tr_b16 v[30:31], v7 offset:6976
    s_waitcnt lgkmcnt(6)
    v_smfmac_f32_16x16x64_bf16 v[36:39], v[32:35], v[144:151], v10
    v_smfmac_f32_16x16x64_bf16 v[40:43], v[32:35], v[152:159], v10
    ds_read_b64_tr_b16 v[32:33], v7 offset:8064
    ds_read_b64_tr_b16 v[34:35], v7 offset:8128
    s_waitcnt lgkmcnt(6)
    v_smfmac_f32_16x16x64_bf16 v[36:39], v[20:23], v[160:167], v10
    v_smfmac_f32_16x16x64_bf16 v[40:43], v[20:23], v[168:175], v10
    ds_read_b64_tr_b16 v[20:21], v7 offset:9216
    ds_read_b64_tr_b16 v[22:23], v7 offset:9280
    s_waitcnt lgkmcnt(6)
    v_smfmac_f32_16x16x64_bf16 v[36:39], v[24:27], v[176:183], v10
    v_smfmac_f32_16x16x64_bf16 v[40:43], v[24:27], v[184:191], v10
    ds_read_b64_tr_b16 v[24:25], v7 offset:10368
    ds_read_b64_tr_b16 v[26:27], v7 offset:10432
    s_waitcnt lgkmcnt(6)
    v_smfmac_f32_16x16x64_bf16 v[36:39], v[28:31], v[192:199], v10
    v_smfmac_f32_16x16x64_bf16 v[40:43], v[28:31], v[200:207], v10
    s_waitcnt lgkmcnt(4)
    v_smfmac_f32_16x16x64_bf16 v[36:39], v[32:35], v[208:215], v10
    v_smfmac_f32_16x16x64_bf16 v[40:43], v[32:35], v[216:223], v10
    s_waitcnt lgkmcnt(2)
    v_smfmac_f32_16x16x64_bf16 v[36:39], v[20:23], v[224:231], v10
    v_smfmac_f32_16x16x64_bf16 v[40:43], v[20:23], v[232:239], v10
    s_waitcnt lgkmcnt(0)
    v_smfmac_f32_16x16x64_bf16 v[36:39], v[24:27], v[240:247], v10
    v_smfmac_f32_16x16x64_bf16 v[40:43], v[24:27], v[248:255], v10
    s_nop 7
    v_permlane32_swap_b32 v36, v40
    v_permlane32_swap_b32 v37, v41
    v_permlane32_swap_b32 v38, v42
    v_permlane32_swap_b32 v39, v43
    v_add_f32 v36, v36, v40
    v_add_f32 v37, v37, v41
    v_add_f32 v38, v38, v42
    v_add_f32 v39, v39, v43
    v_cvt_pk_bf16_f32 v44, v36, v37
    v_cvt_pk_bf16_f32 v45, v38, v39
    ds_write_b64 v9, v[44:45]
    s_waitcnt lgkmcnt(0)
    s_barrier
    v_mov_b32 v36, 0
    v_mov_b32 v37, 0
    v_mov_b32 v38, 0
    v_mov_b32 v39, 0
    v_add_u32 v12, 81920, v4
    ds_read_b64_tr_b16 v[20:21], v7 offset:0
    ds_read_b64_tr_b16 v[22:23], v7 offset:64
    ds_read_b128 v[48:51], v12 offset:0
    ds_read_b128 v[52:55], v12 offset:1024
    ds_read_b64_tr_b16 v[24:25], v7 offset:1152
    ds_read_b64_tr_b16 v[26:27], v7 offset:1216
    ds_read_b128 v[56:59], v12 offset:4096
    ds_read_b128 v[60:63], v12 offset:5120
    ds_read_b64_tr_b16 v[28:29], v7 offset:2304
    ds_read_b64_tr_b16 v[30:31], v7 offset:2368
    ds_read_b128 v[64:67], v12 offset:8192
    ds_read_b128 v[68:71], v12 offset:9216
    ds_read_b64_tr_b16 v[32:33], v7 offset:3456
    ds_read_b64_tr_b16 v[34:35], v7 offset:3520
    ds_read_b128 v[72:75], v12 offset:12288
    ds_read_b128 v[76:79], v12 offset:13312
    s_waitcnt lgkmcnt(12)
    v_smfmac_f32_16x16x64_bf16 v[36:39], v[20:23], v[48:55], v10
    ds_read_b64_tr_b16 v[20:21], v7 offset:4608
    ds_read_b64_tr_b16 v[22:23], v7 offset:4672
    ds_read_b128 v[48:51], v12 offset:16384
    ds_read_b128 v[52:55], v12 offset:17408
    s_waitcnt lgkmcnt(12)
    v_smfmac_f32_16x16x64_bf16 v[36:39], v[24:27], v[56:63], v10
    ds_read_b64_tr_b16 v[24:25], v7 offset:5760
    ds_read_b64_tr_b16 v[26:27], v7 offset:5824
    ds_read_b128 v[56:59], v12 offset:20480
    ds_read_b128 v[60:63], v12 offset:21504
    s_waitcnt lgkmcnt(12)
    v_smfmac_f32_16x16x64_bf16 v[36:39], v[28:31], v[64:71], v10
    ds_read_b64_tr_b16 v[28:29], v7 offset:6912
    ds_read_b64_tr_b16 v[30:31], v7 offset:6976
    ds_read_b128 v[64:67], v12 offset:24576
    ds_read_b128 v[68:71], v12 offset:25600
    s_waitcnt lgkmcnt(12)
    v_smfmac_f32_16x16x64_bf16 v[36:39], v[32:35], v[72:79], v10
    ds_read_b64_tr_b16 v[32:33], v7 offset:8064
    ds_read_b64_tr_b16 v[34:35], v7 offset:8128
    ds_read_b128 v[72:75], v12 offset:28672
    ds_read_b128 v[76:79], v12 offset:29696
    s_waitcnt lgkmcnt(12)
    v_smfmac_f32_16x16x64_bf16 v[36:39], v[20:23], v[48:55], v10
    ds_read_b64_tr_b16 v[20:21], v7 offset:9216
    ds_read_b64_tr_b16 v[22:23], v7 offset:9280
    ds_read_b128 v[48:51], v12 offset:32768
    ds_read_b128 v[52:55], v12 offset:33792
    s_waitcnt lgkmcnt(12)
    v_smfmac_f32_16x16x64_bf16 v[36:39], v[24:27], v[56:63], v10
    ds_read_b64_tr_b16 v[24:25], v7 offset:10368
    ds_read_b64_tr_b16 v[26:27], v7 offset:10432
    ds_read_b128 v[56:59], v12 offset:36864
    ds_read_b128 v[60:63], v12 offset:37888
    s_waitcnt lgkmcnt(12)
    v_smfmac_f32_16x16x64_bf16 v[36:39], v[28:31], v[64:71], v10
    s_waitcnt lgkmcnt(8)
    v_smfmac_f32_16x16x64_bf16 v[36:39], v[32:35], v[72:79], v10
    s_waitcnt lgkmcnt(4)
    v_smfmac_f32_16x16x64_bf16 v[36:39], v[20:23], v[48:55], v10
    s_waitcnt lgkmcnt(0)
    v_smfmac_f32_16x16x64_bf16 v[36:39], v[24:27], v[56:63], v10
    s_nop 7
    v_mov_b32 v80, v36
    v_mov_b32 v81, v37
    v_mov_b32 v82, v38
    v_mov_b32 v83, v39
    s_nop 1
    v_permlane32_swap_b32 v80, v36
    v_permlane32_swap_b32 v81, v37
    v_permlane32_swap_b32 v82, v38
    v_permlane32_swap_b32 v83, v39
    v_add_f32 v80, v80, v36
    v_add_f32 v81, v81, v37
    v_add_f32 v82, v82, v38
    v_add_f32 v83, v83, v39
    v_cvt_pk_bf16_f32 v84, v80, v81
    v_cvt_pk_bf16_f32 v85, v82, v83
    s_nop 1
    v_mov_b32_dpp v84, v6 quad_perm:[0,1,2,3] row_mask:0x3 bank_mask:0xf
    v_mov_b32_dpp v85, v6 quad_perm:[0,1,2,3] row_mask:0x3 bank_mask:0xf
    ds_write_b64 v4, v[84:85] offset:1024
    s_waitcnt lgkmcnt(0)
    s_mov_b64 exec, 1
    ds_add_u32 v6, v16 offset:36
    s_mov_b64 exec, -1
    s_cmp_eq_u32 s29, 63
    s_cbranch_scc1 L6_last
    s_and_b32 s38, s29, 3
    s_add_u32 s39, s29, 2
    s_and_b32 s39, s39, 3
    s_lshl_b32 s32, s38, 16
    s_add_u32 s32, s32, s52
    s_lshl_b32 s36, s39, 16
    s_add_u32 s36, s36, s52
    s_add_u32 s38, s29, 1
    s_and_b32 s38, s38, 3
    s_mul_i32 s30, s38, 40960
    s_add_u32 s30, s30, s50
    s_add_u32 s39, s29, 3
    s_and_b32 s39, s39, 3
    s_mul_i32 s34, s39, 40960
    s_add_u32 s34, s34, s50
    s_cmp_lg_u32 s29, 0
    s_cbranch_scc1 Lpf_37
    s_mov_b32 s39, 125829120
Lpr_38:
    buffer_load_dwordx4 v[80:83], v4, s[8:11], s39 offen sc1
    s_waitcnt vmcnt(0)
    v_min_u32 v80, v80, v82
    v_min_u32 v81, v81, v83
    v_min_u32 v11, v80, v81
    v_cmp_eq_u32 vcc, 0, v11
    s_cbranch_vccz Lprd_39
    s_sleep 8
    s_branch Lpr_38
Lprd_39:
    s_nop 1
    v_min_u32_dpp v80, v80, v80 quad_perm:[1,0,3,2] row_mask:0xf bank_mask:0xf
    v_min_u32_dpp v81, v81, v81 quad_perm:[1,0,3,2] row_mask:0xf bank_mask:0xf
    s_nop 1
    v_min_u32_dpp v80, v80, v80 quad_perm:[2,3,0,1] row_mask:0xf bank_mask:0xf
    v_min_u32_dpp v81, v81, v81 quad_perm:[2,3,0,1] row_mask:0xf bank_mask:0xf
    v_cmp_lt_u32 s[18:19], v81, v80
Lpf_37:
    s_and_b32 s38, s29, 0x3c
    s_lshr_b64 s[38:39], s[18:19], s38
    s_bfe_u32 s39, s38, 0x10004
    s_and_b32 s38, s38, 1
    s_lshl_b32 s38, s38, 13
    s_lshl_b32 s39, s39, 13
    s_lshl_b32 s33, s29, 19
    s_add_u32 s33, s33, 134217728
    s_add_u32 s22, s33, s39
    s_add_u32 s22, s22, 2097152
    s_add_u32 s22, s22, s43
    s_add_u32 s33, s33, s38
    s_add_u32 s37, s33, s43
    s_add_u32 s33, s33, s42
    v_mov_b32 v36, 0
    v_mov_b32 v37, 0
    v_mov_b32 v38, 0
    v_mov_b32 v39, 0
    v_mov_b32 v40, 0
    v_mov_b32 v41, 0
    v_mov_b32 v42, 0
    v_mov_b32 v43, 0
    s_mov_b64 exec, s[56:57]
    s_barrier
    s_barrier
    ds_read_b128 v[48:51], v8 offset:0
    ds_read_b128 v[52:55], v8 offset:512
    ds_read_b128 v[56:59], v8 offset:3072
    ds_read_b128 v[60:63], v8 offset:3584
    ds_read_b128 v[64:67], v8 offset:6144
    ds_read_b128 v[68:71], v8 offset:6656
    ds_read_b128 v[72:75], v8 offset:9216
    ds_read_b128 v[76:79], v8 offset:9728
    s_waitcnt lgkmcnt(6)
    v_add_f32 v48, v48, v52
    v_add_f32 v49, v49, v53
    v_add_f32 v50, v50, v54
    v_add_f32 v51, v51, v55
    s_waitcnt lgkmcnt(4)
    v_add_f32 v56, v56, v60
    v_add_f32 v57, v57, v61
    v_add_f32 v58, v58, v62
    v_add_f32 v59, v59, v63
    v_add_f32 v48, v48, v56
    v_add_f32 v49, v49, v57
    v_add_f32 v50, v50, v58
    v_add_f32 v51, v51, v59
    s_waitcnt lgkmcnt(2)
    v_add_f32 v64, v64, v68
    v_add_f32 v65, v65, v69
    v_add_f32 v66, v66, v70
    v_add_f32 v67, v67, v71
    s_waitcnt lgkmcnt(0)
    v_add_f32 v72, v72, v76
    v_add_f32 v73, v73, v77
    v_add_f32 v74, v74, v78
    v_add_f32 v75, v75, v79
    v_add_f32 v64, v64, v72
    v_add_f32 v65, v65, v73
    v_add_f32 v66, v66, v74
    v_add_f32 v67, v67, v75
    v_add_f32 v48, v48, v64
    v_add_f32 v49, v49, v65
    v_add_f32 v50, v50, v66
    v_add_f32 v51, v51, v67
    buffer_store_dwordx4 v[48:51], v15, s[8:11], s37 offen sc1
    s_add_u32 s29, s29, 1
    s_add_u32 s44, s44, 131072
    s_add_u32 s45, s45, 131072
    s_add_u32 s55, s55, 2048
    s_add_u32 s48, s48, 10240
    s_cmp_eq_u32 s48, 61440
    s_cselect_b32 s48, 30720, s48
    s_mov_b64 exec, s[56:57]
    s_sleep 10
    buffer_store_dwordx4 v[92:95], v15, s[8:11], s22 offen sc1
    s_mov_b64 exec, -1
    s_barrier
    s_branch L6f_w4l
L6f_w5:
    v_mov_b32 v92, -1
    v_mov_b32 v93, -1
    v_mov_b32 v94, -1
    v_mov_b32 v95, -1
L6f_w5l:
    v_mov_b32 v36, 0
    v_mov_b32 v37, 0
    v_mov_b32 v38, 0
    v_mov_b32 v39, 0
    v_mov_b32 v40, 0
    v_mov_b32 v41, 0
    v_mov_b32 v42, 0
    v_mov_b32 v43, 0
    s_waitcnt lgkmcnt(0)
    s_barrier
    ds_read_b64_tr_b16 v[20:21], v7 offset:0
    ds_read_b64_tr_b16 v[22:23], v7 offset:64
    ds_read_b64_tr_b16 v[24:25], v7 offset:1152
    ds_read_b64_tr_b16 v[26:27], v7 offset:1216
    ds_read_b64_tr_b16 v[28:29], v7 offset:2304
    ds_read_b64_tr_b16 v[30:31], v7 offset:2368
    ds_read_b64_tr_b16 v[32:33], v7 offset:3456
    ds_read_b64_tr_b16 v[34:35], v7 offset:3520
    s_waitcnt lgkmcnt(6)
    v_smfmac_f32_16x16x64_bf16 v[36:39], v[20:23], v[96:103], v10
    v_smfmac_f32_16x16x64_bf16 v[40:43], v[20:23], v[104:111], v10
    ds_read_b64_tr_b16 v[20:21], v7 offset:4608
    ds_read_b64_tr_b16 v[22:23], v7 offset:4672
    s_waitcnt lgkmcnt(6)
    v_smfmac_f32_16x16x64_bf16 v[36:39], v[24:27], v[112:119], v10
    v_smfmac_f32_16x16x64_bf16 v[40:43], v[24:27], v[120:127], v10
    ds_read_b64_tr_b16 v[24:25], v7 offset:5760
    ds_read_b64_tr_b16 v[26:27], v7 offset:5824
    s_waitcnt lgkmcnt(6)
    v_smfmac_f32_16x16x64_bf16 v[36:39], v[28:31], v[128:135], v10
    v_smfmac_f32_16x16x64_bf16 v[40:43], v[28:31], v[136:143], v10
    ds_read_b64_tr_b16 v[28:29], v7 offset:6912
    ds_read_b64_tr_b16 v[30:31], v7 offset:6976
    s_waitcnt lgkmcnt(6)
    v_smfmac_f32_16x16x64_bf16 v[36:39], v[32:35], v[144:151], v10
    v_smfmac_f32_16x16x64_bf16 v[40:43], v[32:35], v[152:159], v10
    ds_read_b64_tr_b16 v[32:33], v7 offset:8064
    ds_read_b64_tr_b16 v[34:35], v7 offset:8128
    s_waitcnt lgkmcnt(6)
    v_smfmac_f32_16x16x64_bf16 v[36:39], v[20:23], v[160:167], v10
    v_smfmac_f32_16x16x64_bf16 v[40:43], v[20:23], v[168:175], v10
    ds_read_b64_tr_b16 v[20:21], v7 offset:9216
    ds_read_b64_tr_b16 v[22:23], v7 offset:9280
    s_waitcnt lgkmcnt(6)
    v_smfmac_f32_16x16x64_bf16 v[36:39], v[24:27], v[176:183], v10
    v_smfmac_f32_16x16x64_bf16 v[40:43], v[24:27], v[184:191], v10
    ds_read_b64_tr_b16 v[24:25], v7 offset:10368
    ds_read_b64_tr_b16 v[26:27], v7 offset:10432
    s_waitcnt lgkmcnt(6)
    v_smfmac_f32_16x16x64_bf16 v[36:39], v[28:31], v[192:199], v10
    v_smfmac_f32_16x16x64_bf16 v[40:43], v[28:31], v[200:207], v10
    s_waitcnt lgkmcnt(4)
    v_smfmac_f32_16x16x64_bf16 v[36:39], v[32:35], v[208:215], v10
    v_smfmac_f32_16x16x64_bf16 v[40:43], v[32:35], v[216:223], v10
    s_waitcnt lgkmcnt(2)
    v_smfmac_f32_16x16x64_bf16 v[36:39], v[20:23], v[224:231], v10
    v_smfmac_f32_16x16x64_bf16 v[40:43], v[20:23], v[232:239], v10
    s_waitcnt lgkmcnt(0)
    v_smfmac_f32_16x16x64_bf16 v[36:39], v[24:27], v[240:247], v10
    v_smfmac_f32_16x16x64_bf16 v[40:43], v[24:27], v[248:255], v10
    s_nop 7
    v_permlane32_swap_b32 v36, v40
    v_permlane32_swap_b32 v37, v41
    v_permlane32_swap_b32 v38, v42
    v_permlane32_swap_b32 v39, v43
    v_add_f32 v36, v36, v40
    v_add_f32 v37, v37, v41
    v_add_f32 v38, v38, v42
    v_add_f32 v39, v39, v43
    v_cvt_pk_bf16_f32 v44, v36, v37
    v_cvt_pk_bf16_f32 v45, v38, v39
    ds_write_b64 v9, v[44:45]
    s_waitcnt lgkmcnt(0)
    s_barrier
    v_mov_b32 v36, 0
    v_mov_b32 v37, 0
    v_mov_b32 v38, 0
    v_mov_b32 v39, 0
    v_add_u32 v12, 83968, v4
    ds_read_b64_tr_b16 v[20:21], v7 offset:0
    ds_read_b64_tr_b16 v[22:23], v7 offset:64
    ds_read_b128 v[48:51], v12 offset:0
    ds_read_b128 v[52:55], v12 offset:1024
    ds_read_b64_tr_b16 v[24:25], v7 offset:1152
    ds_read_b64_tr_b16 v[26:27], v7 offset:1216
    ds_read_b128 v[56:59], v12 offset:4096
    ds_read_b128 v[60:63], v12 offset:5120
    ds_read_b64_tr_b16 v[28:29], v7 offset:2304
    ds_read_b64_tr_b16 v[30:31], v7 offset:2368
    ds_read_b128 v[64:67], v12 offset:8192
    ds_read_b128 v[68:71], v12 offset:9216
    ds_read_b64_tr_b16 v[32:33], v7 offset:3456
    ds_read_b64_tr_b16 v[34:35], v7 offset:3520
    ds_read_b128 v[72:75], v12 offset:12288
    ds_read_b128 v[76:79], v12 offset:13312
    s_waitcnt lgkmcnt(12)
    v_smfmac_f32_16x16x64_bf16 v[36:39], v[20:23], v[48:55], v10
    ds_read_b64_tr_b16 v[20:21], v7 offset:4608
    ds_read_b64_tr_b16 v[22:23], v7 offset:4672
    ds_read_b128 v[48:51], v12 offset:16384
    ds_read_b128 v[52:55], v12 offset:17408
    s_waitcnt lgkmcnt(12)
    v_smfmac_f32_16x16x64_bf16 v[36:39], v[24:27], v[56:63], v10
    ds_read_b64_tr_b16 v[24:25], v7 offset:5760
    ds_read_b64_tr_b16 v[26:27], v7 offset:5824
    ds_read_b128 v[56:59], v12 offset:20480
    ds_read_b128 v[60:63], v12 offset:21504
    s_waitcnt lgkmcnt(12)
    v_smfmac_f32_16x16x64_bf16 v[36:39], v[28:31], v[64:71], v10
    ds_read_b64_tr_b16 v[28:29], v7 offset:6912
    ds_read_b64_tr_b16 v[30:31], v7 offset:6976
    ds_read_b128 v[64:67], v12 offset:24576
    ds_read_b128 v[68:71], v12 offset:25600
    s_waitcnt lgkmcnt(12)
    v_smfmac_f32_16x16x64_bf16 v[36:39], v[32:35], v[72:79], v10
    ds_read_b64_tr_b16 v[32:33], v7 offset:8064
    ds_read_b64_tr_b16 v[34:35], v7 offset:8128
    ds_read_b128 v[72:75], v12 offset:28672
    ds_read_b128 v[76:79], v12 offset:29696
    s_waitcnt lgkmcnt(12)
    v_smfmac_f32_16x16x64_bf16 v[36:39], v[20:23], v[48:55], v10
    ds_read_b64_tr_b16 v[20:21], v7 offset:9216
    ds_read_b64_tr_b16 v[22:23], v7 offset:9280
    ds_read_b128 v[48:51], v12 offset:32768
    ds_read_b128 v[52:55], v12 offset:33792
    s_waitcnt lgkmcnt(12)
    v_smfmac_f32_16x16x64_bf16 v[36:39], v[24:27], v[56:63], v10
    ds_read_b64_tr_b16 v[24:25], v7 offset:10368
    ds_read_b64_tr_b16 v[26:27], v7 offset:10432
    ds_read_b128 v[56:59], v12 offset:36864
    ds_read_b128 v[60:63], v12 offset:37888
    s_waitcnt lgkmcnt(12)
    v_smfmac_f32_16x16x64_bf16 v[36:39], v[28:31], v[64:71], v10
    s_waitcnt lgkmcnt(8)
    v_smfmac_f32_16x16x64_bf16 v[36:39], v[32:35], v[72:79], v10
    s_waitcnt lgkmcnt(4)
    v_smfmac_f32_16x16x64_bf16 v[36:39], v[20:23], v[48:55], v10
    s_waitcnt lgkmcnt(0)
    v_smfmac_f32_16x16x64_bf16 v[36:39], v[24:27], v[56:63], v10
    s_nop 7
    v_mov_b32 v80, v36
    v_mov_b32 v81, v37
    v_mov_b32 v82, v38
    v_mov_b32 v83, v39
    s_nop 1
    v_permlane32_swap_b32 v80, v36
    v_permlane32_swap_b32 v81, v37
    v_permlane32_swap_b32 v82, v38
    v_permlane32_swap_b32 v83, v39
    v_add_f32 v80, v80, v36
    v_add_f32 v81, v81, v37
    v_add_f32 v82, v82, v38
    v_add_f32 v83, v83, v39
    v_cvt_pk_bf16_f32 v84, v80, v81
    v_cvt_pk_bf16_f32 v85, v82, v83
    s_nop 1
    v_mov_b32_dpp v84, v6 quad_perm:[0,1,2,3] row_mask:0x3 bank_mask:0xf
    v_mov_b32_dpp v85, v6 quad_perm:[0,1,2,3] row_mask:0x3 bank_mask:0xf
    ds_write_b64 v4, v[84:85] offset:1032
    s_waitcnt lgkmcnt(0)
    s_mov_b64 exec, 1
    ds_add_u32 v6, v16 offset:36
    s_mov_b64 exec, -1
    s_cmp_eq_u32 s29, 63
    s_cbranch_scc1 L6_last
    s_cmp_lg_u32 s29, 0
    s_cbranch_scc1 Lpf_40
    s_mov_b32 s39, 125829120
Lpr_41:
    buffer_load_dwordx4 v[80:83], v4, s[8:11], s39 offen sc1
    s_waitcnt vmcnt(0)
    v_min_u32 v80, v80, v82
    v_min_u32 v81, v81, v83
    v_min_u32 v11, v80, v81
    v_cmp_eq_u32 vcc, 0, v11
    s_cbranch_vccz Lprd_42
    s_sleep 8
    s_branch Lpr_41
Lprd_42:
    s_nop 1
    v_min_u32_dpp v80, v80, v80 quad_perm:[1,0,3,2] row_mask:0xf bank_mask:0xf
    v_min_u32_dpp v81, v81, v81 quad_perm:[1,0,3,2] row_mask:0xf bank_mask:0xf
    s_nop 1
    v_min_u32_dpp v80, v80, v80 quad_perm:[2,3,0,1] row_mask:0xf bank_mask:0xf
    v_min_u32_dpp v81, v81, v81 quad_perm:[2,3,0,1] row_mask:0xf bank_mask:0xf
    v_cmp_lt_u32 s[18:19], v81, v80
Lpf_40:
    s_and_b32 s38, s29, 0x3c
    s_lshr_b64 s[38:39], s[18:19], s38
    s_bfe_u32 s39, s38, 0x10004
    s_and_b32 s38, s38, 1
    s_lshl_b32 s38, s38, 13
    s_lshl_b32 s39, s39, 13
    s_lshl_b32 s33, s29, 19
    s_add_u32 s33, s33, 134217728
    s_add_u32 s22, s33, s39
    s_add_u32 s22, s22, 2097152
    s_add_u32 s22, s22, s43
    s_add_u32 s33, s33, s38
    s_add_u32 s37, s33, s43
    s_add_u32 s33, s33, s42
    s_waitcnt vmcnt(0) lgkmcnt(0)
    s_mov_b64 exec, s[56:57]
    s_barrier
    s_barrier
    ds_read_b128 v[48:51], v8 offset:0
    ds_read_b128 v[52:55], v8 offset:512
    ds_read_b128 v[56:59], v8 offset:3072
    ds_read_b128 v[60:63], v8 offset:3584
    ds_read_b128 v[64:67], v8 offset:6144
    ds_read_b128 v[68:71], v8 offset:6656
    ds_read_b128 v[72:75], v8 offset:9216
    ds_read_b128 v[76:79], v8 offset:9728
    s_waitcnt lgkmcnt(6)
    v_add_f32 v48, v48, v52
    v_add_f32 v49, v49, v53
    v_add_f32 v50, v50, v54
    v_add_f32 v51, v51, v55
    s_waitcnt lgkmcnt(4)
    v_add_f32 v56, v56, v60
    v_add_f32 v57, v57, v61
    v_add_f32 v58, v58, v62
    v_add_f32 v59, v59, v63
    v_add_f32 v48, v48, v56
    v_add_f32 v49, v49, v57
    v_add_f32 v50, v50, v58
    v_add_f32 v51, v51, v59
    s_waitcnt lgkmcnt(2)
    v_add_f32 v64, v64, v68
    v_add_f32 v65, v65, v69
    v_add_f32 v66, v66, v70
    v_add_f32 v67, v67, v71
    s_waitcnt lgkmcnt(0)
    v_add_f32 v72, v72, v76
    v_add_f32 v73, v73, v77
    v_add_f32 v74, v74, v78
    v_add_f32 v75, v75, v79
    v_add_f32 v64, v64, v72
    v_add_f32 v65, v65, v73
    v_add_f32 v66, v66, v74
    v_add_f32 v67, v67, v75
    v_add_f32 v48, v48, v64
    v_add_f32 v49, v49, v65
    v_add_f32 v50, v50, v66
    v_add_f32 v51, v51, v67
    buffer_store_dwordx4 v[48:51], v15, s[8:11], s37 offen sc1
    s_mov_b64 exec, -1
    s_cmp_ge_u32 s29, 61
    s_cbranch_scc1 L6f_w5d
    s_add_u32 m0, s54, 0
    s_add_u32 s38, s46, 0
    buffer_load_dwordx4 v4, s[8:11], s38 offen lds
    s_add_u32 m0, s54, 1024
    s_add_u32 s38, s46, 1024
    buffer_load_dwordx4 v4, s[8:11], s38 offen lds
    s_add_u32 m0, s54, 2048
    s_add_u32 s38, s46, 2048
    buffer_load_dwordx4 v4, s[8:11], s38 offen lds
    s_add_u32 m0, s54, 3072
    s_add_u32 s38, s46, 3072
    buffer_load_dwordx4 v4, s[8:11], s38 offen lds
    s_add_u32 m0, s54, 4096
    s_add_u32 s38, s46, 4096
    buffer_load_dwordx4 v4, s[8:11], s38 offen lds
    s_add_u32 m0, s54, 5120
    s_add_u32 s38, s46, 5120
    buffer_load_dwordx4 v4, s[8:11], s38 offen lds
    s_add_u32 m0, s54, 6144
    s_add_u32 s38, s46, 6144
    buffer_load_dwordx4 v4, s[8:11], s38 offen lds
    s_add_u32 m0, s54, 7168
    s_add_u32 s38, s46, 7168
    buffer_load_dwordx4 v4, s[8:11], s38 offen lds
    s_add_u32 m0, s54, 8192
    s_add_u32 s38, s47, 0
    buffer_load_dwordx4 v4, s[8:11], s38 offen lds
    s_add_u32 m0, s54, 9216
    s_add_u32 s38, s47, 1024
    buffer_load_dwordx4 v4, s[8:11], s38 offen lds
    s_add_u32 s46, s46, 262144
    s_add_u32 s47, s47, 262144
    s_add_u32 s54, s54, 10240
    s_cmp_eq_u32 s54, 61440
    s_cselect_b32 s54, 30720, s54
L6f_w5d:
    s_add_u32 s29, s29, 1
    s_add_u32 s44, s44, 131072
    s_add_u32 s45, s45, 131072
    s_add_u32 s55, s55, 2048
    s_add_u32 s48, s48, 10240
    s_cmp_eq_u32 s48, 61440
    s_cselect_b32 s48, 30720, s48
    s_mov_b64 exec, s[56:57]
    s_sleep 7
    buffer_store_dwordx4 v[92:95], v15, s[8:11], s22 offen sc1
    s_mov_b64 exec, -1
    s_barrier
    s_branch L6f_w5l
L6f_w6:
L6f_w6l:
    v_mov_b32 v36, 0
    v_mov_b32 v37, 0
    v_mov_b32 v38, 0
    v_mov_b32 v39, 0
    v_mov_b32 v40, 0
    v_mov_b32 v41, 0
    v_mov_b32 v42, 0
    v_mov_b32 v43, 0
    s_barrier
    ds_read_b64_tr_b16 v[20:21], v7 offset:0
    ds_read_b64_tr_b16 v[22:23], v7 offset:64
    ds_read_b64_tr_b16 v[24:25], v7 offset:1152
    ds_read_b64_tr_b16 v[26:27], v7 offset:1216
    ds_read_b64_tr_b16 v[28:29], v7 offset:2304
    ds_read_b64_tr_b16 v[30:31], v7 offset:2368
    ds_read_b64_tr_b16 v[32:33], v7 offset:3456
    ds_read_b64_tr_b16 v[34:35], v7 offset:3520
    s_waitcnt lgkmcnt(6)
    v_smfmac_f32_16x16x64_bf16 v[36:39], v[20:23], v[96:103], v10
    v_smfmac_f32_16x16x64_bf16 v[40:43], v[20:23], v[104:111], v10
    ds_read_b64_tr_b16 v[20:21], v7 offset:4608
    ds_read_b64_tr_b16 v[22:23], v7 offset:4672
    s_waitcnt lgkmcnt(6)
    v_smfmac_f32_16x16x64_bf16 v[36:39], v[24:27], v[112:119], v10
    v_smfmac_f32_16x16x64_bf16 v[40:43], v[24:27], v[120:127], v10
    ds_read_b64_tr_b16 v[24:25], v7 offset:5760
    ds_read_b64_tr_b16 v[26:27], v7 offset:5824
    s_waitcnt lgkmcnt(6)
    v_smfmac_f32_16x16x64_bf16 v[36:39], v[28:31], v[128:135], v10
    v_smfmac_f32_16x16x64_bf16 v[40:43], v[28:31], v[136:143], v10
    ds_read_b64_tr_b16 v[28:29], v7 offset:6912
    ds_read_b64_tr_b16 v[30:31], v7 offset:6976
    s_waitcnt lgkmcnt(6)
    v_smfmac_f32_16x16x64_bf16 v[36:39], v[32:35], v[144:151], v10
    v_smfmac_f32_16x16x64_bf16 v[40:43], v[32:35], v[152:159], v10
    ds_read_b64_tr_b16 v[32:33], v7 offset:8064
    ds_read_b64_tr_b16 v[34:35], v7 offset:8128
    s_waitcnt lgkmcnt(6)
    v_smfmac_f32_16x16x64_bf16 v[36:39], v[20:23], v[160:167], v10
    v_smfmac_f32_16x16x64_bf16 v[40:43], v[20:23], v[168:175], v10
    ds_read_b64_tr_b16 v[20:21], v7 offset:9216
    ds_read_b64_tr_b16 v[22:23], v7 offset:9280
    s_waitcnt lgkmcnt(6)
    v_smfmac_f32_16x16x64_bf16 v[36:39], v[24:27], v[176:183], v10
    v_smfmac_f32_16x16x64_bf16 v[40:43], v[24:27], v[184:191], v10
    ds_read_b64_tr_b16 v[24:25], v7 offset:10368
    ds_read_b64_tr_b16 v[26:27], v7 offset:10432
    s_waitcnt lgkmcnt(6)
    v_smfmac_f32_16x16x64_bf16 v[36:39], v[28:31], v[192:199], v10
    v_smfmac_f32_16x16x64_bf16 v[40:43], v[28:31], v[200:207], v10
    s_waitcnt lgkmcnt(4)
    v_smfmac_f32_16x16x64_bf16 v[36:39], v[32:35], v[208:215], v10
    v_smfmac_f32_16x16x64_bf16 v[40:43], v[32:35], v[216:223], v10
    s_waitcnt lgkmcnt(2)
    v_smfmac_f32_16x16x64_bf16 v[36:39], v[20:23], v[224:231], v10
    v_smfmac_f32_16x16x64_bf16 v[40:43], v[20:23], v[232:239], v10
    s_waitcnt lgkmcnt(0)
    v_smfmac_f32_16x16x64_bf16 v[36:39], v[24:27], v[240:247], v10
    v_smfmac_f32_16x16x64_bf16 v[40:43], v[24:27], v[248:255], v10
    s_nop 7
    v_permlane32_swap_b32 v36, v40
    v_permlane32_swap_b32 v37, v41
    v_permlane32_swap_b32 v38, v42
    v_permlane32_swap_b32 v39, v43
    v_add_f32 v36, v36, v40
    v_add_f32 v37, v37, v41
    v_add_f32 v38, v38, v42
    v_add_f32 v39, v39, v43
    v_cvt_pk_bf16_f32 v44, v36, v37
    v_cvt_pk_bf16_f32 v45, v38, v39
    ds_write_b64 v9, v[44:45]
    s_waitcnt lgkmcnt(0)
    v_add_u32 v12, s48, v4
    ds_read_b128 v[48:51], v12 offset:0
    ds_read_b128 v[52:55], v12 offset:1024
    ds_read_b128 v[56:59], v12 offset:2048
    ds_read_b128 v[60:63], v12 offset:3072
    ds_read_b128 v[64:67], v12 offset:4096
    ds_read_b128 v[68:71], v12 offset:5120
    ds_read_b128 v[72:75], v12 offset:6144
    ds_read_b128 v[76:79], v12 offset:7168
    ds_read_b128 v[80:83], v12 offset:8192
    ds_read_b128 v[84:87], v12 offset:9216
    s_barrier
    ds_read_b64_tr_b16 v[20:21], v18 offset:0
    ds_read_b64_tr_b16 v[22:23], v18 offset:512
    ds_read_b64_tr_b16 v[24:25], v18 offset:1024
    ds_read_b64_tr_b16 v[26:27], v18 offset:1536
    ds_read_b64_tr_b16 v[28:29], v18 offset:2048
    ds_read_b64_tr_b16 v[30:31], v18 offset:2560
    ds_read_b64_tr_b16 v[32:33], v18 offset:3072
    ds_read_b64_tr_b16 v[34:35], v18 offset:3584
    s_cmp_eq_u32 s29, 63
    s_cbranch_scc1 L6f_w6last
    s_waitcnt lgkmcnt(6)
    v_mfma_f32_16x16x32_bf16 v[36:39], v[48:51], v[20:23], 0
    v_mfma_f32_16x16x32_bf16 v[40:43], v[64:67], v[20:23], 0
    s_waitcnt lgkmcnt(4)
    v_mfma_f32_16x16x32_bf16 v[36:39], v[52:55], v[24:27], v[36:39]
    v_mfma_f32_16x16x32_bf16 v[40:43], v[68:71], v[24:27], v[40:43]
    s_waitcnt lgkmcnt(2)
    v_mfma_f32_16x16x32_bf16 v[36:39], v[56:59], v[28:31], v[36:39]
    v_mfma_f32_16x16x32_bf16 v[40:43], v[72:75], v[28:31], v[40:43]
    s_waitcnt lgkmcnt(0)
    v_mfma_f32_16x16x32_bf16 v[36:39], v[60:63], v[32:35], v[36:39]
    v_mfma_f32_16x16x32_bf16 v[40:43], v[76:79], v[32:35], v[40:43]
    v_mfma_f32_16x16x32_bf16 v[44:47], v[20:23], v[20:23], 0
    s_and_b32 s38, s29, 3
    s_add_u32 s39, s29, 2
    s_and_b32 s39, s39, 3
    s_lshl_b32 s32, s38, 16
    s_add_u32 s32, s32, s52
    s_lshl_b32 s36, s39, 16
    s_add_u32 s36, s36, s52
    s_add_u32 s38, s29, 1
    s_and_b32 s38, s38, 3
    s_mul_i32 s30, s38, 40960
    s_add_u32 s30, s30, s50
    s_add_u32 s39, s29, 3
    s_and_b32 s39, s39, 3
    s_mul_i32 s34, s39, 40960
    s_add_u32 s34, s34, s50
    v_mfma_f32_16x16x32_bf16 v[44:47], v[24:27], v[24:27], v[44:47]
    v_mfma_f32_16x16x32_bf16 v[44:47], v[28:31], v[28:31], v[44:47]
    v_mfma_f32_16x16x32_bf16 v[44:47], v[32:35], v[32:35], v[44:47]
    s_lshl_b32 s53, s29, 1
    s_add_u32 s53, s53, 2
    v_mov_b32 v92, 0xf149f2ca
    v_max3_f32 v13, v36, v37, v38
    v_max3_f32 v11, v39, v40, v41
    v_max3_f32 v13, v13, v42, v43
    v_max_f32 v13, v13, v11
    s_nop 1
    v_mov_b32_dpp v44, v92 quad_perm:[0,1,2,3] row_mask:0x3 bank_mask:0xf
    v_mov_b32_dpp v45, v92 quad_perm:[0,1,2,3] row_mask:0x3 bank_mask:0xf
    v_mov_b32_dpp v46, v92 quad_perm:[0,1,2,3] row_mask:0x3 bank_mask:0xf
    v_mov_b32_dpp v47, v92 quad_perm:[0,1,2,3] row_mask:0x3 bank_mask:0xf
    v_max3_f32 v11, v44, v45, v46
    v_max3_f32 v13, v13, v11, v47
    v_mov_b32 v11, v13
    s_nop 1
    v_permlane32_swap_b32 v13, v11
    v_max_f32 v13, v13, v11
    v_mov_b32 v11, v13
    s_nop 1
    v_permlane16_swap_b32 v13, v11
    v_max_f32 v13, v13, v11
    v_mul_f32 v13, s41, v13
    v_fma_f32 v36, v36, s41, -v13
    v_fma_f32 v37, v37, s41, -v13
    v_fma_f32 v38, v38, s41, -v13
    v_fma_f32 v39, v39, s41, -v13
    v_fma_f32 v40, v40, s41, -v13
    v_fma_f32 v41, v41, s41, -v13
    v_fma_f32 v42, v42, s41, -v13
    v_fma_f32 v43, v43, s41, -v13
    v_exp_f32 v36, v36
    v_exp_f32 v37, v37
    v_exp_f32 v38, v38
    v_exp_f32 v39, v39
    v_exp_f32 v40, v40
    v_exp_f32 v41, v41
    v_exp_f32 v42, v42
    v_exp_f32 v43, v43
    v_fma_f32 v44, v44, s41, -v13
    v_fma_f32 v45, v45, s41, -v13
    v_fma_f32 v46, v46, s41, -v13
    v_fma_f32 v47, v47, s41, -v13
    ds_read_b32 v12, v6 offset:36
    ds_read_b128 v[88:91], v4 offset:1024
    v_cvt_pk_bf16_f32 v48, v36, v37
    v_cvt_pk_bf16_f32 v49, v38, v39
    v_cvt_pk_bf16_f32 v50, v40, v41
    v_cvt_pk_bf16_f32 v51, v42, v43
    v_mov_b32 v56, 0x3f803f80
    v_mov_b32 v57, 0x3f803f80
    v_mov_b32 v58, 0x3f803f80
    v_mov_b32 v59, 0x3f803f80
    v_exp_f32 v44, v44
    v_exp_f32 v45, v45
    v_mfma_f32_16x16x32_bf16 v[60:63], v[56:59], v[48:51], 0
    v_exp_f32 v46, v46
    v_exp_f32 v47, v47
    v_mfma_f32_16x16x32_bf16 v[64:67], v[80:83], v[48:51], 0
    v_cvt_pk_bf16_f32 v52, v44, v45
    v_cvt_pk_bf16_f32 v53, v46, v47
    v_mfma_f32_16x16x32_bf16 v[68:71], v[84:87], v[48:51], 0
    s_waitcnt lgkmcnt(0)
    v_readfirstlane_b32 s38, v12
    v_mfma_f32_16x16x16_bf16 v[60:63], v[56:57], v[52:53], v[60:63]
    s_cmp_ge_u32 s38, s53
    s_cbranch_scc0 L6f_vmw
L6f_vmok:
    v_mfma_f32_16x16x16_bf16 v[64:67], v[88:89], v[52:53], v[64:67]
    v_mfma_f32_16x16x16_bf16 v[68:71], v[90:91], v[52:53], v[68:71]
    s_nop 3
    v_rcp_f32 v11, v60
    s_mov_b32 exec_lo, 0x00ff00ff
    s_mov_b32 exec_hi, 0x00ff00ff
    s_nop 0
    v_mul_f32 v64, v64, v11
    v_mul_f32 v65, v65, v11
    v_mul_f32 v66, v66, v11
    v_mul_f32 v67, v67, v11
    v_mul_f32 v68, v68, v11
    v_mul_f32 v69, v69, v11
    v_mul_f32 v70, v70, v11
    v_mul_f32 v71, v71, v11
    v_cvt_pk_bf16_f32 v72, v64, v65
    v_cvt_pk_bf16_f32 v73, v66, v67
    v_cvt_pk_bf16_f32 v74, v68, v69
    v_cvt_pk_bf16_f32 v75, v70, v71
    buffer_store_dwordx4 v[72:75], v3, s[8:11], s32 offen
    s_barrier
    v_mov_b32 v76, -1
    v_mov_b32 v77, -1
    v_mov_b32 v78, -1
    v_mov_b32 v79, -1
    buffer_store_dwordx4 v[76:79], v3, s[8:11], s36 offen
    s_mov_b64 exec, -1
    s_waitcnt vmcnt(0)
    s_barrier
    s_sleep 13
    s_cmp_eq_u32 s29, 0
    s_cbranch_scc1 Lfl_43
    s_sub_u32 s38, s55, 2048
    s_mov_b64 exec, 1
    buffer_store_dword v16, v6, s[8:11], s38 offen sc1
    s_mov_b64 exec, -1
Lfl_43:
    s_cmp_lg_u32 s27, 0
    s_cbranch_scc1 Lkmn_44
    buffer_store_dwordx4 v[20:23], v4, s[8:11], s44 offen offset:0 sc1
Lkmn_44:
    s_cmp_lg_u32 s27, 1
    s_cbranch_scc1 Lkmn_45
    buffer_store_dwordx4 v[24:27], v4, s[8:11], s44 offen offset:1024 sc1
Lkmn_45:
    s_cmp_lg_u32 s27, 2
    s_cbranch_scc1 Lkmn_46
    buffer_store_dwordx4 v[28:31], v4, s[8:11], s44 offen offset:2048 sc1
Lkmn_46:
    s_cmp_lg_u32 s27, 3
    s_cbranch_scc1 Lkmn_47
    buffer_store_dwordx4 v[32:35], v4, s[8:11], s44 offen offset:3072 sc1
Lkmn_47:
    buffer_store_dwordx2 v[88:89], v14, s[8:11], s45 offen sc1
    buffer_store_dwordx2 v[90:91], v14, s[8:11], s45 offen offset:512 sc1
    s_add_u32 s29, s29, 1
    s_add_u32 s44, s44, 131072
    s_add_u32 s45, s45, 131072
    s_add_u32 s55, s55, 2048
    s_add_u32 s48, s48, 10240
    s_cmp_eq_u32 s48, 61440
    s_cselect_b32 s48, 30720, s48
    s_barrier
    s_branch L6f_w6l
L6f_vmw:
Lspin_48:
    ds_read_b32 v11, v6 offset:36
    s_waitcnt lgkmcnt(0)
    v_readfirstlane_b32 s38, v11
    s_nop 0
    s_cmp_ge_u32 s38, s53
    s_cbranch_scc0 Lspin_48
    ds_read_b128 v[88:91], v4 offset:1024
    s_waitcnt lgkmcnt(0)
    s_branch L6f_vmok
L6f_w6last:
    s_lshl_b32 s53, s29, 1
    s_add_u32 s53, s53, 2
Lspin_49:
    ds_read_b32 v11, v6 offset:36
    s_waitcnt lgkmcnt(0)
    v_readfirstlane_b32 s38, v11
    s_nop 0
    s_cmp_ge_u32 s38, s53
    s_cbranch_scc0 Lspin_49
    ds_read_b128 v[88:91], v4 offset:1024
    s_waitcnt lgkmcnt(0) vmcnt(0)
    s_cmp_eq_u32 s29, 0
    s_cbranch_scc1 Lfl_50
    s_sub_u32 s38, s55, 2048
    s_mov_b64 exec, 1
    buffer_store_dword v16, v6, s[8:11], s38 offen sc1
    s_mov_b64 exec, -1
Lfl_50:
    s_cmp_lg_u32 s27, 0
    s_cbranch_scc1 Lkmn_51
    buffer_store_dwordx4 v[20:23], v4, s[8:11], s44 offen offset:0 sc1
Lkmn_51:
    s_cmp_lg_u32 s27, 1
    s_cbranch_scc1 Lkmn_52
    buffer_store_dwordx4 v[24:27], v4, s[8:11], s44 offen offset:1024 sc1
Lkmn_52:
    s_cmp_lg_u32 s27, 2
    s_cbranch_scc1 Lkmn_53
    buffer_store_dwordx4 v[28:31], v4, s[8:11], s44 offen offset:2048 sc1
Lkmn_53:
    s_cmp_lg_u32 s27, 3
    s_cbranch_scc1 Lkmn_54
    buffer_store_dwordx4 v[32:35], v4, s[8:11], s44 offen offset:3072 sc1
Lkmn_54:
    buffer_store_dwordx2 v[88:89], v14, s[8:11], s45 offen sc1
    buffer_store_dwordx2 v[90:91], v14, s[8:11], s45 offen offset:512 sc1
    s_branch L6_last
L6f_w7:
    v_mov_b32 v92, -1
    v_mov_b32 v93, -1
L6f_w7l:
    v_mov_b32 v36, 0
    v_mov_b32 v37, 0
    v_mov_b32 v38, 0
    v_mov_b32 v39, 0
    v_mov_b32 v40, 0
    v_mov_b32 v41, 0
    v_mov_b32 v42, 0
    v_mov_b32 v43, 0
    s_waitcnt lgkmcnt(0)
    s_barrier
    ds_read_b64_tr_b16 v[20:21], v7 offset:0
    ds_read_b64_tr_b16 v[22:23], v7 offset:64
    ds_read_b64_tr_b16 v[24:25], v7 offset:1152
    ds_read_b64_tr_b16 v[26:27], v7 offset:1216
    ds_read_b64_tr_b16 v[28:29], v7 offset:2304
    ds_read_b64_tr_b16 v[30:31], v7 offset:2368
    ds_read_b64_tr_b16 v[32:33], v7 offset:3456
    ds_read_b64_tr_b16 v[34:35], v7 offset:3520
    s_waitcnt lgkmcnt(6)
    v_smfmac_f32_16x16x64_bf16 v[36:39], v[20:23], v[96:103], v10
    v_smfmac_f32_16x16x64_bf16 v[40:43], v[20:23], v[104:111], v10
    ds_read_b64_tr_b16 v[20:21], v7 offset:4608
    ds_read_b64_tr_b16 v[22:23], v7 offset:4672
    s_waitcnt lgkmcnt(6)
    v_smfmac_f32_16x16x64_bf16 v[36:39], v[24:27], v[112:119], v10
    v_smfmac_f32_16x16x64_bf16 v[40:43], v[24:27], v[120:127], v10
    ds_read_b64_tr_b16 v[24:25], v7 offset:5760
    ds_read_b64_tr_b16 v[26:27], v7 offset:5824
    s_waitcnt lgkmcnt(6)
    v_smfmac_f32_16x16x64_bf16 v[36:39], v[28:31], v[128:135], v10
    v_smfmac_f32_16x16x64_bf16 v[40:43], v[28:31], v[136:143], v10
    ds_read_b64_tr_b16 v[28:29], v7 offset:6912
    ds_read_b64_tr_b16 v[30:31], v7 offset:6976
    s_waitcnt lgkmcnt(6)
    v_smfmac_f32_16x16x64_bf16 v[36:39], v[32:35], v[144:151], v10
    v_smfmac_f32_16x16x64_bf16 v[40:43], v[32:35], v[152:159], v10
    ds_read_b64_tr_b16 v[32:33], v7 offset:8064
    ds_read_b64_tr_b16 v[34:35], v7 offset:8128
    s_waitcnt lgkmcnt(6)
    v_smfmac_f32_16x16x64_bf16 v[36:39], v[20:23], v[160:167], v10
    v_smfmac_f32_16x16x64_bf16 v[40:43], v[20:23], v[168:175], v10
    ds_read_b64_tr_b16 v[20:21], v7 offset:9216
    ds_read_b64_tr_b16 v[22:23], v7 offset:9280
    s_waitcnt lgkmcnt(6)
    v_smfmac_f32_16x16x64_bf16 v[36:39], v[24:27], v[176:183], v10
    v_smfmac_f32_16x16x64_bf16 v[40:43], v[24:27], v[184:191], v10
    ds_read_b64_tr_b16 v[24:25], v7 offset:10368
    ds_read_b64_tr_b16 v[26:27], v7 offset:10432
    s_waitcnt lgkmcnt(6)
    v_smfmac_f32_16x16x64_bf16 v[36:39], v[28:31], v[192:199], v10
    v_smfmac_f32_16x16x64_bf16 v[40:43], v[28:31], v[200:207], v10
    s_waitcnt lgkmcnt(4)
    v_smfmac_f32_16x16x64_bf16 v[36:39], v[32:35], v[208:215], v10
    v_smfmac_f32_16x16x64_bf16 v[40:43], v[32:35], v[216:223], v10
    s_waitcnt lgkmcnt(2)
    v_smfmac_f32_16x16x64_bf16 v[36:39], v[20:23], v[224:231], v10
    v_smfmac_f32_16x16x64_bf16 v[40:43], v[20:23], v[232:239], v10
    s_waitcnt lgkmcnt(0)
    v_smfmac_f32_16x16x64_bf16 v[36:39], v[24:27], v[240:247], v10
    v_smfmac_f32_16x16x64_bf16 v[40:43], v[24:27], v[248:255], v10
    s_nop 7
    v_permlane32_swap_b32 v36, v40
    v_permlane32_swap_b32 v37, v41
    v_permlane32_swap_b32 v38, v42
    v_permlane32_swap_b32 v39, v43
    v_add_f32 v36, v36, v40
    v_add_f32 v37, v37, v41
    v_add_f32 v38, v38, v42
    v_add_f32 v39, v39, v43
    v_cvt_pk_bf16_f32 v44, v36, v37
    v_cvt_pk_bf16_f32 v45, v38, v39
    ds_write_b64 v9, v[44:45]
    s_waitcnt lgkmcnt(0)
    s_barrier
    s_cmp_eq_u32 s29, 63
    s_cbranch_scc1 L6_last
    s_and_b32 s38, s29, 3
    s_add_u32 s39, s29, 2
    s_and_b32 s39, s39, 3
    s_lshl_b32 s32, s38, 16
    s_add_u32 s32, s32, s52
    s_lshl_b32 s36, s39, 16
    s_add_u32 s36, s36, s52
    s_add_u32 s38, s29, 1
    s_and_b32 s38, s38, 3
    s_mul_i32 s30, s38, 40960
    s_add_u32 s30, s30, s50
    s_add_u32 s39, s29, 3
    s_and_b32 s39, s39, 3
    s_mul_i32 s34, s39, 40960
    s_add_u32 s34, s34, s50
    s_cmp_lg_u32 s29, 0
    s_cbranch_scc1 Lpf_55
    s_mov_b32 s39, 125829120
Lpr_56:
    buffer_load_dwordx4 v[80:83], v4, s[8:11], s39 offen sc1
    s_waitcnt vmcnt(0)
    v_min_u32 v80, v80, v82
    v_min_u32 v81, v81, v83
    v_min_u32 v11, v80, v81
    v_cmp_eq_u32 vcc, 0, v11
    s_cbranch_vccz Lprd_57
    s_sleep 8
    s_branch Lpr_56
Lprd_57:
    s_nop 1
    v_min_u32_dpp v80, v80, v80 quad_perm:[1,0,3,2] row_mask:0xf bank_mask:0xf
    v_min_u32_dpp v81, v81, v81 quad_perm:[1,0,3,2] row_mask:0xf bank_mask:0xf
    s_nop 1
    v_min_u32_dpp v80, v80, v80 quad_perm:[2,3,0,1] row_mask:0xf bank_mask:0xf
    v_min_u32_dpp v81, v81, v81 quad_perm:[2,3,0,1] row_mask:0xf bank_mask:0xf
    v_cmp_lt_u32 s[18:19], v81, v80
Lpf_55:
    s_and_b32 s38, s29, 0x3c
    s_lshr_b64 s[38:39], s[18:19], s38
    s_bfe_u32 s39, s38, 0x10004
    s_and_b32 s38, s38, 1
    s_lshl_b32 s38, s38, 13
    s_lshl_b32 s39, s39, 13
    s_lshl_b32 s33, s29, 19
    s_add_u32 s33, s33, 134217728
    s_add_u32 s22, s33, s39
    s_add_u32 s22, s22, 2097152
    s_add_u32 s22, s22, s43
    s_add_u32 s33, s33, s38
    s_add_u32 s37, s33, s43
    s_add_u32 s33, s33, s42
    s_add_u32 s37, s33, 16384
    s_cmp_ge_u32 s29, 60
    s_cbranch_scc1 L6f_w7n
    s_mov_b32 s40, 0
Lkvw_58:
    s_waitcnt lgkmcnt(0)
    s_and_b32 s38, s64, s65
    s_and_b32 s39, s66, s67
    s_and_b32 s38, s38, s39
    s_add_u32 s40, s40, 1
    s_cmp_ge_u32 s38, 1
    s_cbranch_scc1 Lkvd_59
    s_sleep 4
    s_buffer_load_dwordx4 s[64:67], s[8:11], s58 glc
    s_cmp_lt_u32 s40, 200000
    s_cbranch_scc1 Lkvw_58
Lkvd_59:
    s_add_u32 s58, s58, 2048
    s_buffer_load_dwordx4 s[64:67], s[8:11], s58 glc
L6f_w7n:
    s_mov_b64 exec, s[56:57]
    s_barrier
    s_barrier
    s_sleep 12
    s_mov_b32 s40, 0
    buffer_load_dwordx4 v[48:51], v4, s[8:11], s33 offen offset:0 sc1
    buffer_load_dwordx4 v[52:55], v4, s[8:11], s33 offen offset:1280 sc1
    buffer_load_dwordx4 v[56:59], v4, s[8:11], s33 offen offset:2560 sc1
    buffer_load_dwordx4 v[60:63], v4, s[8:11], s33 offen offset:3840 sc1
    buffer_load_dwordx4 v[64:67], v4, s[8:11], s37 offen offset:0 sc1
    buffer_load_dwordx4 v[68:71], v4, s[8:11], s37 offen offset:1280 sc1
    buffer_load_dwordx4 v[72:75], v4, s[8:11], s37 offen offset:2560 sc1
    buffer_load_dwordx4 v[76:79], v4, s[8:11], s37 offen offset:3840 sc1
Lpchk_60:
    s_waitcnt vmcnt(0)
    v_max3_u32 v11, v48, v49, v50
    v_max_u32 v11, v11, v51
    v_cmp_eq_u32 s[84:85], -1, v11
    v_max3_u32 v13, v52, v53, v54
    v_max_u32 v13, v13, v55
    v_cmp_eq_u32 s[86:87], -1, v13
    v_max3_u32 v11, v56, v57, v58
    v_max_u32 v11, v11, v59
    v_cmp_eq_u32 s[88:89], -1, v11
    v_max3_u32 v13, v60, v61, v62
    v_max_u32 v13, v13, v63
    v_cmp_eq_u32 s[90:91], -1, v13
    v_max3_u32 v11, v64, v65, v66
    v_max_u32 v11, v11, v67
    v_cmp_eq_u32 s[92:93], -1, v11
    v_max3_u32 v13, v68, v69, v70
    v_max_u32 v13, v13, v71
    v_cmp_eq_u32 s[94:95], -1, v13
    v_max3_u32 v11, v72, v73, v74
    v_max_u32 v11, v11, v75
    v_cmp_eq_u32 s[96:97], -1, v11
    v_max3_u32 v13, v76, v77, v78
    v_max_u32 v13, v13, v79
    v_cmp_eq_u32 s[98:99], -1, v13
    s_or_b64 vcc, s[84:85], s[86:87]
    s_or_b64 vcc, vcc, s[88:89]
    s_or_b64 vcc, vcc, s[90:91]
    s_or_b64 vcc, vcc, s[92:93]
    s_or_b64 vcc, vcc, s[94:95]
    s_or_b64 vcc, vcc, s[96:97]
    s_or_b64 vcc, vcc, s[98:99]
    s_cbranch_scc0 Lpd_61
    s_mov_b64 exec, s[84:85]
    s_cbranch_execz Lpsk_62
    buffer_load_dwordx4 v[48:51], v4, s[8:11], s33 offen offset:0 sc1
Lpsk_62:
    s_mov_b64 exec, s[86:87]
    s_cbranch_execz Lpsk_63
    buffer_load_dwordx4 v[52:55], v4, s[8:11], s33 offen offset:1280 sc1
Lpsk_63:
    s_mov_b64 exec, s[88:89]
    s_cbranch_execz Lpsk_64
    buffer_load_dwordx4 v[56:59], v4, s[8:11], s33 offen offset:2560 sc1
Lpsk_64:
    s_mov_b64 exec, s[90:91]
    s_cbranch_execz Lpsk_65
    buffer_load_dwordx4 v[60:63], v4, s[8:11], s33 offen offset:3840 sc1
Lpsk_65:
    s_mov_b64 exec, s[92:93]
    s_cbranch_execz Lpsk_66
    buffer_load_dwordx4 v[64:67], v4, s[8:11], s37 offen offset:0 sc1
Lpsk_66:
    s_mov_b64 exec, s[94:95]
    s_cbranch_execz Lpsk_67
    buffer_load_dwordx4 v[68:71], v4, s[8:11], s37 offen offset:1280 sc1
Lpsk_67:
    s_mov_b64 exec, s[96:97]
    s_cbranch_execz Lpsk_68
    buffer_load_dwordx4 v[72:75], v4, s[8:11], s37 offen offset:2560 sc1
Lpsk_68:
    s_mov_b64 exec, s[98:99]
    s_cbranch_execz Lpsk_69
    buffer_load_dwordx4 v[76:79], v4, s[8:11], s37 offen offset:3840 sc1
Lpsk_69:
    s_mov_b64 exec, s[56:57]
    s_add_u32 s40, s40, 1
    s_cmp_lt_u32 s40, 200000
    s_cbranch_scc1 Lpchk_60
    s_waitcnt vmcnt(0)
Lpd_61:
    v_add_f32 v48, v48, v64
    v_add_f32 v49, v49, v65
    v_add_f32 v50, v50, v66
    v_add_f32 v51, v51, v67
    v_add_f32 v52, v52, v68
    v_add_f32 v53, v53, v69
    v_add_f32 v54, v54, v70
    v_add_f32 v55, v55, v71
    v_add_f32 v56, v56, v72
    v_add_f32 v57, v57, v73
    v_add_f32 v58, v58, v74
    v_add_f32 v59, v59, v75
    v_add_f32 v60, v60, v76
    v_add_f32 v61, v61, v77
    v_add_f32 v62, v62, v78
    v_add_f32 v63, v63, v79
    v_add_f32 v48, v48, v56
    v_add_f32 v49, v49, v57
    v_add_f32 v50, v50, v58
    v_add_f32 v51, v51, v59
    v_add_f32 v52, v52, v60
    v_add_f32 v53, v53, v61
    v_add_f32 v54, v54, v62
    v_add_f32 v55, v55, v63
    v_add_f32 v48, v48, v52
    v_add_f32 v49, v49, v53
    v_add_f32 v50, v50, v54
    v_add_f32 v51, v51, v55
    v_cvt_pk_bf16_f32 v80, v48, v49
    v_cvt_pk_bf16_f32 v81, v50, v51
    buffer_store_dwordx2 v[80:81], v19, s[8:11], s30 offen
    s_barrier
    buffer_store_dwordx2 v[92:93], v19, s[8:11], s34 offen
    s_mov_b64 exec, -1
    s_add_u32 s29, s29, 1
    s_add_u32 s44, s44, 131072
    s_add_u32 s45, s45, 131072
    s_add_u32 s55, s55, 2048
    s_add_u32 s48, s48, 10240
    s_cmp_eq_u32 s48, 61440
    s_cselect_b32 s48, 30720, s48
    s_branch L6f_w7l
L6_safe:
    s_cmp_eq_u32 s28, 4
    s_cbranch_scc1 L6s_w4
    s_cmp_eq_u32 s28, 5
    s_cbranch_scc1 L6s_w5
    s_cmp_eq_u32 s28, 6
    s_cbranch_scc1 L6s_w6
    s_cmp_eq_u32 s28, 7
    s_cbranch_scc1 L6s_w7
    s_lshl_b32 s38, s27, 11
    s_lshl_b32 s39, s28, 9
    s_add_u32 s20, s46, s38
    s_add_u32 s20, s20, s39
    s_add_u32 s20, s20, 786432
    s_add_u32 s21, s47, s39
    s_add_u32 s21, s21, 786432
    v_mov_b32 v36, 0
    v_mov_b32 v37, 0
    v_mov_b32 v38, 0
    v_mov_b32 v39, 0
    v_mov_b32 v40, 0
    v_mov_b32 v41, 0
    v_mov_b32 v42, 0
    v_mov_b32 v43, 0
    s_branch L6s_c_bm
L6s_c:
    s_sleep 3
    s_mov_b32 s40, 0
    buffer_load_dwordx4 v[20:23], v2, s[8:11], s30 offen offset:0 sc1
    buffer_load_dwordx4 v[24:27], v2, s[8:11], s30 offen offset:1024 sc1
Lpchk_70:
    s_waitcnt vmcnt(0)
    v_max3_u32 v11, v20, v21, v22
    v_max_u32 v11, v11, v23
    v_cmp_eq_u32 s[84:85], -1, v11
    v_max3_u32 v13, v24, v25, v26
    v_max_u32 v13, v13, v27
    v_cmp_eq_u32 s[86:87], -1, v13
    s_or_b64 vcc, s[84:85], s[86:87]
    s_cbranch_scc0 Lpd_71
    s_mov_b64 exec, s[84:85]
    s_cbranch_execz Lpsk_72
    buffer_load_dwordx4 v[20:23], v2, s[8:11], s30 offen offset:0 sc1
Lpsk_72:
    s_mov_b64 exec, s[86:87]
    s_cbranch_execz Lpsk_73
    buffer_load_dwordx4 v[24:27], v2, s[8:11], s30 offen offset:1024 sc1
Lpsk_73:
    s_mov_b64 exec, -1
    s_add_u32 s40, s40, 1
    s_cmp_lt_u32 s40, 200000
    s_cbranch_scc1 Lpchk_70
    s_waitcnt vmcnt(0)
Lpd_71:
    ds_write_b128 v5, v[20:23]
    ds_write_b128 v5, v[24:27] offset:1152
    s_waitcnt lgkmcnt(0)
L6s_c_bm:
    s_barrier
    ds_read_b64_tr_b16 v[20:21], v7 offset:0
    ds_read_b64_tr_b16 v[22:23], v7 offset:64
    ds_read_b64_tr_b16 v[24:25], v7 offset:1152
    ds_read_b64_tr_b16 v[26:27], v7 offset:1216
    ds_read_b64_tr_b16 v[28:29], v7 offset:2304
    ds_read_b64_tr_b16 v[30:31], v7 offset:2368
    ds_read_b64_tr_b16 v[32:33], v7 offset:3456
    ds_read_b64_tr_b16 v[34:35], v7 offset:3520
    s_waitcnt lgkmcnt(6)
    v_smfmac_f32_16x16x64_bf16 v[36:39], v[20:23], v[96:103], v10
    v_smfmac_f32_16x16x64_bf16 v[40:43], v[20:23], v[104:111], v10
    ds_read_b64_tr_b16 v[20:21], v7 offset:4608
    ds_read_b64_tr_b16 v[22:23], v7 offset:4672
    s_waitcnt lgkmcnt(6)
    v_smfmac_f32_16x16x64_bf16 v[36:39], v[24:27], v[112:119], v10
    v_smfmac_f32_16x16x64_bf16 v[40:43], v[24:27], v[120:127], v10
    ds_read_b64_tr_b16 v[24:25], v7 offset:5760
    ds_read_b64_tr_b16 v[26:27], v7 offset:5824
    s_waitcnt lgkmcnt(6)
    v_smfmac_f32_16x16x64_bf16 v[36:39], v[28:31], v[128:135], v10
    v_smfmac_f32_16x16x64_bf16 v[40:43], v[28:31], v[136:143], v10
    ds_read_b64_tr_b16 v[28:29], v7 offset:6912
    ds_read_b64_tr_b16 v[30:31], v7 offset:6976
    s_waitcnt lgkmcnt(6)
    v_smfmac_f32_16x16x64_bf16 v[36:39], v[32:35], v[144:151], v10
    v_smfmac_f32_16x16x64_bf16 v[40:43], v[32:35], v[152:159], v10
    ds_read_b64_tr_b16 v[32:33], v7 offset:8064
    ds_read_b64_tr_b16 v[34:35], v7 offset:8128
    s_waitcnt lgkmcnt(6)
    v_smfmac_f32_16x16x64_bf16 v[36:39], v[20:23], v[160:167], v10
    v_smfmac_f32_16x16x64_bf16 v[40:43], v[20:23], v[168:175], v10
    ds_read_b64_tr_b16 v[20:21], v7 offset:9216
    ds_read_b64_tr_b16 v[22:23], v7 offset:9280
    s_waitcnt lgkmcnt(6)
    v_smfmac_f32_16x16x64_bf16 v[36:39], v[24:27], v[176:183], v10
    v_smfmac_f32_16x16x64_bf16 v[40:43], v[24:27], v[184:191], v10
    ds_read_b64_tr_b16 v[24:25], v7 offset:10368
    ds_read_b64_tr_b16 v[26:27], v7 offset:10432
    s_waitcnt lgkmcnt(6)
    v_smfmac_f32_16x16x64_bf16 v[36:39], v[28:31], v[192:199], v10
    v_smfmac_f32_16x16x64_bf16 v[40:43], v[28:31], v[200:207], v10
    s_waitcnt lgkmcnt(4)
    v_smfmac_f32_16x16x64_bf16 v[36:39], v[32:35], v[208:215], v10
    v_smfmac_f32_16x16x64_bf16 v[40:43], v[32:35], v[216:223], v10
    s_waitcnt lgkmcnt(2)
    v_smfmac_f32_16x16x64_bf16 v[36:39], v[20:23], v[224:231], v10
    v_smfmac_f32_16x16x64_bf16 v[40:43], v[20:23], v[232:239], v10
    s_waitcnt lgkmcnt(0)
    v_smfmac_f32_16x16x64_bf16 v[36:39], v[24:27], v[240:247], v10
    v_smfmac_f32_16x16x64_bf16 v[40:43], v[24:27], v[248:255], v10
    s_nop 7
    v_permlane32_swap_b32 v36, v40
    v_permlane32_swap_b32 v37, v41
    v_permlane32_swap_b32 v38, v42
    v_permlane32_swap_b32 v39, v43
    v_add_f32 v36, v36, v40
    v_add_f32 v37, v37, v41
    v_add_f32 v38, v38, v42
    v_add_f32 v39, v39, v43
    v_cvt_pk_bf16_f32 v44, v36, v37
    v_cvt_pk_bf16_f32 v45, v38, v39
    ds_write_b64 v9, v[44:45]
    s_waitcnt lgkmcnt(0)
    s_barrier
    s_cmp_eq_u32 s29, 63
    s_cbranch_scc1 L6_last
    s_and_b32 s38, s29, 3
    s_add_u32 s39, s29, 2
    s_and_b32 s39, s39, 3
    s_lshl_b32 s32, s38, 16
    s_add_u32 s32, s32, s52
    s_lshl_b32 s36, s39, 16
    s_add_u32 s36, s36, s52
    s_add_u32 s38, s29, 1
    s_and_b32 s38, s38, 3
    s_mul_i32 s30, s38, 40960
    s_add_u32 s30, s30, s50
    s_add_u32 s39, s29, 3
    s_and_b32 s39, s39, 3
    s_mul_i32 s34, s39, 40960
    s_add_u32 s34, s34, s50
    s_add_u32 s29, s29, 1
    v_mov_b32 v36, 0
    v_mov_b32 v37, 0
    v_mov_b32 v38, 0
    v_mov_b32 v39, 0
    v_mov_b32 v40, 0
    v_mov_b32 v41, 0
    v_mov_b32 v42, 0
    v_mov_b32 v43, 0
    v_mov_b32 v44, 0
    v_mov_b32 v45, 0
    v_mov_b32 v46, 0
    v_mov_b32 v47, 0
    s_barrier
    s_sleep 3
    s_mov_b32 s40, 0
    buffer_load_dwordx4 v[20:23], v3, s[8:11], s32 offen offset:0 sc1
    buffer_load_dwordx4 v[24:27], v3, s[8:11], s32 offen offset:1024 sc1
Lpchk_74:
    s_waitcnt vmcnt(0)
    v_max3_u32 v11, v20, v21, v22
    v_max_u32 v11, v11, v23
    v_cmp_eq_u32 s[84:85], -1, v11
    v_max3_u32 v13, v24, v25, v26
    v_max_u32 v13, v13, v27
    v_cmp_eq_u32 s[86:87], -1, v13
    s_or_b64 vcc, s[84:85], s[86:87]
    s_cbranch_scc0 Lpd_75
    s_mov_b64 exec, s[84:85]
    s_cbranch_execz Lpsk_76
    buffer_load_dwordx4 v[20:23], v3, s[8:11], s32 offen offset:0 sc1
Lpsk_76:
    s_mov_b64 exec, s[86:87]
    s_cbranch_execz Lpsk_77
    buffer_load_dwordx4 v[24:27], v3, s[8:11], s32 offen offset:1024 sc1
Lpsk_77:
    s_mov_b64 exec, -1
    s_add_u32 s40, s40, 1
    s_cmp_lt_u32 s40, 200000
    s_cbranch_scc1 Lpchk_74
    s_waitcnt vmcnt(0)
Lpd_75:
    v_smfmac_f32_16x16x64_bf16 v[36:39], v[20:23], v[48:55], v10
    v_smfmac_f32_16x16x64_bf16 v[36:39], v[24:27], v[72:79], v10
    v_smfmac_f32_16x16x64_bf16 v[40:43], v[20:23], v[56:63], v10
    v_smfmac_f32_16x16x64_bf16 v[40:43], v[24:27], v[80:87], v10
    v_smfmac_f32_16x16x64_bf16 v[44:47], v[20:23], v[64:71], v10
    v_smfmac_f32_16x16x64_bf16 v[44:47], v[24:27], v[88:95], v10
    s_nop 3
    ds_write_b128 v17, v[36:39]
    s_nop 0
    ds_write_b128 v17, v[40:43] offset:1024
    s_nop 0
    ds_write_b128 v17, v[44:47] offset:2048
    s_waitcnt lgkmcnt(0)
    s_barrier
    v_mov_b32 v36, 0
    v_mov_b32 v37, 0
    v_mov_b32 v38, 0
    v_mov_b32 v39, 0
    v_mov_b32 v40, 0
    v_mov_b32 v41, 0
    v_mov_b32 v42, 0
    v_mov_b32 v43, 0
    s_cmp_ge_u32 s29, 61
    s_cbranch_scc1 L6s_cnp
    s_add_u32 s38, s20, 0
    s_buffer_load_dword s92, s[8:11], s38 glc
    s_add_u32 s39, s21, 0
    s_buffer_load_dword s96, s[8:11], s39 glc
    s_add_u32 s38, s20, 128
    s_buffer_load_dword s93, s[8:11], s38 glc
    s_add_u32 s39, s21, 128
    s_buffer_load_dword s97, s[8:11], s39 glc
    s_add_u32 s38, s20, 256
    s_buffer_load_dword s94, s[8:11], s38 glc
    s_add_u32 s39, s21, 256
    s_buffer_load_dword s98, s[8:11], s39 glc
    s_add_u32 s38, s20, 384
    s_buffer_load_dword s95, s[8:11], s38 glc
    s_add_u32 s39, s21, 384
    s_buffer_load_dword s99, s[8:11], s39 glc
    s_add_u32 s20, s20, 262144
    s_add_u32 s21, s21, 262144
L6s_cnp:
    s_barrier
    s_branch L6s_c
L6s_w4:
    v_mov_b32 v92, -1
    v_mov_b32 v93, -1
    v_mov_b32 v94, -1
    v_mov_b32 v95, -1
    v_mov_b32 v36, 0
    v_mov_b32 v37, 0
    v_mov_b32 v38, 0
    v_mov_b32 v39, 0
    v_mov_b32 v40, 0
    v_mov_b32 v41, 0
    v_mov_b32 v42, 0
    v_mov_b32 v43, 0
    s_branch L6s_w4_bm
L6s_w4l:
    s_sleep 3
    s_mov_b32 s40, 0
    buffer_load_dwordx4 v[20:23], v2, s[8:11], s30 offen offset:0 sc1
    buffer_load_dwordx4 v[24:27], v2, s[8:11], s30 offen offset:1024 sc1
Lpchk_78:
    s_waitcnt vmcnt(0)
    v_max3_u32 v11, v20, v21, v22
    v_max_u32 v11, v11, v23
    v_cmp_eq_u32 s[84:85], -1, v11
    v_max3_u32 v13, v24, v25, v26
    v_max_u32 v13, v13, v27
    v_cmp_eq_u32 s[86:87], -1, v13
    s_or_b64 vcc, s[84:85], s[86:87]
    s_cbranch_scc0 Lpd_79
    s_mov_b64 exec, s[84:85]
    s_cbranch_execz Lpsk_80
    buffer_load_dwordx4 v[20:23], v2, s[8:11], s30 offen offset:0 sc1
Lpsk_80:
    s_mov_b64 exec, s[86:87]
    s_cbranch_execz Lpsk_81
    buffer_load_dwordx4 v[24:27], v2, s[8:11], s30 offen offset:1024 sc1
Lpsk_81:
    s_mov_b64 exec, -1
    s_add_u32 s40, s40, 1
    s_cmp_lt_u32 s40, 200000
    s_cbranch_scc1 Lpchk_78
    s_waitcnt vmcnt(0)
Lpd_79:
    ds_write_b128 v5, v[20:23]
    ds_write_b128 v5, v[24:27] offset:1152
    s_waitcnt lgkmcnt(0)
L6s_w4_bm:
    s_barrier
    ds_read_b64_tr_b16 v[20:21], v7 offset:0
    ds_read_b64_tr_b16 v[22:23], v7 offset:64
    ds_read_b64_tr_b16 v[24:25], v7 offset:1152
    ds_read_b64_tr_b16 v[26:27], v7 offset:1216
    ds_read_b64_tr_b16 v[28:29], v7 offset:2304
    ds_read_b64_tr_b16 v[30:31], v7 offset:2368
    ds_read_b64_tr_b16 v[32:33], v7 offset:3456
    ds_read_b64_tr_b16 v[34:35], v7 offset:3520
    s_waitcnt lgkmcnt(6)
    v_smfmac_f32_16x16x64_bf16 v[36:39], v[20:23], v[96:103], v10
    v_smfmac_f32_16x16x64_bf16 v[40:43], v[20:23], v[104:111], v10
    ds_read_b64_tr_b16 v[20:21], v7 offset:4608
    ds_read_b64_tr_b16 v[22:23], v7 offset:4672
    s_waitcnt lgkmcnt(6)
    v_smfmac_f32_16x16x64_bf16 v[36:39], v[24:27], v[112:119], v10
    v_smfmac_f32_16x16x64_bf16 v[40:43], v[24:27], v[120:127], v10
    ds_read_b64_tr_b16 v[24:25], v7 offset:5760
    ds_read_b64_tr_b16 v[26:27], v7 offset:5824
    s_waitcnt lgkmcnt(6)
    v_smfmac_f32_16x16x64_bf16 v[36:39], v[28:31], v[128:135], v10
    v_smfmac_f32_16x16x64_bf16 v[40:43], v[28:31], v[136:143], v10
    ds_read_b64_tr_b16 v[28:29], v7 offset:6912
    ds_read_b64_tr_b16 v[30:31], v7 offset:6976
    s_waitcnt lgkmcnt(6)
    v_smfmac_f32_16x16x64_bf16 v[36:39], v[32:35], v[144:151], v10
    v_smfmac_f32_16x16x64_bf16 v[40:43], v[32:35], v[152:159], v10
    ds_read_b64_tr_b16 v[32:33], v7 offset:8064
    ds_read_b64_tr_b16 v[34:35], v7 offset:8128
    s_waitcnt lgkmcnt(6)
    v_smfmac_f32_16x16x64_bf16 v[36:39], v[20:23], v[160:167], v10
    v_smfmac_f32_16x16x64_bf16 v[40:43], v[20:23], v[168:175], v10
    ds_read_b64_tr_b16 v[20:21], v7 offset:9216
    ds_read_b64_tr_b16 v[22:23], v7 offset:9280
    s_waitcnt lgkmcnt(6)
    v_smfmac_f32_16x16x64_bf16 v[36:39], v[24:27], v[176:183], v10
    v_smfmac_f32_16x16x64_bf16 v[40:43], v[24:27], v[184:191], v10
    ds_read_b64_tr_b16 v[24:25], v7 offset:10368
    ds_read_b64_tr_b16 v[26:27], v7 offset:10432
    s_waitcnt lgkmcnt(6)
    v_smfmac_f32_16x16x64_bf16 v[36:39], v[28:31], v[192:199], v10
    v_smfmac_f32_16x16x64_bf16 v[40:43], v[28:31], v[200:207], v10
    s_waitcnt lgkmcnt(4)
    v_smfmac_f32_16x16x64_bf16 v[36:39], v[32:35], v[208:215], v10
    v_smfmac_f32_16x16x64_bf16 v[40:43], v[32:35], v[216:223], v10
    s_waitcnt lgkmcnt(2)
    v_smfmac_f32_16x16x64_bf16 v[36:39], v[20:23], v[224:231], v10
    v_smfmac_f32_16x16x64_bf16 v[40:43], v[20:23], v[232:239], v10
    s_waitcnt lgkmcnt(0)
    v_smfmac_f32_16x16x64_bf16 v[36:39], v[24:27], v[240:247], v10
    v_smfmac_f32_16x16x64_bf16 v[40:43], v[24:27], v[248:255], v10
    s_nop 7
    v_permlane32_swap_b32 v36, v40
    v_permlane32_swap_b32 v37, v41
    v_permlane32_swap_b32 v38, v42
    v_permlane32_swap_b32 v39, v43
    v_add_f32 v36, v36, v40
    v_add_f32 v37, v37, v41
    v_add_f32 v38, v38, v42
    v_add_f32 v39, v39, v43
    v_cvt_pk_bf16_f32 v44, v36, v37
    v_cvt_pk_bf16_f32 v45, v38, v39
    ds_write_b64 v9, v[44:45]
    s_waitcnt lgkmcnt(0)
    s_barrier
    v_mov_b32 v36, 0
    v_mov_b32 v37, 0
    v_mov_b32 v38, 0
    v_mov_b32 v39, 0
    v_add_u32 v12, 81920, v4
    ds_read_b64_tr_b16 v[20:21], v7 offset:0
    ds_read_b64_tr_b16 v[22:23], v7 offset:64
    ds_read_b128 v[48:51], v12 offset:0
    ds_read_b128 v[52:55], v12 offset:1024
    ds_read_b64_tr_b16 v[24:25], v7 offset:1152
    ds_read_b64_tr_b16 v[26:27], v7 offset:1216
    ds_read_b128 v[56:59], v12 offset:4096
    ds_read_b128 v[60:63], v12 offset:5120
    ds_read_b64_tr_b16 v[28:29], v7 offset:2304
    ds_read_b64_tr_b16 v[30:31], v7 offset:2368
    ds_read_b128 v[64:67], v12 offset:8192
    ds_read_b128 v[68:71], v12 offset:9216
    ds_read_b64_tr_b16 v[32:33], v7 offset:3456
    ds_read_b64_tr_b16 v[34:35], v7 offset:3520
    ds_read_b128 v[72:75], v12 offset:12288
    ds_read_b128 v[76:79], v12 offset:13312
    s_waitcnt lgkmcnt(12)
    v_smfmac_f32_16x16x64_bf16 v[36:39], v[20:23], v[48:55], v10
    ds_read_b64_tr_b16 v[20:21], v7 offset:4608
    ds_read_b64_tr_b16 v[22:23], v7 offset:4672
    ds_read_b128 v[48:51], v12 offset:16384
    ds_read_b128 v[52:55], v12 offset:17408
    s_waitcnt lgkmcnt(12)
    v_smfmac_f32_16x16x64_bf16 v[36:39], v[24:27], v[56:63], v10
    ds_read_b64_tr_b16 v[24:25], v7 offset:5760
    ds_read_b64_tr_b16 v[26:27], v7 offset:5824
    ds_read_b128 v[56:59], v12 offset:20480
    ds_read_b128 v[60:63], v12 offset:21504
    s_waitcnt lgkmcnt(12)
    v_smfmac_f32_16x16x64_bf16 v[36:39], v[28:31], v[64:71], v10
    ds_read_b64_tr_b16 v[28:29], v7 offset:6912
    ds_read_b64_tr_b16 v[30:31], v7 offset:6976
    ds_read_b128 v[64:67], v12 offset:24576
    ds_read_b128 v[68:71], v12 offset:25600
    s_waitcnt lgkmcnt(12)
    v_smfmac_f32_16x16x64_bf16 v[36:39], v[32:35], v[72:79], v10
    ds_read_b64_tr_b16 v[32:33], v7 offset:8064
    ds_read_b64_tr_b16 v[34:35], v7 offset:8128
    ds_read_b128 v[72:75], v12 offset:28672
    ds_read_b128 v[76:79], v12 offset:29696
    s_waitcnt lgkmcnt(12)
    v_smfmac_f32_16x16x64_bf16 v[36:39], v[20:23], v[48:55], v10
    ds_read_b64_tr_b16 v[20:21], v7 offset:9216
    ds_read_b64_tr_b16 v[22:23], v7 offset:9280
    ds_read_b128 v[48:51], v12 offset:32768
    ds_read_b128 v[52:55], v12 offset:33792
    s_waitcnt lgkmcnt(12)
    v_smfmac_f32_16x16x64_bf16 v[36:39], v[24:27], v[56:63], v10
    ds_read_b64_tr_b16 v[24:25], v7 offset:10368
    ds_read_b64_tr_b16 v[26:27], v7 offset:10432
    ds_read_b128 v[56:59], v12 offset:36864
    ds_read_b128 v[60:63], v12 offset:37888
    s_waitcnt lgkmcnt(12)
    v_smfmac_f32_16x16x64_bf16 v[36:39], v[28:31], v[64:71], v10
    s_waitcnt lgkmcnt(8)
    v_smfmac_f32_16x16x64_bf16 v[36:39], v[32:35], v[72:79], v10
    s_waitcnt lgkmcnt(4)
    v_smfmac_f32_16x16x64_bf16 v[36:39], v[20:23], v[48:55], v10
    s_waitcnt lgkmcnt(0)
    v_smfmac_f32_16x16x64_bf16 v[36:39], v[24:27], v[56:63], v10
    s_nop 7
    v_mov_b32 v80, v36
    v_mov_b32 v81, v37
    v_mov_b32 v82, v38
    v_mov_b32 v83, v39
    s_nop 1
    v_permlane32_swap_b32 v80, v36
    v_permlane32_swap_b32 v81, v37
    v_permlane32_swap_b32 v82, v38
    v_permlane32_swap_b32 v83, v39
    v_add_f32 v80, v80, v36
    v_add_f32 v81, v81, v37
    v_add_f32 v82, v82, v38
    v_add_f32 v83, v83, v39
    v_cvt_pk_bf16_f32 v84, v80, v81
    v_cvt_pk_bf16_f32 v85, v82, v83
    s_nop 1
    v_mov_b32_dpp v84, v6 quad_perm:[0,1,2,3] row_mask:0x3 bank_mask:0xf
    v_mov_b32_dpp v85, v6 quad_perm:[0,1,2,3] row_mask:0x3 bank_mask:0xf
    ds_write_b64 v4, v[84:85] offset:1024
    s_waitcnt lgkmcnt(0)
    s_mov_b64 exec, 1
    ds_add_u32 v6, v16 offset:36
    s_mov_b64 exec, -1
    s_cmp_eq_u32 s29, 63
    s_cbranch_scc1 L6_last
    s_and_b32 s38, s29, 3
    s_add_u32 s39, s29, 2
    s_and_b32 s39, s39, 3
    s_lshl_b32 s32, s38, 16
    s_add_u32 s32, s32, s52
    s_lshl_b32 s36, s39, 16
    s_add_u32 s36, s36, s52
    s_add_u32 s38, s29, 1
    s_and_b32 s38, s38, 3
    s_mul_i32 s30, s38, 40960
    s_add_u32 s30, s30, s50
    s_add_u32 s39, s29, 3
    s_and_b32 s39, s39, 3
    s_mul_i32 s34, s39, 40960
    s_add_u32 s34, s34, s50
    s_cmp_lg_u32 s29, 0
    s_cbranch_scc1 Lpf_82
    s_mov_b32 s39, 125829120
Lpr_83:
    buffer_load_dwordx4 v[80:83], v4, s[8:11], s39 offen sc1
    s_waitcnt vmcnt(0)
    v_min_u32 v80, v80, v82
    v_min_u32 v81, v81, v83
    v_min_u32 v11, v80, v81
    v_cmp_eq_u32 vcc, 0, v11
    s_cbranch_vccz Lprd_84
    s_sleep 8
    s_branch Lpr_83
Lprd_84:
    s_nop 1
    v_min_u32_dpp v80, v80, v80 quad_perm:[1,0,3,2] row_mask:0xf bank_mask:0xf
    v_min_u32_dpp v81, v81, v81 quad_perm:[1,0,3,2] row_mask:0xf bank_mask:0xf
    s_nop 1
    v_min_u32_dpp v80, v80, v80 quad_perm:[2,3,0,1] row_mask:0xf bank_mask:0xf
    v_min_u32_dpp v81, v81, v81 quad_perm:[2,3,0,1] row_mask:0xf bank_mask:0xf
    v_cmp_lt_u32 s[18:19], v81, v80
Lpf_82:
    s_and_b32 s38, s29, 0x3c
    s_lshr_b64 s[38:39], s[18:19], s38
    s_bfe_u32 s39, s38, 0x10004
    s_and_b32 s38, s38, 1
    s_lshl_b32 s38, s38, 13
    s_lshl_b32 s39, s39, 13
    s_lshl_b32 s33, s29, 19
    s_add_u32 s33, s33, 134217728
    s_add_u32 s22, s33, s39
    s_add_u32 s22, s22, 2097152
    s_add_u32 s22, s22, s43
    s_add_u32 s33, s33, s38
    s_add_u32 s37, s33, s43
    s_add_u32 s33, s33, s42
    v_mov_b32 v36, 0
    v_mov_b32 v37, 0
    v_mov_b32 v38, 0
    v_mov_b32 v39, 0
    v_mov_b32 v40, 0
    v_mov_b32 v41, 0
    v_mov_b32 v42, 0
    v_mov_b32 v43, 0
    s_mov_b64 exec, s[56:57]
    s_barrier
    s_barrier
    ds_read_b128 v[48:51], v8 offset:0
    ds_read_b128 v[52:55], v8 offset:512
    ds_read_b128 v[56:59], v8 offset:3072
    ds_read_b128 v[60:63], v8 offset:3584
    ds_read_b128 v[64:67], v8 offset:6144
    ds_read_b128 v[68:71], v8 offset:6656
    ds_read_b128 v[72:75], v8 offset:9216
    ds_read_b128 v[76:79], v8 offset:9728
    s_waitcnt lgkmcnt(6)
    v_add_f32 v48, v48, v52
    v_add_f32 v49, v49, v53
    v_add_f32 v50, v50, v54
    v_add_f32 v51, v51, v55
    s_waitcnt lgkmcnt(4)
    v_add_f32 v56, v56, v60
    v_add_f32 v57, v57, v61
    v_add_f32 v58, v58, v62
    v_add_f32 v59, v59, v63
    v_add_f32 v48, v48, v56
    v_add_f32 v49, v49, v57
    v_add_f32 v50, v50, v58
    v_add_f32 v51, v51, v59
    s_waitcnt lgkmcnt(2)
    v_add_f32 v64, v64, v68
    v_add_f32 v65, v65, v69
    v_add_f32 v66, v66, v70
    v_add_f32 v67, v67, v71
    s_waitcnt lgkmcnt(0)
    v_add_f32 v72, v72, v76
    v_add_f32 v73, v73, v77
    v_add_f32 v74, v74, v78
    v_add_f32 v75, v75, v79
    v_add_f32 v64, v64, v72
    v_add_f32 v65, v65, v73
    v_add_f32 v66, v66, v74
    v_add_f32 v67, v67, v75
    v_add_f32 v48, v48, v64
    v_add_f32 v49, v49, v65
    v_add_f32 v50, v50, v66
    v_add_f32 v51, v51, v67
    buffer_store_dwordx4 v[48:51], v15, s[8:11], s37 offen sc1
    s_add_u32 s29, s29, 1
    s_add_u32 s44, s44, 131072
    s_add_u32 s45, s45, 131072
    s_add_u32 s55, s55, 2048
    s_add_u32 s48, s48, 10240
    s_cmp_eq_u32 s48, 61440
    s_cselect_b32 s48, 30720, s48
    s_mov_b64 exec, s[56:57]
    s_sleep 10
    buffer_store_dwordx4 v[92:95], v15, s[8:11], s22 offen sc1
    s_mov_b64 exec, -1
    s_barrier
    s_branch L6s_w4l
L6s_w5:
    v_mov_b32 v92, -1
    v_mov_b32 v93, -1
    v_mov_b32 v94, -1
    v_mov_b32 v95, -1
L6s_w5l:
    v_mov_b32 v36, 0
    v_mov_b32 v37, 0
    v_mov_b32 v38, 0
    v_mov_b32 v39, 0
    v_mov_b32 v40, 0
    v_mov_b32 v41, 0
    v_mov_b32 v42, 0
    v_mov_b32 v43, 0
    s_waitcnt lgkmcnt(0)
    s_barrier
    ds_read_b64_tr_b16 v[20:21], v7 offset:0
    ds_read_b64_tr_b16 v[22:23], v7 offset:64
    ds_read_b64_tr_b16 v[24:25], v7 offset:1152
    ds_read_b64_tr_b16 v[26:27], v7 offset:1216
    ds_read_b64_tr_b16 v[28:29], v7 offset:2304
    ds_read_b64_tr_b16 v[30:31], v7 offset:2368
    ds_read_b64_tr_b16 v[32:33], v7 offset:3456
    ds_read_b64_tr_b16 v[34:35], v7 offset:3520
    s_waitcnt lgkmcnt(6)
    v_smfmac_f32_16x16x64_bf16 v[36:39], v[20:23], v[96:103], v10
    v_smfmac_f32_16x16x64_bf16 v[40:43], v[20:23], v[104:111], v10
    ds_read_b64_tr_b16 v[20:21], v7 offset:4608
    ds_read_b64_tr_b16 v[22:23], v7 offset:4672
    s_waitcnt lgkmcnt(6)
    v_smfmac_f32_16x16x64_bf16 v[36:39], v[24:27], v[112:119], v10
    v_smfmac_f32_16x16x64_bf16 v[40:43], v[24:27], v[120:127], v10
    ds_read_b64_tr_b16 v[24:25], v7 offset:5760
    ds_read_b64_tr_b16 v[26:27], v7 offset:5824
    s_waitcnt lgkmcnt(6)
    v_smfmac_f32_16x16x64_bf16 v[36:39], v[28:31], v[128:135], v10
    v_smfmac_f32_16x16x64_bf16 v[40:43], v[28:31], v[136:143], v10
    ds_read_b64_tr_b16 v[28:29], v7 offset:6912
    ds_read_b64_tr_b16 v[30:31], v7 offset:6976
    s_waitcnt lgkmcnt(6)
    v_smfmac_f32_16x16x64_bf16 v[36:39], v[32:35], v[144:151], v10
    v_smfmac_f32_16x16x64_bf16 v[40:43], v[32:35], v[152:159], v10
    ds_read_b64_tr_b16 v[32:33], v7 offset:8064
    ds_read_b64_tr_b16 v[34:35], v7 offset:8128
    s_waitcnt lgkmcnt(6)
    v_smfmac_f32_16x16x64_bf16 v[36:39], v[20:23], v[160:167], v10
    v_smfmac_f32_16x16x64_bf16 v[40:43], v[20:23], v[168:175], v10
    ds_read_b64_tr_b16 v[20:21], v7 offset:9216
    ds_read_b64_tr_b16 v[22:23], v7 offset:9280
    s_waitcnt lgkmcnt(6)
    v_smfmac_f32_16x16x64_bf16 v[36:39], v[24:27], v[176:183], v10
    v_smfmac_f32_16x16x64_bf16 v[40:43], v[24:27], v[184:191], v10
    ds_read_b64_tr_b16 v[24:25], v7 offset:10368
    ds_read_b64_tr_b16 v[26:27], v7 offset:10432
    s_waitcnt lgkmcnt(6)
    v_smfmac_f32_16x16x64_bf16 v[36:39], v[28:31], v[192:199], v10
    v_smfmac_f32_16x16x64_bf16 v[40:43], v[28:31], v[200:207], v10
    s_waitcnt lgkmcnt(4)
    v_smfmac_f32_16x16x64_bf16 v[36:39], v[32:35], v[208:215], v10
    v_smfmac_f32_16x16x64_bf16 v[40:43], v[32:35], v[216:223], v10
    s_waitcnt lgkmcnt(2)
    v_smfmac_f32_16x16x64_bf16 v[36:39], v[20:23], v[224:231], v10
    v_smfmac_f32_16x16x64_bf16 v[40:43], v[20:23], v[232:239], v10
    s_waitcnt lgkmcnt(0)
    v_smfmac_f32_16x16x64_bf16 v[36:39], v[24:27], v[240:247], v10
    v_smfmac_f32_16x16x64_bf16 v[40:43], v[24:27], v[248:255], v10
    s_nop 7
    v_permlane32_swap_b32 v36, v40
    v_permlane32_swap_b32 v37, v41
    v_permlane32_swap_b32 v38, v42
    v_permlane32_swap_b32 v39, v43
    v_add_f32 v36, v36, v40
    v_add_f32 v37, v37, v41
    v_add_f32 v38, v38, v42
    v_add_f32 v39, v39, v43
    v_cvt_pk_bf16_f32 v44, v36, v37
    v_cvt_pk_bf16_f32 v45, v38, v39
    ds_write_b64 v9, v[44:45]
    s_waitcnt lgkmcnt(0)
    s_barrier
    v_mov_b32 v36, 0
    v_mov_b32 v37, 0
    v_mov_b32 v38, 0
    v_mov_b32 v39, 0
    v_add_u32 v12, 83968, v4
    ds_read_b64_tr_b16 v[20:21], v7 offset:0
    ds_read_b64_tr_b16 v[22:23], v7 offset:64
    ds_read_b128 v[48:51], v12 offset:0
    ds_read_b128 v[52:55], v12 offset:1024
    ds_read_b64_tr_b16 v[24:25], v7 offset:1152
    ds_read_b64_tr_b16 v[26:27], v7 offset:1216
    ds_read_b128 v[56:59], v12 offset:4096
    ds_read_b128 v[60:63], v12 offset:5120
    ds_read_b64_tr_b16 v[28:29], v7 offset:2304
    ds_read_b64_tr_b16 v[30:31], v7 offset:2368
    ds_read_b128 v[64:67], v12 offset:8192
    ds_read_b128 v[68:71], v12 offset:9216
    ds_read_b64_tr_b16 v[32:33], v7 offset:3456
    ds_read_b64_tr_b16 v[34:35], v7 offset:3520
    ds_read_b128 v[72:75], v12 offset:12288
    ds_read_b128 v[76:79], v12 offset:13312
    s_waitcnt lgkmcnt(12)
    v_smfmac_f32_16x16x64_bf16 v[36:39], v[20:23], v[48:55], v10
    ds_read_b64_tr_b16 v[20:21], v7 offset:4608
    ds_read_b64_tr_b16 v[22:23], v7 offset:4672
    ds_read_b128 v[48:51], v12 offset:16384
    ds_read_b128 v[52:55], v12 offset:17408
    s_waitcnt lgkmcnt(12)
    v_smfmac_f32_16x16x64_bf16 v[36:39], v[24:27], v[56:63], v10
    ds_read_b64_tr_b16 v[24:25], v7 offset:5760
    ds_read_b64_tr_b16 v[26:27], v7 offset:5824
    ds_read_b128 v[56:59], v12 offset:20480
    ds_read_b128 v[60:63], v12 offset:21504
    s_waitcnt lgkmcnt(12)
    v_smfmac_f32_16x16x64_bf16 v[36:39], v[28:31], v[64:71], v10
    ds_read_b64_tr_b16 v[28:29], v7 offset:6912
    ds_read_b64_tr_b16 v[30:31], v7 offset:6976
    ds_read_b128 v[64:67], v12 offset:24576
    ds_read_b128 v[68:71], v12 offset:25600
    s_waitcnt lgkmcnt(12)
    v_smfmac_f32_16x16x64_bf16 v[36:39], v[32:35], v[72:79], v10
    ds_read_b64_tr_b16 v[32:33], v7 offset:8064
    ds_read_b64_tr_b16 v[34:35], v7 offset:8128
    ds_read_b128 v[72:75], v12 offset:28672
    ds_read_b128 v[76:79], v12 offset:29696
    s_waitcnt lgkmcnt(12)
    v_smfmac_f32_16x16x64_bf16 v[36:39], v[20:23], v[48:55], v10
    ds_read_b64_tr_b16 v[20:21], v7 offset:9216
    ds_read_b64_tr_b16 v[22:23], v7 offset:9280
    ds_read_b128 v[48:51], v12 offset:32768
    ds_read_b128 v[52:55], v12 offset:33792
    s_waitcnt lgkmcnt(12)
    v_smfmac_f32_16x16x64_bf16 v[36:39], v[24:27], v[56:63], v10
    ds_read_b64_tr_b16 v[24:25], v7 offset:10368
    ds_read_b64_tr_b16 v[26:27], v7 offset:10432
    ds_read_b128 v[56:59], v12 offset:36864
    ds_read_b128 v[60:63], v12 offset:37888
    s_waitcnt lgkmcnt(12)
    v_smfmac_f32_16x16x64_bf16 v[36:39], v[28:31], v[64:71], v10
    s_waitcnt lgkmcnt(8)
    v_smfmac_f32_16x16x64_bf16 v[36:39], v[32:35], v[72:79], v10
    s_waitcnt lgkmcnt(4)
    v_smfmac_f32_16x16x64_bf16 v[36:39], v[20:23], v[48:55], v10
    s_waitcnt lgkmcnt(0)
    v_smfmac_f32_16x16x64_bf16 v[36:39], v[24:27], v[56:63], v10
    s_nop 7
    v_mov_b32 v80, v36
    v_mov_b32 v81, v37
    v_mov_b32 v82, v38
    v_mov_b32 v83, v39
    s_nop 1
    v_permlane32_swap_b32 v80, v36
    v_permlane32_swap_b32 v81, v37
    v_permlane32_swap_b32 v82, v38
    v_permlane32_swap_b32 v83, v39
    v_add_f32 v80, v80, v36
    v_add_f32 v81, v81, v37
    v_add_f32 v82, v82, v38
    v_add_f32 v83, v83, v39
    v_cvt_pk_bf16_f32 v84, v80, v81
    v_cvt_pk_bf16_f32 v85, v82, v83
    s_nop 1
    v_mov_b32_dpp v84, v6 quad_perm:[0,1,2,3] row_mask:0x3 bank_mask:0xf
    v_mov_b32_dpp v85, v6 quad_perm:[0,1,2,3] row_mask:0x3 bank_mask:0xf
    ds_write_b64 v4, v[84:85] offset:1032
    s_waitcnt lgkmcnt(0)
    s_mov_b64 exec, 1
    ds_add_u32 v6, v16 offset:36
    s_mov_b64 exec, -1
    s_cmp_eq_u32 s29, 63
    s_cbranch_scc1 L6_last
    s_cmp_lg_u32 s29, 0
    s_cbranch_scc1 Lpf_85
    s_mov_b32 s39, 125829120
Lpr_86:
    buffer_load_dwordx4 v[80:83], v4, s[8:11], s39 offen sc1
    s_waitcnt vmcnt(0)
    v_min_u32 v80, v80, v82
    v_min_u32 v81, v81, v83
    v_min_u32 v11, v80, v81
    v_cmp_eq_u32 vcc, 0, v11
    s_cbranch_vccz Lprd_87
    s_sleep 8
    s_branch Lpr_86
Lprd_87:
    s_nop 1
    v_min_u32_dpp v80, v80, v80 quad_perm:[1,0,3,2] row_mask:0xf bank_mask:0xf
    v_min_u32_dpp v81, v81, v81 quad_perm:[1,0,3,2] row_mask:0xf bank_mask:0xf
    s_nop 1
    v_min_u32_dpp v80, v80, v80 quad_perm:[2,3,0,1] row_mask:0xf bank_mask:0xf
    v_min_u32_dpp v81, v81, v81 quad_perm:[2,3,0,1] row_mask:0xf bank_mask:0xf
    v_cmp_lt_u32 s[18:19], v81, v80
Lpf_85:
    s_and_b32 s38, s29, 0x3c
    s_lshr_b64 s[38:39], s[18:19], s38
    s_bfe_u32 s39, s38, 0x10004
    s_and_b32 s38, s38, 1
    s_lshl_b32 s38, s38, 13
    s_lshl_b32 s39, s39, 13
    s_lshl_b32 s33, s29, 19
    s_add_u32 s33, s33, 134217728
    s_add_u32 s22, s33, s39
    s_add_u32 s22, s22, 2097152
    s_add_u32 s22, s22, s43
    s_add_u32 s33, s33, s38
    s_add_u32 s37, s33, s43
    s_add_u32 s33, s33, s42
    s_waitcnt vmcnt(0) lgkmcnt(0)
    s_mov_b64 exec, s[56:57]
    s_barrier
    s_barrier
    ds_read_b128 v[48:51], v8 offset:0
    ds_read_b128 v[52:55], v8 offset:512
    ds_read_b128 v[56:59], v8 offset:3072
    ds_read_b128 v[60:63], v8 offset:3584
    ds_read_b128 v[64:67], v8 offset:6144
    ds_read_b128 v[68:71], v8 offset:6656
    ds_read_b128 v[72:75], v8 offset:9216
    ds_read_b128 v[76:79], v8 offset:9728
    s_waitcnt lgkmcnt(6)
    v_add_f32 v48, v48, v52
    v_add_f32 v49, v49, v53
    v_add_f32 v50, v50, v54
    v_add_f32 v51, v51, v55
    s_waitcnt lgkmcnt(4)
    v_add_f32 v56, v56, v60
    v_add_f32 v57, v57, v61
    v_add_f32 v58, v58, v62
    v_add_f32 v59, v59, v63
    v_add_f32 v48, v48, v56
    v_add_f32 v49, v49, v57
    v_add_f32 v50, v50, v58
    v_add_f32 v51, v51, v59
    s_waitcnt lgkmcnt(2)
    v_add_f32 v64, v64, v68
    v_add_f32 v65, v65, v69
    v_add_f32 v66, v66, v70
    v_add_f32 v67, v67, v71
    s_waitcnt lgkmcnt(0)
    v_add_f32 v72, v72, v76
    v_add_f32 v73, v73, v77
    v_add_f32 v74, v74, v78
    v_add_f32 v75, v75, v79
    v_add_f32 v64, v64, v72
    v_add_f32 v65, v65, v73
    v_add_f32 v66, v66, v74
    v_add_f32 v67, v67, v75
    v_add_f32 v48, v48, v64
    v_add_f32 v49, v49, v65
    v_add_f32 v50, v50, v66
    v_add_f32 v51, v51, v67
    buffer_store_dwordx4 v[48:51], v15, s[8:11], s37 offen sc1
    s_mov_b64 exec, -1
    s_cmp_ge_u32 s29, 61
    s_cbranch_scc1 L6s_w5d
    s_add_u32 m0, s54, 0
    s_add_u32 s38, s46, 0
    buffer_load_dwordx4 v4, s[8:11], s38 offen lds
    s_add_u32 m0, s54, 1024
    s_add_u32 s38, s46, 1024
    buffer_load_dwordx4 v4, s[8:11], s38 offen lds
    s_add_u32 m0, s54, 2048
    s_add_u32 s38, s46, 2048
    buffer_load_dwordx4 v4, s[8:11], s38 offen lds
    s_add_u32 m0, s54, 3072
    s_add_u32 s38, s46, 3072
    buffer_load_dwordx4 v4, s[8:11], s38 offen lds
    s_add_u32 m0, s54, 4096
    s_add_u32 s38, s46, 4096
    buffer_load_dwordx4 v4, s[8:11], s38 offen lds
    s_add_u32 m0, s54, 5120
    s_add_u32 s38, s46, 5120
    buffer_load_dwordx4 v4, s[8:11], s38 offen lds
    s_add_u32 m0, s54, 6144
    s_add_u32 s38, s46, 6144
    buffer_load_dwordx4 v4, s[8:11], s38 offen lds
    s_add_u32 m0, s54, 7168
    s_add_u32 s38, s46, 7168
    buffer_load_dwordx4 v4, s[8:11], s38 offen lds
    s_add_u32 m0, s54, 8192
    s_add_u32 s38, s47, 0
    buffer_load_dwordx4 v4, s[8:11], s38 offen lds
    s_add_u32 m0, s54, 9216
    s_add_u32 s38, s47, 1024
    buffer_load_dwordx4 v4, s[8:11], s38 offen lds
    s_add_u32 s46, s46, 262144
    s_add_u32 s47, s47, 262144
    s_add_u32 s54, s54, 10240
    s_cmp_eq_u32 s54, 61440
    s_cselect_b32 s54, 30720, s54
L6s_w5d:
    s_add_u32 s29, s29, 1
    s_add_u32 s44, s44, 131072
    s_add_u32 s45, s45, 131072
    s_add_u32 s55, s55, 2048
    s_add_u32 s48, s48, 10240
    s_cmp_eq_u32 s48, 61440
    s_cselect_b32 s48, 30720, s48
    s_mov_b64 exec, s[56:57]
    s_sleep 7
    buffer_store_dwordx4 v[92:95], v15, s[8:11], s22 offen sc1
    s_mov_b64 exec, -1
    s_barrier
    s_branch L6s_w5l
L6s_w6:
L6s_w6l:
    v_mov_b32 v36, 0
    v_mov_b32 v37, 0
    v_mov_b32 v38, 0
    v_mov_b32 v39, 0
    v_mov_b32 v40, 0
    v_mov_b32 v41, 0
    v_mov_b32 v42, 0
    v_mov_b32 v43, 0
    s_barrier
    ds_read_b64_tr_b16 v[20:21], v7 offset:0
    ds_read_b64_tr_b16 v[22:23], v7 offset:64
    ds_read_b64_tr_b16 v[24:25], v7 offset:1152
    ds_read_b64_tr_b16 v[26:27], v7 offset:1216
    ds_read_b64_tr_b16 v[28:29], v7 offset:2304
    ds_read_b64_tr_b16 v[30:31], v7 offset:2368
    ds_read_b64_tr_b16 v[32:33], v7 offset:3456
    ds_read_b64_tr_b16 v[34:35], v7 offset:3520
    s_waitcnt lgkmcnt(6)
    v_smfmac_f32_16x16x64_bf16 v[36:39], v[20:23], v[96:103], v10
    v_smfmac_f32_16x16x64_bf16 v[40:43], v[20:23], v[104:111], v10
    ds_read_b64_tr_b16 v[20:21], v7 offset:4608
    ds_read_b64_tr_b16 v[22:23], v7 offset:4672
    s_waitcnt lgkmcnt(6)
    v_smfmac_f32_16x16x64_bf16 v[36:39], v[24:27], v[112:119], v10
    v_smfmac_f32_16x16x64_bf16 v[40:43], v[24:27], v[120:127], v10
    ds_read_b64_tr_b16 v[24:25], v7 offset:5760
    ds_read_b64_tr_b16 v[26:27], v7 offset:5824
    s_waitcnt lgkmcnt(6)
    v_smfmac_f32_16x16x64_bf16 v[36:39], v[28:31], v[128:135], v10
    v_smfmac_f32_16x16x64_bf16 v[40:43], v[28:31], v[136:143], v10
    ds_read_b64_tr_b16 v[28:29], v7 offset:6912
    ds_read_b64_tr_b16 v[30:31], v7 offset:6976
    s_waitcnt lgkmcnt(6)
    v_smfmac_f32_16x16x64_bf16 v[36:39], v[32:35], v[144:151], v10
    v_smfmac_f32_16x16x64_bf16 v[40:43], v[32:35], v[152:159], v10
    ds_read_b64_tr_b16 v[32:33], v7 offset:8064
    ds_read_b64_tr_b16 v[34:35], v7 offset:8128
    s_waitcnt lgkmcnt(6)
    v_smfmac_f32_16x16x64_bf16 v[36:39], v[20:23], v[160:167], v10
    v_smfmac_f32_16x16x64_bf16 v[40:43], v[20:23], v[168:175], v10
    ds_read_b64_tr_b16 v[20:21], v7 offset:9216
    ds_read_b64_tr_b16 v[22:23], v7 offset:9280
    s_waitcnt lgkmcnt(6)
    v_smfmac_f32_16x16x64_bf16 v[36:39], v[24:27], v[176:183], v10
    v_smfmac_f32_16x16x64_bf16 v[40:43], v[24:27], v[184:191], v10
    ds_read_b64_tr_b16 v[24:25], v7 offset:10368
    ds_read_b64_tr_b16 v[26:27], v7 offset:10432
    s_waitcnt lgkmcnt(6)
    v_smfmac_f32_16x16x64_bf16 v[36:39], v[28:31], v[192:199], v10
    v_smfmac_f32_16x16x64_bf16 v[40:43], v[28:31], v[200:207], v10
    s_waitcnt lgkmcnt(4)
    v_smfmac_f32_16x16x64_bf16 v[36:39], v[32:35], v[208:215], v10
    v_smfmac_f32_16x16x64_bf16 v[40:43], v[32:35], v[216:223], v10
    s_waitcnt lgkmcnt(2)
    v_smfmac_f32_16x16x64_bf16 v[36:39], v[20:23], v[224:231], v10
    v_smfmac_f32_16x16x64_bf16 v[40:43], v[20:23], v[232:239], v10
    s_waitcnt lgkmcnt(0)
    v_smfmac_f32_16x16x64_bf16 v[36:39], v[24:27], v[240:247], v10
    v_smfmac_f32_16x16x64_bf16 v[40:43], v[24:27], v[248:255], v10
    s_nop 7
    v_permlane32_swap_b32 v36, v40
    v_permlane32_swap_b32 v37, v41
    v_permlane32_swap_b32 v38, v42
    v_permlane32_swap_b32 v39, v43
    v_add_f32 v36, v36, v40
    v_add_f32 v37, v37, v41
    v_add_f32 v38, v38, v42
    v_add_f32 v39, v39, v43
    v_cvt_pk_bf16_f32 v44, v36, v37
    v_cvt_pk_bf16_f32 v45, v38, v39
    ds_write_b64 v9, v[44:45]
    s_waitcnt lgkmcnt(0)
    v_add_u32 v12, s48, v4
    ds_read_b128 v[48:51], v12 offset:0
    ds_read_b128 v[52:55], v12 offset:1024
    ds_read_b128 v[56:59], v12 offset:2048
    ds_read_b128 v[60:63], v12 offset:3072
    ds_read_b128 v[64:67], v12 offset:4096
    ds_read_b128 v[68:71], v12 offset:5120
    ds_read_b128 v[72:75], v12 offset:6144
    ds_read_b128 v[76:79], v12 offset:7168
    ds_read_b128 v[80:83], v12 offset:8192
    ds_read_b128 v[84:87], v12 offset:9216
    s_barrier
    ds_read_b64_tr_b16 v[20:21], v18 offset:0
    ds_read_b64_tr_b16 v[22:23], v18 offset:512
    ds_read_b64_tr_b16 v[24:25], v18 offset:1024
    ds_read_b64_tr_b16 v[26:27], v18 offset:1536
    ds_read_b64_tr_b16 v[28:29], v18 offset:2048
    ds_read_b64_tr_b16 v[30:31], v18 offset:2560
    ds_read_b64_tr_b16 v[32:33], v18 offset:3072
    ds_read_b64_tr_b16 v[34:35], v18 offset:3584
    s_cmp_eq_u32 s29, 63
    s_cbranch_scc1 L6s_w6last
    s_waitcnt lgkmcnt(6)
    v_mfma_f32_16x16x32_bf16 v[36:39], v[48:51], v[20:23], 0
    v_mfma_f32_16x16x32_bf16 v[40:43], v[64:67], v[20:23], 0
    s_waitcnt lgkmcnt(4)
    v_mfma_f32_16x16x32_bf16 v[36:39], v[52:55], v[24:27], v[36:39]
    v_mfma_f32_16x16x32_bf16 v[40:43], v[68:71], v[24:27], v[40:43]
    s_waitcnt lgkmcnt(2)
    v_mfma_f32_16x16x32_bf16 v[36:39], v[56:59], v[28:31], v[36:39]
    v_mfma_f32_16x16x32_bf16 v[40:43], v[72:75], v[28:31], v[40:43]
    s_waitcnt lgkmcnt(0)
    v_mfma_f32_16x16x32_bf16 v[36:39], v[60:63], v[32:35], v[36:39]
    v_mfma_f32_16x16x32_bf16 v[40:43], v[76:79], v[32:35], v[40:43]
    v_mfma_f32_16x16x32_bf16 v[44:47], v[20:23], v[20:23], 0
    s_and_b32 s38, s29, 3
    s_add_u32 s39, s29, 2
    s_and_b32 s39, s39, 3
    s_lshl_b32 s32, s38, 16
    s_add_u32 s32, s32, s52
    s_lshl_b32 s36, s39, 16
    s_add_u32 s36, s36, s52
    s_add_u32 s38, s29, 1
    s_and_b32 s38, s38, 3
    s_mul_i32 s30, s38, 40960
    s_add_u32 s30, s30, s50
    s_add_u32 s39, s29, 3
    s_and_b32 s39, s39, 3
    s_mul_i32 s34, s39, 40960
    s_add_u32 s34, s34, s50
    v_mfma_f32_16x16x32_bf16 v[44:47], v[24:27], v[24:27], v[44:47]
    v_mfma_f32_16x16x32_bf16 v[44:47], v[28:31], v[28:31], v[44:47]
    v_mfma_f32_16x16x32_bf16 v[44:47], v[32:35], v[32:35], v[44:47]
    s_lshl_b32 s53, s29, 1
    s_add_u32 s53, s53, 2
    v_mov_b32 v92, 0xf149f2ca
    v_max3_f32 v13, v36, v37, v38
    v_max3_f32 v11, v39, v40, v41
    v_max3_f32 v13, v13, v42, v43
    v_max_f32 v13, v13, v11
    s_nop 1
    v_mov_b32_dpp v44, v92 quad_perm:[0,1,2,3] row_mask:0x3 bank_mask:0xf
    v_mov_b32_dpp v45, v92 quad_perm:[0,1,2,3] row_mask:0x3 bank_mask:0xf
    v_mov_b32_dpp v46, v92 quad_perm:[0,1,2,3] row_mask:0x3 bank_mask:0xf
    v_mov_b32_dpp v47, v92 quad_perm:[0,1,2,3] row_mask:0x3 bank_mask:0xf
    v_max3_f32 v11, v44, v45, v46
    v_max3_f32 v13, v13, v11, v47
    v_mov_b32 v11, v13
    s_nop 1
    v_permlane32_swap_b32 v13, v11
    v_max_f32 v13, v13, v11
    v_mov_b32 v11, v13
    s_nop 1
    v_permlane16_swap_b32 v13, v11
    v_max_f32 v13, v13, v11
    v_mul_f32 v13, s41, v13
    v_fma_f32 v36, v36, s41, -v13
    v_fma_f32 v37, v37, s41, -v13
    v_fma_f32 v38, v38, s41, -v13
    v_fma_f32 v39, v39, s41, -v13
    v_fma_f32 v40, v40, s41, -v13
    v_fma_f32 v41, v41, s41, -v13
    v_fma_f32 v42, v42, s41, -v13
    v_fma_f32 v43, v43, s41, -v13
    v_exp_f32 v36, v36
    v_exp_f32 v37, v37
    v_exp_f32 v38, v38
    v_exp_f32 v39, v39
    v_exp_f32 v40, v40
    v_exp_f32 v41, v41
    v_exp_f32 v42, v42
    v_exp_f32 v43, v43
    v_fma_f32 v44, v44, s41, -v13
    v_fma_f32 v45, v45, s41, -v13
    v_fma_f32 v46, v46, s41, -v13
    v_fma_f32 v47, v47, s41, -v13
    ds_read_b32 v12, v6 offset:36
    ds_read_b128 v[88:91], v4 offset:1024
    v_cvt_pk_bf16_f32 v48, v36, v37
    v_cvt_pk_bf16_f32 v49, v38, v39
    v_cvt_pk_bf16_f32 v50, v40, v41
    v_cvt_pk_bf16_f32 v51, v42, v43
    v_mov_b32 v56, 0x3f803f80
    v_mov_b32 v57, 0x3f803f80
    v_mov_b32 v58, 0x3f803f80
    v_mov_b32 v59, 0x3f803f80
    v_exp_f32 v44, v44
    v_exp_f32 v45, v45
    v_mfma_f32_16x16x32_bf16 v[60:63], v[56:59], v[48:51], 0
    v_exp_f32 v46, v46
    v_exp_f32 v47, v47
    v_mfma_f32_16x16x32_bf16 v[64:67], v[80:83], v[48:51], 0
    v_cvt_pk_bf16_f32 v52, v44, v45
    v_cvt_pk_bf16_f32 v53, v46, v47
    v_mfma_f32_16x16x32_bf16 v[68:71], v[84:87], v[48:51], 0
    s_waitcnt lgkmcnt(0)
    v_readfirstlane_b32 s38, v12
    v_mfma_f32_16x16x16_bf16 v[60:63], v[56:57], v[52:53], v[60:63]
    s_cmp_ge_u32 s38, s53
    s_cbranch_scc0 L6s_vmw
L6s_vmok:
    v_mfma_f32_16x16x16_bf16 v[64:67], v[88:89], v[52:53], v[64:67]
    v_mfma_f32_16x16x16_bf16 v[68:71], v[90:91], v[52:53], v[68:71]
    s_nop 3
    v_rcp_f32 v11, v60
    s_mov_b32 exec_lo, 0x00ff00ff
    s_mov_b32 exec_hi, 0x00ff00ff
    s_nop 0
    v_mul_f32 v64, v64, v11
    v_mul_f32 v65, v65, v11
    v_mul_f32 v66, v66, v11
    v_mul_f32 v67, v67, v11
    v_mul_f32 v68, v68, v11
    v_mul_f32 v69, v69, v11
    v_mul_f32 v70, v70, v11
    v_mul_f32 v71, v71, v11
    v_cvt_pk_bf16_f32 v72, v64, v65
    v_cvt_pk_bf16_f32 v73, v66, v67
    v_cvt_pk_bf16_f32 v74, v68, v69
    v_cvt_pk_bf16_f32 v75, v70, v71
    buffer_store_dwordx4 v[72:75], v3, s[8:11], s32 offen sc1
    s_barrier
    v_mov_b32 v76, -1
    v_mov_b32 v77, -1
    v_mov_b32 v78, -1
    v_mov_b32 v79, -1
    buffer_store_dwordx4 v[76:79], v3, s[8:11], s36 offen sc1
    s_mov_b64 exec, -1
    s_waitcnt vmcnt(0)
    s_barrier
    s_sleep 13
    s_cmp_eq_u32 s29, 0
    s_cbranch_scc1 Lfl_88
    s_sub_u32 s38, s55, 2048
    s_mov_b64 exec, 1
    buffer_store_dword v16, v6, s[8:11], s38 offen sc1
    s_mov_b64 exec, -1
Lfl_88:
    s_cmp_lg_u32 s27, 0
    s_cbranch_scc1 Lkmn_89
    buffer_store_dwordx4 v[20:23], v4, s[8:11], s44 offen offset:0 sc1
Lkmn_89:
    s_cmp_lg_u32 s27, 1
    s_cbranch_scc1 Lkmn_90
    buffer_store_dwordx4 v[24:27], v4, s[8:11], s44 offen offset:1024 sc1
Lkmn_90:
    s_cmp_lg_u32 s27, 2
    s_cbranch_scc1 Lkmn_91
    buffer_store_dwordx4 v[28:31], v4, s[8:11], s44 offen offset:2048 sc1
Lkmn_91:
    s_cmp_lg_u32 s27, 3
    s_cbranch_scc1 Lkmn_92
    buffer_store_dwordx4 v[32:35], v4, s[8:11], s44 offen offset:3072 sc1
Lkmn_92:
    buffer_store_dwordx2 v[88:89], v14, s[8:11], s45 offen sc1
    buffer_store_dwordx2 v[90:91], v14, s[8:11], s45 offen offset:512 sc1
    s_add_u32 s29, s29, 1
    s_add_u32 s44, s44, 131072
    s_add_u32 s45, s45, 131072
    s_add_u32 s55, s55, 2048
    s_add_u32 s48, s48, 10240
    s_cmp_eq_u32 s48, 61440
    s_cselect_b32 s48, 30720, s48
    s_barrier
    s_branch L6s_w6l
L6s_vmw:
Lspin_93:
    ds_read_b32 v11, v6 offset:36
    s_waitcnt lgkmcnt(0)
    v_readfirstlane_b32 s38, v11
    s_nop 0
    s_cmp_ge_u32 s38, s53
    s_cbranch_scc0 Lspin_93
    ds_read_b128 v[88:91], v4 offset:1024
    s_waitcnt lgkmcnt(0)
    s_branch L6s_vmok
L6s_w6last:
    s_lshl_b32 s53, s29, 1
    s_add_u32 s53, s53, 2
Lspin_94:
    ds_read_b32 v11, v6 offset:36
    s_waitcnt lgkmcnt(0)
    v_readfirstlane_b32 s38, v11
    s_nop 0
    s_cmp_ge_u32 s38, s53
    s_cbranch_scc0 Lspin_94
    ds_read_b128 v[88:91], v4 offset:1024
    s_waitcnt lgkmcnt(0) vmcnt(0)
    s_cmp_eq_u32 s29, 0
    s_cbranch_scc1 Lfl_95
    s_sub_u32 s38, s55, 2048
    s_mov_b64 exec, 1
    buffer_store_dword v16, v6, s[8:11], s38 offen sc1
    s_mov_b64 exec, -1
Lfl_95:
    s_cmp_lg_u32 s27, 0
    s_cbranch_scc1 Lkmn_96
    buffer_store_dwordx4 v[20:23], v4, s[8:11], s44 offen offset:0 sc1
Lkmn_96:
    s_cmp_lg_u32 s27, 1
    s_cbranch_scc1 Lkmn_97
    buffer_store_dwordx4 v[24:27], v4, s[8:11], s44 offen offset:1024 sc1
Lkmn_97:
    s_cmp_lg_u32 s27, 2
    s_cbranch_scc1 Lkmn_98
    buffer_store_dwordx4 v[28:31], v4, s[8:11], s44 offen offset:2048 sc1
Lkmn_98:
    s_cmp_lg_u32 s27, 3
    s_cbranch_scc1 Lkmn_99
    buffer_store_dwordx4 v[32:35], v4, s[8:11], s44 offen offset:3072 sc1
Lkmn_99:
    buffer_store_dwordx2 v[88:89], v14, s[8:11], s45 offen sc1
    buffer_store_dwordx2 v[90:91], v14, s[8:11], s45 offen offset:512 sc1
    s_branch L6_last
L6s_w7:
    v_mov_b32 v92, -1
    v_mov_b32 v93, -1
L6s_w7l:
    v_mov_b32 v36, 0
    v_mov_b32 v37, 0
    v_mov_b32 v38, 0
    v_mov_b32 v39, 0
    v_mov_b32 v40, 0
    v_mov_b32 v41, 0
    v_mov_b32 v42, 0
    v_mov_b32 v43, 0
    s_waitcnt lgkmcnt(0)
    s_barrier
    ds_read_b64_tr_b16 v[20:21], v7 offset:0
    ds_read_b64_tr_b16 v[22:23], v7 offset:64
    ds_read_b64_tr_b16 v[24:25], v7 offset:1152
    ds_read_b64_tr_b16 v[26:27], v7 offset:1216
    ds_read_b64_tr_b16 v[28:29], v7 offset:2304
    ds_read_b64_tr_b16 v[30:31], v7 offset:2368
    ds_read_b64_tr_b16 v[32:33], v7 offset:3456
    ds_read_b64_tr_b16 v[34:35], v7 offset:3520
    s_waitcnt lgkmcnt(6)
    v_smfmac_f32_16x16x64_bf16 v[36:39], v[20:23], v[96:103], v10
    v_smfmac_f32_16x16x64_bf16 v[40:43], v[20:23], v[104:111], v10
    ds_read_b64_tr_b16 v[20:21], v7 offset:4608
    ds_read_b64_tr_b16 v[22:23], v7 offset:4672
    s_waitcnt lgkmcnt(6)
    v_smfmac_f32_16x16x64_bf16 v[36:39], v[24:27], v[112:119], v10
    v_smfmac_f32_16x16x64_bf16 v[40:43], v[24:27], v[120:127], v10
    ds_read_b64_tr_b16 v[24:25], v7 offset:5760
    ds_read_b64_tr_b16 v[26:27], v7 offset:5824
    s_waitcnt lgkmcnt(6)
    v_smfmac_f32_16x16x64_bf16 v[36:39], v[28:31], v[128:135], v10
    v_smfmac_f32_16x16x64_bf16 v[40:43], v[28:31], v[136:143], v10
    ds_read_b64_tr_b16 v[28:29], v7 offset:6912
    ds_read_b64_tr_b16 v[30:31], v7 offset:6976
    s_waitcnt lgkmcnt(6)
    v_smfmac_f32_16x16x64_bf16 v[36:39], v[32:35], v[144:151], v10
    v_smfmac_f32_16x16x64_bf16 v[40:43], v[32:35], v[152:159], v10
    ds_read_b64_tr_b16 v[32:33], v7 offset:8064
    ds_read_b64_tr_b16 v[34:35], v7 offset:8128
    s_waitcnt lgkmcnt(6)
    v_smfmac_f32_16x16x64_bf16 v[36:39], v[20:23], v[160:167], v10
    v_smfmac_f32_16x16x64_bf16 v[40:43], v[20:23], v[168:175], v10
    ds_read_b64_tr_b16 v[20:21], v7 offset:9216
    ds_read_b64_tr_b16 v[22:23], v7 offset:9280
    s_waitcnt lgkmcnt(6)
    v_smfmac_f32_16x16x64_bf16 v[36:39], v[24:27], v[176:183], v10
    v_smfmac_f32_16x16x64_bf16 v[40:43], v[24:27], v[184:191], v10
    ds_read_b64_tr_b16 v[24:25], v7 offset:10368
    ds_read_b64_tr_b16 v[26:27], v7 offset:10432
    s_waitcnt lgkmcnt(6)
    v_smfmac_f32_16x16x64_bf16 v[36:39], v[28:31], v[192:199], v10
    v_smfmac_f32_16x16x64_bf16 v[40:43], v[28:31], v[200:207], v10
    s_waitcnt lgkmcnt(4)
    v_smfmac_f32_16x16x64_bf16 v[36:39], v[32:35], v[208:215], v10
    v_smfmac_f32_16x16x64_bf16 v[40:43], v[32:35], v[216:223], v10
    s_waitcnt lgkmcnt(2)
    v_smfmac_f32_16x16x64_bf16 v[36:39], v[20:23], v[224:231], v10
    v_smfmac_f32_16x16x64_bf16 v[40:43], v[20:23], v[232:239], v10
    s_waitcnt lgkmcnt(0)
    v_smfmac_f32_16x16x64_bf16 v[36:39], v[24:27], v[240:247], v10
    v_smfmac_f32_16x16x64_bf16 v[40:43], v[24:27], v[248:255], v10
    s_nop 7
    v_permlane32_swap_b32 v36, v40
    v_permlane32_swap_b32 v37, v41
    v_permlane32_swap_b32 v38, v42
    v_permlane32_swap_b32 v39, v43
    v_add_f32 v36, v36, v40
    v_add_f32 v37, v37, v41
    v_add_f32 v38, v38, v42
    v_add_f32 v39, v39, v43
    v_cvt_pk_bf16_f32 v44, v36, v37
    v_cvt_pk_bf16_f32 v45, v38, v39
    ds_write_b64 v9, v[44:45]
    s_waitcnt lgkmcnt(0)
    s_barrier
    s_cmp_eq_u32 s29, 63
    s_cbranch_scc1 L6_last
    s_and_b32 s38, s29, 3
    s_add_u32 s39, s29, 2
    s_and_b32 s39, s39, 3
    s_lshl_b32 s32, s38, 16
    s_add_u32 s32, s32, s52
    s_lshl_b32 s36, s39, 16
    s_add_u32 s36, s36, s52
    s_add_u32 s38, s29, 1
    s_and_b32 s38, s38, 3
    s_mul_i32 s30, s38, 40960
    s_add_u32 s30, s30, s50
    s_add_u32 s39, s29, 3
    s_and_b32 s39, s39, 3
    s_mul_i32 s34, s39, 40960
    s_add_u32 s34, s34, s50
    s_cmp_lg_u32 s29, 0
    s_cbranch_scc1 Lpf_100
    s_mov_b32 s39, 125829120
Lpr_101:
    buffer_load_dwordx4 v[80:83], v4, s[8:11], s39 offen sc1
    s_waitcnt vmcnt(0)
    v_min_u32 v80, v80, v82
    v_min_u32 v81, v81, v83
    v_min_u32 v11, v80, v81
    v_cmp_eq_u32 vcc, 0, v11
    s_cbranch_vccz Lprd_102
    s_sleep 8
    s_branch Lpr_101
Lprd_102:
    s_nop 1
    v_min_u32_dpp v80, v80, v80 quad_perm:[1,0,3,2] row_mask:0xf bank_mask:0xf
    v_min_u32_dpp v81, v81, v81 quad_perm:[1,0,3,2] row_mask:0xf bank_mask:0xf
    s_nop 1
    v_min_u32_dpp v80, v80, v80 quad_perm:[2,3,0,1] row_mask:0xf bank_mask:0xf
    v_min_u32_dpp v81, v81, v81 quad_perm:[2,3,0,1] row_mask:0xf bank_mask:0xf
    v_cmp_lt_u32 s[18:19], v81, v80
Lpf_100:
    s_and_b32 s38, s29, 0x3c
    s_lshr_b64 s[38:39], s[18:19], s38
    s_bfe_u32 s39, s38, 0x10004
    s_and_b32 s38, s38, 1
    s_lshl_b32 s38, s38, 13
    s_lshl_b32 s39, s39, 13
    s_lshl_b32 s33, s29, 19
    s_add_u32 s33, s33, 134217728
    s_add_u32 s22, s33, s39
    s_add_u32 s22, s22, 2097152
    s_add_u32 s22, s22, s43
    s_add_u32 s33, s33, s38
    s_add_u32 s37, s33, s43
    s_add_u32 s33, s33, s42
    s_add_u32 s37, s33, 16384
    s_cmp_ge_u32 s29, 60
    s_cbranch_scc1 L6s_w7n
    s_mov_b32 s40, 0
Lkvw_103:
    s_waitcnt lgkmcnt(0)
    s_and_b32 s38, s64, s65
    s_and_b32 s39, s66, s67
    s_and_b32 s38, s38, s39
    s_add_u32 s40, s40, 1
    s_cmp_ge_u32 s38, 1
    s_cbranch_scc1 Lkvd_104
    s_sleep 4
    s_buffer_load_dwordx4 s[64:67], s[8:11], s58 glc
    s_cmp_lt_u32 s40, 200000
    s_cbranch_scc1 Lkvw_103
Lkvd_104:
    s_add_u32 s58, s58, 2048
    s_buffer_load_dwordx4 s[64:67], s[8:11], s58 glc
L6s_w7n:
    s_mov_b64 exec, s[56:57]
    s_barrier
    s_barrier
    s_sleep 12
    s_mov_b32 s40, 0
    buffer_load_dwordx4 v[48:51], v4, s[8:11], s33 offen offset:0 sc1
    buffer_load_dwordx4 v[52:55], v4, s[8:11], s33 offen offset:1280 sc1
    buffer_load_dwordx4 v[56:59], v4, s[8:11], s33 offen offset:2560 sc1
    buffer_load_dwordx4 v[60:63], v4, s[8:11], s33 offen offset:3840 sc1
    buffer_load_dwordx4 v[64:67], v4, s[8:11], s37 offen offset:0 sc1
    buffer_load_dwordx4 v[68:71], v4, s[8:11], s37 offen offset:1280 sc1
    buffer_load_dwordx4 v[72:75], v4, s[8:11], s37 offen offset:2560 sc1
    buffer_load_dwordx4 v[76:79], v4, s[8:11], s37 offen offset:3840 sc1
Lpchk_105:
    s_waitcnt vmcnt(0)
    v_max3_u32 v11, v48, v49, v50
    v_max_u32 v11, v11, v51
    v_cmp_eq_u32 s[84:85], -1, v11
    v_max3_u32 v13, v52, v53, v54
    v_max_u32 v13, v13, v55
    v_cmp_eq_u32 s[86:87], -1, v13
    v_max3_u32 v11, v56, v57, v58
    v_max_u32 v11, v11, v59
    v_cmp_eq_u32 s[88:89], -1, v11
    v_max3_u32 v13, v60, v61, v62
    v_max_u32 v13, v13, v63
    v_cmp_eq_u32 s[90:91], -1, v13
    v_max3_u32 v11, v64, v65, v66
    v_max_u32 v11, v11, v67
    v_cmp_eq_u32 s[92:93], -1, v11
    v_max3_u32 v13, v68, v69, v70
    v_max_u32 v13, v13, v71
    v_cmp_eq_u32 s[94:95], -1, v13
    v_max3_u32 v11, v72, v73, v74
    v_max_u32 v11, v11, v75
    v_cmp_eq_u32 s[96:97], -1, v11
    v_max3_u32 v13, v76, v77, v78
    v_max_u32 v13, v13, v79
    v_cmp_eq_u32 s[98:99], -1, v13
    s_or_b64 vcc, s[84:85], s[86:87]
    s_or_b64 vcc, vcc, s[88:89]
    s_or_b64 vcc, vcc, s[90:91]
    s_or_b64 vcc, vcc, s[92:93]
    s_or_b64 vcc, vcc, s[94:95]
    s_or_b64 vcc, vcc, s[96:97]
    s_or_b64 vcc, vcc, s[98:99]
    s_cbranch_scc0 Lpd_106
    s_mov_b64 exec, s[84:85]
    s_cbranch_execz Lpsk_107
    buffer_load_dwordx4 v[48:51], v4, s[8:11], s33 offen offset:0 sc1
Lpsk_107:
    s_mov_b64 exec, s[86:87]
    s_cbranch_execz Lpsk_108
    buffer_load_dwordx4 v[52:55], v4, s[8:11], s33 offen offset:1280 sc1
Lpsk_108:
    s_mov_b64 exec, s[88:89]
    s_cbranch_execz Lpsk_109
    buffer_load_dwordx4 v[56:59], v4, s[8:11], s33 offen offset:2560 sc1
Lpsk_109:
    s_mov_b64 exec, s[90:91]
    s_cbranch_execz Lpsk_110
    buffer_load_dwordx4 v[60:63], v4, s[8:11], s33 offen offset:3840 sc1
Lpsk_110:
    s_mov_b64 exec, s[92:93]
    s_cbranch_execz Lpsk_111
    buffer_load_dwordx4 v[64:67], v4, s[8:11], s37 offen offset:0 sc1
Lpsk_111:
    s_mov_b64 exec, s[94:95]
    s_cbranch_execz Lpsk_112
    buffer_load_dwordx4 v[68:71], v4, s[8:11], s37 offen offset:1280 sc1
Lpsk_112:
    s_mov_b64 exec, s[96:97]
    s_cbranch_execz Lpsk_113
    buffer_load_dwordx4 v[72:75], v4, s[8:11], s37 offen offset:2560 sc1
Lpsk_113:
    s_mov_b64 exec, s[98:99]
    s_cbranch_execz Lpsk_114
    buffer_load_dwordx4 v[76:79], v4, s[8:11], s37 offen offset:3840 sc1
Lpsk_114:
    s_mov_b64 exec, s[56:57]
    s_add_u32 s40, s40, 1
    s_cmp_lt_u32 s40, 200000
    s_cbranch_scc1 Lpchk_105
    s_waitcnt vmcnt(0)
Lpd_106:
    v_add_f32 v48, v48, v64
    v_add_f32 v49, v49, v65
    v_add_f32 v50, v50, v66
    v_add_f32 v51, v51, v67
    v_add_f32 v52, v52, v68
    v_add_f32 v53, v53, v69
    v_add_f32 v54, v54, v70
    v_add_f32 v55, v55, v71
    v_add_f32 v56, v56, v72
    v_add_f32 v57, v57, v73
    v_add_f32 v58, v58, v74
    v_add_f32 v59, v59, v75
    v_add_f32 v60, v60, v76
    v_add_f32 v61, v61, v77
    v_add_f32 v62, v62, v78
    v_add_f32 v63, v63, v79
    v_add_f32 v48, v48, v56
    v_add_f32 v49, v49, v57
    v_add_f32 v50, v50, v58
    v_add_f32 v51, v51, v59
    v_add_f32 v52, v52, v60
    v_add_f32 v53, v53, v61
    v_add_f32 v54, v54, v62
    v_add_f32 v55, v55, v63
    v_add_f32 v48, v48, v52
    v_add_f32 v49, v49, v53
    v_add_f32 v50, v50, v54
    v_add_f32 v51, v51, v55
    v_cvt_pk_bf16_f32 v80, v48, v49
    v_cvt_pk_bf16_f32 v81, v50, v51
    buffer_store_dwordx2 v[80:81], v19, s[8:11], s30 offen sc1
    s_barrier
    buffer_store_dwordx2 v[92:93], v19, s[8:11], s34 offen sc1
    s_mov_b64 exec, -1
    s_add_u32 s29, s29, 1
    s_add_u32 s44, s44, 131072
    s_add_u32 s45, s45, 131072
    s_add_u32 s55, s55, 2048
    s_add_u32 s48, s48, 10240
    s_cmp_eq_u32 s48, 61440
    s_cselect_b32 s48, 30720, s48
    s_branch L6s_w7l
L6_last:
    s_mov_b64 exec, -1
    s_cmp_lg_u32 s28, 6
    s_cbranch_scc1 Lmain_end0
    s_waitcnt vmcnt(0)
    s_mov_b64 exec, 1
    buffer_store_dword v16, v6, s[8:11], s55 offen sc1
    s_branch Lmain_end0
Lmain_end0:
    s_endpgm
Lm_b:
    s_sub_u32 s96, s24, 4
    s_mov_b32 s97, s28
    s_mov_b32 s98, s25
    s_mov_b32 s94, 0
    s_lshr_b32 s99, s98, 2
    s_lshl_b32 s12, s96, 3
    s_add_u32 s99, s99, s12
    s_bfe_u32 s100, s98, 0x10001
    s_add_u32 s100, s100, 1
    s_and_b32 s101, s98, 1
    s_mov_b32 s40, 0
    s_mov_b32 s41, 8
    s_and_b32 s42, s98, 3
    s_lshl_b32 s42, s42, 2
    s_add_u32 s42, s42, 125839360
Lb_proj:
    s_load_dwordx2 s[6:7], s[0:1], 0
    s_load_dwordx4 s[48:51], s[0:1], 16
    s_load_dwordx2 s[52:53], s[0:1], 32
    v_and_b32 v1, 63, v0
    v_lshrrev_b32 v2, 4, v1
    v_and_b32 v3, 15, v1
    v_lshlrev_b32 v14, 4, v1
    v_lshrrev_b32 v15, 3, v1
    v_and_b32 v11, 3, v15
    v_and_b32 v4, 7, v1
    v_xor_b32 v4, v4, v11
    v_lshlrev_b32 v15, 13, v15
    v_lshl_add_u32 v12, v4, 4, v15
    v_xor_b32 v4, 4, v4
    v_lshl_add_u32 v13, v4, 4, v15
    s_mul_i32 s37, s97, 655360
    s_lshl_b32 s32, s99, 8
    s_add_u32 s37, s37, s32
    s_lshl_b32 s32, s101, 7
    s_add_u32 s37, s37, s32
    s_mul_i32 s39, s97, 10240
    s_waitcnt lgkmcnt(0)
    s_mov_b32 s24, s6
    s_and_b32 s25, s7, 0xffff
    s_mov_b32 s26, 2621440
    s_mov_b32 s27, 0x00020000
    s_cmp_eq_u32 s100, 1
    s_cselect_b64 s[48:49], s[50:51], s[48:49]
    s_cmp_eq_u32 s100, 2
    s_cselect_b64 s[48:49], s[52:53], s[48:49]
    s_mov_b32 s12, s48
    s_and_b32 s13, s49, 0xffff
    s_mov_b32 s14, 5242880
    s_mov_b32 s15, 0x00020000
    s_add_u32 m0, s39, 0
    s_add_u32 s32, s37, 0
    buffer_load_dwordx4 v12, s[12:15], s32 offen lds
    s_add_u32 m0, s39, 1024
    s_add_u32 s32, s37, 65536
    buffer_load_dwordx4 v13, s[12:15], s32 offen lds
    s_add_u32 m0, s39, 2048
    s_add_u32 s32, s37, 131072
    buffer_load_dwordx4 v12, s[12:15], s32 offen lds
    s_add_u32 m0, s39, 3072
    s_add_u32 s32, s37, 196608
    buffer_load_dwordx4 v13, s[12:15], s32 offen lds
    s_add_u32 m0, s39, 4096
    s_add_u32 s32, s37, 262144
    buffer_load_dwordx4 v12, s[12:15], s32 offen lds
    s_add_u32 m0, s39, 5120
    s_add_u32 s32, s37, 327680
    buffer_load_dwordx4 v13, s[12:15], s32 offen lds
    s_add_u32 m0, s39, 6144
    s_add_u32 s32, s37, 393216
    buffer_load_dwordx4 v12, s[12:15], s32 offen lds
    s_add_u32 m0, s39, 7168
    s_add_u32 s32, s37, 458752
    buffer_load_dwordx4 v13, s[12:15], s32 offen lds
    s_add_u32 m0, s39, 8192
    s_add_u32 s32, s37, 524288
    buffer_load_dwordx4 v12, s[12:15], s32 offen lds
    s_add_u32 m0, s39, 9216
    s_add_u32 s32, s37, 589824
    buffer_load_dwordx4 v13, s[12:15], s32 offen lds
    v_mul_u32_u24 v10, 1280, v3
    v_lshl_add_u32 v10, v2, 4, v10
    s_add_u32 s31, s40, s97
    s_or_b32 s57, s94, s59
    s_cmp_lg_u32 s57, 0
    s_cbranch_scc1 Lxl_116
    s_cmp_lg_u32 s97, 7
    s_cbranch_scc1 Lxl_115
    s_load_dwordx2 s[88:89], s[0:1], 144
    v_and_b32 v240, 63, v0
    v_and_b32 v241, 7, v240
    v_lshlrev_b32 v241, 2, v241
    s_waitcnt lgkmcnt(0)
    s_mov_b32 s4, s88
    s_and_b32 s5, s89, 0xffff
    s_mov_b32 s6, 256
    s_mov_b32 s7, 0x00020000
    s_mov_b32 s90, 0
    s_mov_b64 exec, 0xffff
Lv_117:
    buffer_load_dword v243, v241, s[4:7], 0 offen offset:128 sc1
    buffer_load_dword v242, v241, s[4:7], 0 offen sc1
    s_waitcnt vmcnt(0)
    s_nop 1
    v_add_u32_dpp v243, v243, v243 row_ror:4 row_mask:0xf bank_mask:0xf
    s_nop 1
    v_add_u32_dpp v243, v243, v243 row_ror:2 row_mask:0xf bank_mask:0xf
    s_nop 1
    v_add_u32_dpp v243, v243, v243 row_ror:1 row_mask:0xf bank_mask:0xf
    s_nop 0
    v_readlane_b32 s91, v243, 0
    s_add_u32 s90, s90, 1
    s_cmp_ge_u32 s91, 256
    s_cbranch_scc1 Lvd_118
    s_sleep 2
    s_cmp_lt_u32 s90, 4194304
    s_cbranch_scc1 Lv_117
Lvd_118:
    v_cmp_ne_u32 vcc, 32, v242
    s_mov_b32 s92, 0
    s_cbranch_vccz Lvo_119
    buffer_load_dword v242, v241, s[4:7], 0 offen sc1
    s_waitcnt vmcnt(0)
    v_cmp_ne_u32 vcc, 32, v242
    s_cbranch_vccz Lvo_119
    s_mov_b32 s92, 1
Lvo_119:
    v_cmp_gt_u32 vcc, s83, v240
    s_nop 1
    v_cndmask_b32 v243, 0, v242, vcc
    s_nop 1
    v_add_u32_dpp v243, v243, v243 row_ror:8 row_mask:0xf bank_mask:0xf
    s_nop 1
    v_add_u32_dpp v243, v243, v243 row_ror:4 row_mask:0xf bank_mask:0xf
    s_nop 1
    v_add_u32_dpp v243, v243, v243 row_ror:2 row_mask:0xf bank_mask:0xf
    s_nop 1
    v_add_u32_dpp v243, v243, v243 row_ror:1 row_mask:0xf bank_mask:0xf
    s_nop 0
    v_readlane_b32 s91, v243, 0
    s_nop 3
    s_add_u32 s91, s91, s84
    s_mov_b64 exec, 1
    v_mov_b32 v244, s92
    v_mov_b32 v245, s91
    v_mov_b32 v246, 0
    v_mov_b32 v240, 163776
    ds_write_b96 v240, v[244:246]
    s_waitcnt lgkmcnt(0)
    s_mov_b64 exec, -1
Lxl_115:
    s_waitcnt vmcnt(0)
    s_barrier
    v_mov_b32 v254, 163776
    ds_read_b64 v[252:253], v254
    s_waitcnt lgkmcnt(0)
    v_readfirstlane_b32 s92, v252
    v_readfirstlane_b32 s91, v253
    s_nop 3
    s_cmp_lg_u32 s92, 0
    s_cbranch_scc1 Lm_restart
    s_cmp_lt_u32 s97, 8
    s_cbranch_scc1 Lxl_116
    s_sleep 10
Lxl_116:
    s_mul_i32 s44, s31, 40960
    s_add_u32 s44, s44, 121634816
    s_add_u32 s33, s44, 0
    s_add_u32 s47, s44, 20480
    buffer_load_dwordx4 v[88:91], v14, s[8:11], s33 offen offset:0
    buffer_load_dwordx4 v[92:95], v14, s[8:11], s47 offen offset:0
    buffer_load_dwordx4 v[96:99], v14, s[8:11], s33 offen offset:1024
    buffer_load_dwordx4 v[100:103], v14, s[8:11], s47 offen offset:1024
    buffer_load_dwordx4 v[104:107], v14, s[8:11], s33 offen offset:2048
    buffer_load_dwordx4 v[108:111], v14, s[8:11], s47 offen offset:2048
    buffer_load_dwordx4 v[112:115], v14, s[8:11], s33 offen offset:3072
    buffer_load_dwordx4 v[116:119], v14, s[8:11], s47 offen offset:3072
    s_add_u32 s33, s44, 4096
    s_add_u32 s47, s44, 24576
    buffer_load_dwordx4 v[120:123], v14, s[8:11], s33 offen offset:0
    buffer_load_dwordx4 v[124:127], v14, s[8:11], s47 offen offset:0
    buffer_load_dwordx4 v[128:131], v14, s[8:11], s33 offen offset:1024
    buffer_load_dwordx4 v[132:135], v14, s[8:11], s47 offen offset:1024
    buffer_load_dwordx4 v[136:139], v14, s[8:11], s33 offen offset:2048
    buffer_load_dwordx4 v[140:143], v14, s[8:11], s47 offen offset:2048
    buffer_load_dwordx4 v[144:147], v14, s[8:11], s33 offen offset:3072
    buffer_load_dwordx4 v[148:151], v14, s[8:11], s47 offen offset:3072
    s_add_u32 s33, s44, 8192
    s_add_u32 s47, s44, 28672
    buffer_load_dwordx4 v[152:155], v14, s[8:11], s33 offen offset:0
    buffer_load_dwordx4 v[156:159], v14, s[8:11], s47 offen offset:0
    buffer_load_dwordx4 v[160:163], v14, s[8:11], s33 offen offset:1024
    buffer_load_dwordx4 v[164:167], v14, s[8:11], s47 offen offset:1024
    buffer_load_dwordx4 v[168:171], v14, s[8:11], s33 offen offset:2048
    buffer_load_dwordx4 v[172:175], v14, s[8:11], s47 offen offset:2048
    buffer_load_dwordx4 v[176:179], v14, s[8:11], s33 offen offset:3072
    buffer_load_dwordx4 v[180:183], v14, s[8:11], s47 offen offset:3072
    s_add_u32 s33, s44, 12288
    s_add_u32 s47, s44, 32768
    buffer_load_dwordx4 v[184:187], v14, s[8:11], s33 offen offset:0
    buffer_load_dwordx4 v[188:191], v14, s[8:11], s47 offen offset:0
    buffer_load_dwordx4 v[192:195], v14, s[8:11], s33 offen offset:1024
    buffer_load_dwordx4 v[196:199], v14, s[8:11], s47 offen offset:1024
    buffer_load_dwordx4 v[200:203], v14, s[8:11], s33 offen offset:2048
    buffer_load_dwordx4 v[204:207], v14, s[8:11], s47 offen offset:2048
    buffer_load_dwordx4 v[208:211], v14, s[8:11], s33 offen offset:3072
    buffer_load_dwordx4 v[212:215], v14, s[8:11], s47 offen offset:3072
    s_add_u32 s33, s44, 16384
    s_add_u32 s47, s44, 36864
    buffer_load_dwordx4 v[216:219], v14, s[8:11], s33 offen offset:0
    buffer_load_dwordx4 v[220:223], v14, s[8:11], s47 offen offset:0
    buffer_load_dwordx4 v[224:227], v14, s[8:11], s33 offen offset:1024
    buffer_load_dwordx4 v[228:231], v14, s[8:11], s47 offen offset:1024
    buffer_load_dwordx4 v[232:235], v14, s[8:11], s33 offen offset:2048
    buffer_load_dwordx4 v[236:239], v14, s[8:11], s47 offen offset:2048
    buffer_load_dwordx4 v[240:243], v14, s[8:11], s33 offen offset:3072
    buffer_load_dwordx4 v[244:247], v14, s[8:11], s47 offen offset:3072
    v_lshrrev_b32 v15, 2, v3
    v_and_b32 v4, 1, v2
    v_lshl_or_b32 v4, v4, 2, v15
    v_lshl_add_u32 v5, v2, 3, v15
    v_lshlrev_b32 v5, 7, v5
    v_and_b32 v6, 1, v3
    v_lshl_add_u32 v5, v6, 3, v5
    v_bfe_u32 v6, v3, 1, 1
    v_or_b32 v7, 0, v6
    v_xor_b32 v7, v7, v4
    v_lshl_add_u32 v16, v7, 4, v5
    v_add_u32 v20, 40960, v16
    v_or_b32 v7, 2, v6
    v_xor_b32 v7, v7, v4
    v_lshl_add_u32 v17, v7, 4, v5
    v_add_u32 v21, 40960, v17
    v_or_b32 v7, 4, v6
    v_xor_b32 v7, v7, v4
    v_lshl_add_u32 v18, v7, 4, v5
    v_add_u32 v22, 40960, v18
    v_or_b32 v7, 6, v6
    v_xor_b32 v7, v7, v4
    v_lshl_add_u32 v19, v7, 4, v5
    v_add_u32 v23, 40960, v19
    s_mov_b32 s43, 0
    s_cmp_eq_u32 s57, 0
    s_cbranch_scc1 Lxl_120
    s_waitcnt vmcnt(40)
    s_barrier
Lxl_120:
    v_mov_b32 v8, 1
    v_mov_b32 v9, 0
    s_lshl_b32 s46, s96, 5
    s_add_u32 s46, s46, s98
    s_lshl_b32 s46, s46, 3
    s_add_u32 s46, s46, s97
    s_lshl_b32 s46, s46, 7
    s_add_u32 s46, s46, 95420416
    s_cmp_eq_u32 s100, 2
    s_cbranch_scc1 Lpv_121
    s_cmp_ge_u32 s97, 8
    s_cbranch_scc1 Lpj1_123
    s_cmp_lg_u32 s94, 0
    s_cbranch_scc1 Lpj1_123
    ds_read_b64_tr_b16 v[24:25], v16 offset:0
    ds_read_b64_tr_b16 v[26:27], v16 offset:512
    ds_read_b64_tr_b16 v[28:29], v17 offset:0
    ds_read_b64_tr_b16 v[30:31], v17 offset:512
    ds_read_b64_tr_b16 v[32:33], v18 offset:0
    ds_read_b64_tr_b16 v[34:35], v18 offset:512
    ds_read_b64_tr_b16 v[36:37], v19 offset:0
    ds_read_b64_tr_b16 v[38:39], v19 offset:512
    s_lshl_b32 s38, s31, 5
    s_add_u32 s38, s38, s99
    s_lshl_b32 s45, s38, 6
    s_add_u32 s45, s45, s42
    s_lshl_b32 s38, s38, 13
    s_lshl_b32 s33, s100, 24
    s_add_u32 s38, s38, s33
    s_lshl_b32 s33, s101, 11
    s_add_u32 s38, s38, s33
    s_add_u32 s43, s43, 1
    s_add_u32 s33, s31, 8
    s_cmp_ge_u32 s43, s41
    s_cselect_b32 s31, s31, s33
    s_mul_i32 s44, s31, 40960
    s_add_u32 s44, s44, 121634816
    ds_read_b64_tr_b16 v[40:41], v16 offset:4096
    ds_read_b64_tr_b16 v[42:43], v16 offset:4608
    ds_read_b64_tr_b16 v[44:45], v17 offset:4096
    ds_read_b64_tr_b16 v[46:47], v17 offset:4608
    ds_read_b64_tr_b16 v[48:49], v18 offset:4096
    ds_read_b64_tr_b16 v[50:51], v18 offset:4608
    ds_read_b64_tr_b16 v[52:53], v19 offset:4096
    ds_read_b64_tr_b16 v[54:55], v19 offset:4608
    s_waitcnt vmcnt(38) lgkmcnt(8)
    v_mfma_f32_16x16x32_bf16 v[56:59], v[24:27], v[88:91], 0
    v_mfma_f32_16x16x32_bf16 v[60:63], v[24:27], v[92:95], 0
    v_mfma_f32_16x16x32_bf16 v[64:67], v[28:31], v[88:91], 0
    v_mfma_f32_16x16x32_bf16 v[68:71], v[28:31], v[92:95], 0
    v_mfma_f32_16x16x32_bf16 v[72:75], v[32:35], v[88:91], 0
    v_mfma_f32_16x16x32_bf16 v[76:79], v[32:35], v[92:95], 0
    v_mfma_f32_16x16x32_bf16 v[80:83], v[36:39], v[88:91], 0
    v_mfma_f32_16x16x32_bf16 v[84:87], v[36:39], v[92:95], 0
    ds_read_b64_tr_b16 v[24:25], v16 offset:8192
    ds_read_b64_tr_b16 v[26:27], v16 offset:8704
    ds_read_b64_tr_b16 v[28:29], v17 offset:8192
    ds_read_b64_tr_b16 v[30:31], v17 offset:8704
    ds_read_b64_tr_b16 v[32:33], v18 offset:8192
    ds_read_b64_tr_b16 v[34:35], v18 offset:8704
    ds_read_b64_tr_b16 v[36:37], v19 offset:8192
    ds_read_b64_tr_b16 v[38:39], v19 offset:8704
    s_waitcnt vmcnt(36) lgkmcnt(8)
    v_mfma_f32_16x16x32_bf16 v[56:59], v[40:43], v[96:99], v[56:59]
    v_mfma_f32_16x16x32_bf16 v[60:63], v[40:43], v[100:103], v[60:63]
    v_mfma_f32_16x16x32_bf16 v[64:67], v[44:47], v[96:99], v[64:67]
    v_mfma_f32_16x16x32_bf16 v[68:71], v[44:47], v[100:103], v[68:71]
    v_mfma_f32_16x16x32_bf16 v[72:75], v[48:51], v[96:99], v[72:75]
    v_mfma_f32_16x16x32_bf16 v[76:79], v[48:51], v[100:103], v[76:79]
    v_mfma_f32_16x16x32_bf16 v[80:83], v[52:55], v[96:99], v[80:83]
    v_mfma_f32_16x16x32_bf16 v[84:87], v[52:55], v[100:103], v[84:87]
    ds_read_b64_tr_b16 v[40:41], v16 offset:12288
    ds_read_b64_tr_b16 v[42:43], v16 offset:12800
    ds_read_b64_tr_b16 v[44:45], v17 offset:12288
    ds_read_b64_tr_b16 v[46:47], v17 offset:12800
    ds_read_b64_tr_b16 v[48:49], v18 offset:12288
    ds_read_b64_tr_b16 v[50:51], v18 offset:12800
    ds_read_b64_tr_b16 v[52:53], v19 offset:12288
    ds_read_b64_tr_b16 v[54:55], v19 offset:12800
    s_waitcnt vmcnt(34) lgkmcnt(8)
    v_mfma_f32_16x16x32_bf16 v[56:59], v[24:27], v[104:107], v[56:59]
    v_mfma_f32_16x16x32_bf16 v[60:63], v[24:27], v[108:111], v[60:63]
    v_mfma_f32_16x16x32_bf16 v[64:67], v[28:31], v[104:107], v[64:67]
    v_mfma_f32_16x16x32_bf16 v[68:71], v[28:31], v[108:111], v[68:71]
    v_mfma_f32_16x16x32_bf16 v[72:75], v[32:35], v[104:107], v[72:75]
    v_mfma_f32_16x16x32_bf16 v[76:79], v[32:35], v[108:111], v[76:79]
    v_mfma_f32_16x16x32_bf16 v[80:83], v[36:39], v[104:107], v[80:83]
    v_mfma_f32_16x16x32_bf16 v[84:87], v[36:39], v[108:111], v[84:87]
    ds_read_b64_tr_b16 v[24:25], v16 offset:16384
    ds_read_b64_tr_b16 v[26:27], v16 offset:16896
    ds_read_b64_tr_b16 v[28:29], v17 offset:16384
    ds_read_b64_tr_b16 v[30:31], v17 offset:16896
    ds_read_b64_tr_b16 v[32:33], v18 offset:16384
    ds_read_b64_tr_b16 v[34:35], v18 offset:16896
    ds_read_b64_tr_b16 v[36:37], v19 offset:16384
    ds_read_b64_tr_b16 v[38:39], v19 offset:16896
    s_waitcnt vmcnt(32) lgkmcnt(8)
    v_mfma_f32_16x16x32_bf16 v[56:59], v[40:43], v[112:115], v[56:59]
    v_mfma_f32_16x16x32_bf16 v[60:63], v[40:43], v[116:119], v[60:63]
    v_mfma_f32_16x16x32_bf16 v[64:67], v[44:47], v[112:115], v[64:67]
    v_mfma_f32_16x16x32_bf16 v[68:71], v[44:47], v[116:119], v[68:71]
    v_mfma_f32_16x16x32_bf16 v[72:75], v[48:51], v[112:115], v[72:75]
    v_mfma_f32_16x16x32_bf16 v[76:79], v[48:51], v[116:119], v[76:79]
    v_mfma_f32_16x16x32_bf16 v[80:83], v[52:55], v[112:115], v[80:83]
    v_mfma_f32_16x16x32_bf16 v[84:87], v[52:55], v[116:119], v[84:87]
    ds_read_b64_tr_b16 v[40:41], v16 offset:20480
    ds_read_b64_tr_b16 v[42:43], v16 offset:20992
    ds_read_b64_tr_b16 v[44:45], v17 offset:20480
    ds_read_b64_tr_b16 v[46:47], v17 offset:20992
    ds_read_b64_tr_b16 v[48:49], v18 offset:20480
    ds_read_b64_tr_b16 v[50:51], v18 offset:20992
    ds_read_b64_tr_b16 v[52:53], v19 offset:20480
    ds_read_b64_tr_b16 v[54:55], v19 offset:20992
    s_waitcnt vmcnt(30) lgkmcnt(8)
    v_mfma_f32_16x16x32_bf16 v[56:59], v[24:27], v[120:123], v[56:59]
    v_mfma_f32_16x16x32_bf16 v[60:63], v[24:27], v[124:127], v[60:63]
    v_mfma_f32_16x16x32_bf16 v[64:67], v[28:31], v[120:123], v[64:67]
    v_mfma_f32_16x16x32_bf16 v[68:71], v[28:31], v[124:127], v[68:71]
    v_mfma_f32_16x16x32_bf16 v[72:75], v[32:35], v[120:123], v[72:75]
    v_mfma_f32_16x16x32_bf16 v[76:79], v[32:35], v[124:127], v[76:79]
    v_mfma_f32_16x16x32_bf16 v[80:83], v[36:39], v[120:123], v[80:83]
    v_mfma_f32_16x16x32_bf16 v[84:87], v[36:39], v[124:127], v[84:87]
    ds_read_b64_tr_b16 v[24:25], v16 offset:24576
    ds_read_b64_tr_b16 v[26:27], v16 offset:25088
    ds_read_b64_tr_b16 v[28:29], v17 offset:24576
    ds_read_b64_tr_b16 v[30:31], v17 offset:25088
    ds_read_b64_tr_b16 v[32:33], v18 offset:24576
    ds_read_b64_tr_b16 v[34:35], v18 offset:25088
    ds_read_b64_tr_b16 v[36:37], v19 offset:24576
    ds_read_b64_tr_b16 v[38:39], v19 offset:25088
    s_waitcnt vmcnt(28) lgkmcnt(8)
    v_mfma_f32_16x16x32_bf16 v[56:59], v[40:43], v[128:131], v[56:59]
    v_mfma_f32_16x16x32_bf16 v[60:63], v[40:43], v[132:135], v[60:63]
    v_mfma_f32_16x16x32_bf16 v[64:67], v[44:47], v[128:131], v[64:67]
    v_mfma_f32_16x16x32_bf16 v[68:71], v[44:47], v[132:135], v[68:71]
    v_mfma_f32_16x16x32_bf16 v[72:75], v[48:51], v[128:131], v[72:75]
    v_mfma_f32_16x16x32_bf16 v[76:79], v[48:51], v[132:135], v[76:79]
    v_mfma_f32_16x16x32_bf16 v[80:83], v[52:55], v[128:131], v[80:83]
    v_mfma_f32_16x16x32_bf16 v[84:87], v[52:55], v[132:135], v[84:87]
    ds_read_b64_tr_b16 v[40:41], v16 offset:28672
    ds_read_b64_tr_b16 v[42:43], v16 offset:29184
    ds_read_b64_tr_b16 v[44:45], v17 offset:28672
    ds_read_b64_tr_b16 v[46:47], v17 offset:29184
    ds_read_b64_tr_b16 v[48:49], v18 offset:28672
    ds_read_b64_tr_b16 v[50:51], v18 offset:29184
    ds_read_b64_tr_b16 v[52:53], v19 offset:28672
    ds_read_b64_tr_b16 v[54:55], v19 offset:29184
    s_waitcnt vmcnt(26) lgkmcnt(8)
    v_mfma_f32_16x16x32_bf16 v[56:59], v[24:27], v[136:139], v[56:59]
    v_mfma_f32_16x16x32_bf16 v[60:63], v[24:27], v[140:143], v[60:63]
    v_mfma_f32_16x16x32_bf16 v[64:67], v[28:31], v[136:139], v[64:67]
    v_mfma_f32_16x16x32_bf16 v[68:71], v[28:31], v[140:143], v[68:71]
    v_mfma_f32_16x16x32_bf16 v[72:75], v[32:35], v[136:139], v[72:75]
    v_mfma_f32_16x16x32_bf16 v[76:79], v[32:35], v[140:143], v[76:79]
    v_mfma_f32_16x16x32_bf16 v[80:83], v[36:39], v[136:139], v[80:83]
    v_mfma_f32_16x16x32_bf16 v[84:87], v[36:39], v[140:143], v[84:87]
    ds_read_b64_tr_b16 v[24:25], v16 offset:32768
    ds_read_b64_tr_b16 v[26:27], v16 offset:33280
    ds_read_b64_tr_b16 v[28:29], v17 offset:32768
    ds_read_b64_tr_b16 v[30:31], v17 offset:33280
    ds_read_b64_tr_b16 v[32:33], v18 offset:32768
    ds_read_b64_tr_b16 v[34:35], v18 offset:33280
    ds_read_b64_tr_b16 v[36:37], v19 offset:32768
    ds_read_b64_tr_b16 v[38:39], v19 offset:33280
    s_waitcnt vmcnt(24) lgkmcnt(8)
    v_mfma_f32_16x16x32_bf16 v[56:59], v[40:43], v[144:147], v[56:59]
    v_mfma_f32_16x16x32_bf16 v[60:63], v[40:43], v[148:151], v[60:63]
    v_mfma_f32_16x16x32_bf16 v[64:67], v[44:47], v[144:147], v[64:67]
    v_mfma_f32_16x16x32_bf16 v[68:71], v[44:47], v[148:151], v[68:71]
    v_mfma_f32_16x16x32_bf16 v[72:75], v[48:51], v[144:147], v[72:75]
    v_mfma_f32_16x16x32_bf16 v[76:79], v[48:51], v[148:151], v[76:79]
    v_mfma_f32_16x16x32_bf16 v[80:83], v[52:55], v[144:147], v[80:83]
    v_mfma_f32_16x16x32_bf16 v[84:87], v[52:55], v[148:151], v[84:87]
    ds_read_b64_tr_b16 v[40:41], v16 offset:36864
    ds_read_b64_tr_b16 v[42:43], v16 offset:37376
    ds_read_b64_tr_b16 v[44:45], v17 offset:36864
    ds_read_b64_tr_b16 v[46:47], v17 offset:37376
    ds_read_b64_tr_b16 v[48:49], v18 offset:36864
    ds_read_b64_tr_b16 v[50:51], v18 offset:37376
    ds_read_b64_tr_b16 v[52:53], v19 offset:36864
    ds_read_b64_tr_b16 v[54:55], v19 offset:37376
    s_waitcnt vmcnt(22) lgkmcnt(8)
    v_mfma_f32_16x16x32_bf16 v[56:59], v[24:27], v[152:155], v[56:59]
    v_mfma_f32_16x16x32_bf16 v[60:63], v[24:27], v[156:159], v[60:63]
    v_mfma_f32_16x16x32_bf16 v[64:67], v[28:31], v[152:155], v[64:67]
    v_mfma_f32_16x16x32_bf16 v[68:71], v[28:31], v[156:159], v[68:71]
    v_mfma_f32_16x16x32_bf16 v[72:75], v[32:35], v[152:155], v[72:75]
    v_mfma_f32_16x16x32_bf16 v[76:79], v[32:35], v[156:159], v[76:79]
    v_mfma_f32_16x16x32_bf16 v[80:83], v[36:39], v[152:155], v[80:83]
    v_mfma_f32_16x16x32_bf16 v[84:87], v[36:39], v[156:159], v[84:87]
    ds_read_b64_tr_b16 v[24:25], v20 offset:0
    ds_read_b64_tr_b16 v[26:27], v20 offset:512
    ds_read_b64_tr_b16 v[28:29], v21 offset:0
    ds_read_b64_tr_b16 v[30:31], v21 offset:512
    ds_read_b64_tr_b16 v[32:33], v22 offset:0
    ds_read_b64_tr_b16 v[34:35], v22 offset:512
    ds_read_b64_tr_b16 v[36:37], v23 offset:0
    ds_read_b64_tr_b16 v[38:39], v23 offset:512
    s_waitcnt vmcnt(20) lgkmcnt(8)
    v_mfma_f32_16x16x32_bf16 v[56:59], v[40:43], v[160:163], v[56:59]
    v_mfma_f32_16x16x32_bf16 v[60:63], v[40:43], v[164:167], v[60:63]
    v_mfma_f32_16x16x32_bf16 v[64:67], v[44:47], v[160:163], v[64:67]
    v_mfma_f32_16x16x32_bf16 v[68:71], v[44:47], v[164:167], v[68:71]
    v_mfma_f32_16x16x32_bf16 v[72:75], v[48:51], v[160:163], v[72:75]
    v_mfma_f32_16x16x32_bf16 v[76:79], v[48:51], v[164:167], v[76:79]
    v_mfma_f32_16x16x32_bf16 v[80:83], v[52:55], v[160:163], v[80:83]
    v_mfma_f32_16x16x32_bf16 v[84:87], v[52:55], v[164:167], v[84:87]
    ds_read_b64_tr_b16 v[40:41], v20 offset:4096
    ds_read_b64_tr_b16 v[42:43], v20 offset:4608
    ds_read_b64_tr_b16 v[44:45], v21 offset:4096
    ds_read_b64_tr_b16 v[46:47], v21 offset:4608
    ds_read_b64_tr_b16 v[48:49], v22 offset:4096
    ds_read_b64_tr_b16 v[50:51], v22 offset:4608
    ds_read_b64_tr_b16 v[52:53], v23 offset:4096
    ds_read_b64_tr_b16 v[54:55], v23 offset:4608
    s_waitcnt vmcnt(18) lgkmcnt(8)
    v_mfma_f32_16x16x32_bf16 v[56:59], v[24:27], v[168:171], v[56:59]
    v_mfma_f32_16x16x32_bf16 v[60:63], v[24:27], v[172:175], v[60:63]
    v_mfma_f32_16x16x32_bf16 v[64:67], v[28:31], v[168:171], v[64:67]
    v_mfma_f32_16x16x32_bf16 v[68:71], v[28:31], v[172:175], v[68:71]
    v_mfma_f32_16x16x32_bf16 v[72:75], v[32:35], v[168:171], v[72:75]
    v_mfma_f32_16x16x32_bf16 v[76:79], v[32:35], v[172:175], v[76:79]
    v_mfma_f32_16x16x32_bf16 v[80:83], v[36:39], v[168:171], v[80:83]
    v_mfma_f32_16x16x32_bf16 v[84:87], v[36:39], v[172:175], v[84:87]
    ds_read_b64_tr_b16 v[24:25], v20 offset:8192
    ds_read_b64_tr_b16 v[26:27], v20 offset:8704
    ds_read_b64_tr_b16 v[28:29], v21 offset:8192
    ds_read_b64_tr_b16 v[30:31], v21 offset:8704
    ds_read_b64_tr_b16 v[32:33], v22 offset:8192
    ds_read_b64_tr_b16 v[34:35], v22 offset:8704
    ds_read_b64_tr_b16 v[36:37], v23 offset:8192
    ds_read_b64_tr_b16 v[38:39], v23 offset:8704
    s_waitcnt vmcnt(16) lgkmcnt(8)
    v_mfma_f32_16x16x32_bf16 v[56:59], v[40:43], v[176:179], v[56:59]
    v_mfma_f32_16x16x32_bf16 v[60:63], v[40:43], v[180:183], v[60:63]
    v_mfma_f32_16x16x32_bf16 v[64:67], v[44:47], v[176:179], v[64:67]
    v_mfma_f32_16x16x32_bf16 v[68:71], v[44:47], v[180:183], v[68:71]
    v_mfma_f32_16x16x32_bf16 v[72:75], v[48:51], v[176:179], v[72:75]
    v_mfma_f32_16x16x32_bf16 v[76:79], v[48:51], v[180:183], v[76:79]
    v_mfma_f32_16x16x32_bf16 v[80:83], v[52:55], v[176:179], v[80:83]
    v_mfma_f32_16x16x32_bf16 v[84:87], v[52:55], v[180:183], v[84:87]
    ds_read_b64_tr_b16 v[40:41], v20 offset:12288
    ds_read_b64_tr_b16 v[42:43], v20 offset:12800
    ds_read_b64_tr_b16 v[44:45], v21 offset:12288
    ds_read_b64_tr_b16 v[46:47], v21 offset:12800
    ds_read_b64_tr_b16 v[48:49], v22 offset:12288
    ds_read_b64_tr_b16 v[50:51], v22 offset:12800
    ds_read_b64_tr_b16 v[52:53], v23 offset:12288
    ds_read_b64_tr_b16 v[54:55], v23 offset:12800
    s_waitcnt vmcnt(14) lgkmcnt(8)
    v_mfma_f32_16x16x32_bf16 v[56:59], v[24:27], v[184:187], v[56:59]
    v_mfma_f32_16x16x32_bf16 v[60:63], v[24:27], v[188:191], v[60:63]
    v_mfma_f32_16x16x32_bf16 v[64:67], v[28:31], v[184:187], v[64:67]
    v_mfma_f32_16x16x32_bf16 v[68:71], v[28:31], v[188:191], v[68:71]
    v_mfma_f32_16x16x32_bf16 v[72:75], v[32:35], v[184:187], v[72:75]
    v_mfma_f32_16x16x32_bf16 v[76:79], v[32:35], v[188:191], v[76:79]
    v_mfma_f32_16x16x32_bf16 v[80:83], v[36:39], v[184:187], v[80:83]
    v_mfma_f32_16x16x32_bf16 v[84:87], v[36:39], v[188:191], v[84:87]
    ds_read_b64_tr_b16 v[24:25], v20 offset:16384
    ds_read_b64_tr_b16 v[26:27], v20 offset:16896
    ds_read_b64_tr_b16 v[28:29], v21 offset:16384
    ds_read_b64_tr_b16 v[30:31], v21 offset:16896
    ds_read_b64_tr_b16 v[32:33], v22 offset:16384
    ds_read_b64_tr_b16 v[34:35], v22 offset:16896
    ds_read_b64_tr_b16 v[36:37], v23 offset:16384
    ds_read_b64_tr_b16 v[38:39], v23 offset:16896
    s_waitcnt vmcnt(12) lgkmcnt(8)
    v_mfma_f32_16x16x32_bf16 v[56:59], v[40:43], v[192:195], v[56:59]
    v_mfma_f32_16x16x32_bf16 v[60:63], v[40:43], v[196:199], v[60:63]
    v_mfma_f32_16x16x32_bf16 v[64:67], v[44:47], v[192:195], v[64:67]
    v_mfma_f32_16x16x32_bf16 v[68:71], v[44:47], v[196:199], v[68:71]
    v_mfma_f32_16x16x32_bf16 v[72:75], v[48:51], v[192:195], v[72:75]
    v_mfma_f32_16x16x32_bf16 v[76:79], v[48:51], v[196:199], v[76:79]
    v_mfma_f32_16x16x32_bf16 v[80:83], v[52:55], v[192:195], v[80:83]
    v_mfma_f32_16x16x32_bf16 v[84:87], v[52:55], v[196:199], v[84:87]
    ds_read_b64_tr_b16 v[40:41], v20 offset:20480
    ds_read_b64_tr_b16 v[42:43], v20 offset:20992
    ds_read_b64_tr_b16 v[44:45], v21 offset:20480
    ds_read_b64_tr_b16 v[46:47], v21 offset:20992
    ds_read_b64_tr_b16 v[48:49], v22 offset:20480
    ds_read_b64_tr_b16 v[50:51], v22 offset:20992
    ds_read_b64_tr_b16 v[52:53], v23 offset:20480
    ds_read_b64_tr_b16 v[54:55], v23 offset:20992
    s_waitcnt vmcnt(10) lgkmcnt(8)
    v_mfma_f32_16x16x32_bf16 v[56:59], v[24:27], v[200:203], v[56:59]
    v_mfma_f32_16x16x32_bf16 v[60:63], v[24:27], v[204:207], v[60:63]
    v_mfma_f32_16x16x32_bf16 v[64:67], v[28:31], v[200:203], v[64:67]
    v_mfma_f32_16x16x32_bf16 v[68:71], v[28:31], v[204:207], v[68:71]
    v_mfma_f32_16x16x32_bf16 v[72:75], v[32:35], v[200:203], v[72:75]
    v_mfma_f32_16x16x32_bf16 v[76:79], v[32:35], v[204:207], v[76:79]
    v_mfma_f32_16x16x32_bf16 v[80:83], v[36:39], v[200:203], v[80:83]
    v_mfma_f32_16x16x32_bf16 v[84:87], v[36:39], v[204:207], v[84:87]
    ds_read_b64_tr_b16 v[24:25], v20 offset:24576
    ds_read_b64_tr_b16 v[26:27], v20 offset:25088
    ds_read_b64_tr_b16 v[28:29], v21 offset:24576
    ds_read_b64_tr_b16 v[30:31], v21 offset:25088
    ds_read_b64_tr_b16 v[32:33], v22 offset:24576
    ds_read_b64_tr_b16 v[34:35], v22 offset:25088
    ds_read_b64_tr_b16 v[36:37], v23 offset:24576
    ds_read_b64_tr_b16 v[38:39], v23 offset:25088
    s_waitcnt vmcnt(8) lgkmcnt(8)
    v_mfma_f32_16x16x32_bf16 v[56:59], v[40:43], v[208:211], v[56:59]
    v_mfma_f32_16x16x32_bf16 v[60:63], v[40:43], v[212:215], v[60:63]
    v_mfma_f32_16x16x32_bf16 v[64:67], v[44:47], v[208:211], v[64:67]
    v_mfma_f32_16x16x32_bf16 v[68:71], v[44:47], v[212:215], v[68:71]
    v_mfma_f32_16x16x32_bf16 v[72:75], v[48:51], v[208:211], v[72:75]
    v_mfma_f32_16x16x32_bf16 v[76:79], v[48:51], v[212:215], v[76:79]
    v_mfma_f32_16x16x32_bf16 v[80:83], v[52:55], v[208:211], v[80:83]
    v_mfma_f32_16x16x32_bf16 v[84:87], v[52:55], v[212:215], v[84:87]
    ds_read_b64_tr_b16 v[40:41], v20 offset:28672
    ds_read_b64_tr_b16 v[42:43], v20 offset:29184
    ds_read_b64_tr_b16 v[44:45], v21 offset:28672
    ds_read_b64_tr_b16 v[46:47], v21 offset:29184
    ds_read_b64_tr_b16 v[48:49], v22 offset:28672
    ds_read_b64_tr_b16 v[50:51], v22 offset:29184
    ds_read_b64_tr_b16 v[52:53], v23 offset:28672
    ds_read_b64_tr_b16 v[54:55], v23 offset:29184
    s_waitcnt vmcnt(6) lgkmcnt(8)
    v_mfma_f32_16x16x32_bf16 v[56:59], v[24:27], v[216:219], v[56:59]
    v_mfma_f32_16x16x32_bf16 v[60:63], v[24:27], v[220:223], v[60:63]
    v_mfma_f32_16x16x32_bf16 v[64:67], v[28:31], v[216:219], v[64:67]
    v_mfma_f32_16x16x32_bf16 v[68:71], v[28:31], v[220:223], v[68:71]
    v_mfma_f32_16x16x32_bf16 v[72:75], v[32:35], v[216:219], v[72:75]
    v_mfma_f32_16x16x32_bf16 v[76:79], v[32:35], v[220:223], v[76:79]
    v_mfma_f32_16x16x32_bf16 v[80:83], v[36:39], v[216:219], v[80:83]
    v_mfma_f32_16x16x32_bf16 v[84:87], v[36:39], v[220:223], v[84:87]
    ds_read_b64_tr_b16 v[24:25], v20 offset:32768
    ds_read_b64_tr_b16 v[26:27], v20 offset:33280
    ds_read_b64_tr_b16 v[28:29], v21 offset:32768
    ds_read_b64_tr_b16 v[30:31], v21 offset:33280
    ds_read_b64_tr_b16 v[32:33], v22 offset:32768
    ds_read_b64_tr_b16 v[34:35], v22 offset:33280
    ds_read_b64_tr_b16 v[36:37], v23 offset:32768
    ds_read_b64_tr_b16 v[38:39], v23 offset:33280
    s_waitcnt vmcnt(4) lgkmcnt(8)
    v_mfma_f32_16x16x32_bf16 v[56:59], v[40:43], v[224:227], v[56:59]
    v_mfma_f32_16x16x32_bf16 v[60:63], v[40:43], v[228:231], v[60:63]
    v_mfma_f32_16x16x32_bf16 v[64:67], v[44:47], v[224:227], v[64:67]
    v_mfma_f32_16x16x32_bf16 v[68:71], v[44:47], v[228:231], v[68:71]
    v_mfma_f32_16x16x32_bf16 v[72:75], v[48:51], v[224:227], v[72:75]
    v_mfma_f32_16x16x32_bf16 v[76:79], v[48:51], v[228:231], v[76:79]
    v_mfma_f32_16x16x32_bf16 v[80:83], v[52:55], v[224:227], v[80:83]
    v_mfma_f32_16x16x32_bf16 v[84:87], v[52:55], v[228:231], v[84:87]
    ds_read_b64_tr_b16 v[40:41], v20 offset:36864
    ds_read_b64_tr_b16 v[42:43], v20 offset:37376
    ds_read_b64_tr_b16 v[44:45], v21 offset:36864
    ds_read_b64_tr_b16 v[46:47], v21 offset:37376
    ds_read_b64_tr_b16 v[48:49], v22 offset:36864
    ds_read_b64_tr_b16 v[50:51], v22 offset:37376
    ds_read_b64_tr_b16 v[52:53], v23 offset:36864
    ds_read_b64_tr_b16 v[54:55], v23 offset:37376
    s_waitcnt vmcnt(2) lgkmcnt(8)
    v_mfma_f32_16x16x32_bf16 v[56:59], v[24:27], v[232:235], v[56:59]
    v_mfma_f32_16x16x32_bf16 v[60:63], v[24:27], v[236:239], v[60:63]
    v_mfma_f32_16x16x32_bf16 v[64:67], v[28:31], v[232:235], v[64:67]
    v_mfma_f32_16x16x32_bf16 v[68:71], v[28:31], v[236:239], v[68:71]
    v_mfma_f32_16x16x32_bf16 v[72:75], v[32:35], v[232:235], v[72:75]
    v_mfma_f32_16x16x32_bf16 v[76:79], v[32:35], v[236:239], v[76:79]
    v_mfma_f32_16x16x32_bf16 v[80:83], v[36:39], v[232:235], v[80:83]
    v_mfma_f32_16x16x32_bf16 v[84:87], v[36:39], v[236:239], v[84:87]
    s_waitcnt vmcnt(0) lgkmcnt(0)
    v_mfma_f32_16x16x32_bf16 v[56:59], v[40:43], v[240:243], v[56:59]
    v_mfma_f32_16x16x32_bf16 v[60:63], v[40:43], v[244:247], v[60:63]
    v_mfma_f32_16x16x32_bf16 v[64:67], v[44:47], v[240:243], v[64:67]
    v_mfma_f32_16x16x32_bf16 v[68:71], v[44:47], v[244:247], v[68:71]
    v_mfma_f32_16x16x32_bf16 v[72:75], v[48:51], v[240:243], v[72:75]
    v_mfma_f32_16x16x32_bf16 v[76:79], v[48:51], v[244:247], v[76:79]
    v_mfma_f32_16x16x32_bf16 v[80:83], v[52:55], v[240:243], v[80:83]
    v_mfma_f32_16x16x32_bf16 v[84:87], v[52:55], v[244:247], v[84:87]
    s_add_u32 s32, s38, 4096
    s_nop 4
    v_cvt_pk_bf16_f32 v24, v56, v57
    v_cvt_pk_bf16_f32 v25, v58, v59
    v_cvt_pk_bf16_f32 v26, v64, v65
    v_cvt_pk_bf16_f32 v27, v66, v67
    buffer_store_dwordx4 v[24:27], v14, s[8:11], s38 offen offset:0 sc1
    v_cvt_pk_bf16_f32 v28, v60, v61
    v_cvt_pk_bf16_f32 v29, v62, v63
    v_cvt_pk_bf16_f32 v30, v68, v69
    v_cvt_pk_bf16_f32 v31, v70, v71
    buffer_store_dwordx4 v[28:31], v14, s[8:11], s32 offen offset:0 sc1
    v_cvt_pk_bf16_f32 v32, v72, v73
    v_cvt_pk_bf16_f32 v33, v74, v75
    v_cvt_pk_bf16_f32 v34, v80, v81
    v_cvt_pk_bf16_f32 v35, v82, v83
    buffer_store_dwordx4 v[32:35], v14, s[8:11], s38 offen offset:1024 sc1
    v_cvt_pk_bf16_f32 v36, v76, v77
    v_cvt_pk_bf16_f32 v37, v78, v79
    v_cvt_pk_bf16_f32 v38, v84, v85
    v_cvt_pk_bf16_f32 v39, v86, v87
    buffer_store_dwordx4 v[36:39], v14, s[8:11], s32 offen offset:1024 sc1
    s_waitcnt vmcnt(0)
    s_mov_b64 exec, 1
    buffer_store_dword v8, v9, s[8:11], s45 offen sc1
    s_mov_b64 exec, -1
    s_mul_i32 s44, s31, 40960
    s_add_u32 s44, s44, 121634816
    s_add_u32 s33, s44, 0
    s_add_u32 s47, s44, 20480
    buffer_load_dwordx4 v[88:91], v14, s[8:11], s33 offen offset:0
    buffer_load_dwordx4 v[92:95], v14, s[8:11], s47 offen offset:0
    buffer_load_dwordx4 v[96:99], v14, s[8:11], s33 offen offset:1024
    buffer_load_dwordx4 v[100:103], v14, s[8:11], s47 offen offset:1024
    buffer_load_dwordx4 v[104:107], v14, s[8:11], s33 offen offset:2048
    buffer_load_dwordx4 v[108:111], v14, s[8:11], s47 offen offset:2048
    buffer_load_dwordx4 v[112:115], v14, s[8:11], s33 offen offset:3072
    buffer_load_dwordx4 v[116:119], v14, s[8:11], s47 offen offset:3072
    s_add_u32 s33, s44, 4096
    s_add_u32 s47, s44, 24576
    buffer_load_dwordx4 v[120:123], v14, s[8:11], s33 offen offset:0
    buffer_load_dwordx4 v[124:127], v14, s[8:11], s47 offen offset:0
    buffer_load_dwordx4 v[128:131], v14, s[8:11], s33 offen offset:1024
    buffer_load_dwordx4 v[132:135], v14, s[8:11], s47 offen offset:1024
    buffer_load_dwordx4 v[136:139], v14, s[8:11], s33 offen offset:2048
    buffer_load_dwordx4 v[140:143], v14, s[8:11], s47 offen offset:2048
    buffer_load_dwordx4 v[144:147], v14, s[8:11], s33 offen offset:3072
    buffer_load_dwordx4 v[148:151], v14, s[8:11], s47 offen offset:3072
    s_add_u32 s33, s44, 8192
    s_add_u32 s47, s44, 28672
    buffer_load_dwordx4 v[152:155], v14, s[8:11], s33 offen offset:0
    buffer_load_dwordx4 v[156:159], v14, s[8:11], s47 offen offset:0
    buffer_load_dwordx4 v[160:163], v14, s[8:11], s33 offen offset:1024
    buffer_load_dwordx4 v[164:167], v14, s[8:11], s47 offen offset:1024
    buffer_load_dwordx4 v[168:171], v14, s[8:11], s33 offen offset:2048
    buffer_load_dwordx4 v[172:175], v14, s[8:11], s47 offen offset:2048
    buffer_load_dwordx4 v[176:179], v14, s[8:11], s33 offen offset:3072
    buffer_load_dwordx4 v[180:183], v14, s[8:11], s47 offen offset:3072
    s_add_u32 s33, s44, 12288
    s_add_u32 s47, s44, 32768
    buffer_load_dwordx4 v[184:187], v14, s[8:11], s33 offen offset:0
    buffer_load_dwordx4 v[188:191], v14, s[8:11], s47 offen offset:0
    buffer_load_dwordx4 v[192:195], v14, s[8:11], s33 offen offset:1024
    buffer_load_dwordx4 v[196:199], v14, s[8:11], s47 offen offset:1024
    buffer_load_dwordx4 v[200:203], v14, s[8:11], s33 offen offset:2048
    buffer_load_dwordx4 v[204:207], v14, s[8:11], s47 offen offset:2048
    buffer_load_dwordx4 v[208:211], v14, s[8:11], s33 offen offset:3072
    buffer_load_dwordx4 v[212:215], v14, s[8:11], s47 offen offset:3072
    s_add_u32 s33, s44, 16384
    s_add_u32 s47, s44, 36864
    buffer_load_dwordx4 v[216:219], v14, s[8:11], s33 offen offset:0
    buffer_load_dwordx4 v[220:223], v14, s[8:11], s47 offen offset:0
    buffer_load_dwordx4 v[224:227], v14, s[8:11], s33 offen offset:1024
    buffer_load_dwordx4 v[228:231], v14, s[8:11], s47 offen offset:1024
    buffer_load_dwordx4 v[232:235], v14, s[8:11], s33 offen offset:2048
    buffer_load_dwordx4 v[236:239], v14, s[8:11], s47 offen offset:2048
    buffer_load_dwordx4 v[240:243], v14, s[8:11], s33 offen offset:3072
    buffer_load_dwordx4 v[244:247], v14, s[8:11], s47 offen offset:3072
Lpj1_123:
    buffer_load_dword v4, v9, s[8:11], s46 offen
    buffer_load_dword v5, v9, s[8:11], s46 offen
    buffer_load_dword v6, v9, s[8:11], s46 offen
    buffer_load_dword v7, v9, s[8:11], s46 offen
Lpj_122:
    ds_read_b64_tr_b16 v[24:25], v16 offset:0
    ds_read_b64_tr_b16 v[26:27], v16 offset:512
    ds_read_b64_tr_b16 v[28:29], v17 offset:0
    ds_read_b64_tr_b16 v[30:31], v17 offset:512
    ds_read_b64_tr_b16 v[32:33], v18 offset:0
    ds_read_b64_tr_b16 v[34:35], v18 offset:512
    ds_read_b64_tr_b16 v[36:37], v19 offset:0
    ds_read_b64_tr_b16 v[38:39], v19 offset:512
    s_lshl_b32 s38, s31, 5
    s_add_u32 s38, s38, s99
    s_lshl_b32 s45, s38, 6
    s_add_u32 s45, s45, s42
    s_lshl_b32 s38, s38, 13
    s_lshl_b32 s33, s100, 24
    s_add_u32 s38, s38, s33
    s_lshl_b32 s33, s101, 11
    s_add_u32 s38, s38, s33
    s_add_u32 s43, s43, 1
    s_add_u32 s33, s31, 8
    s_cmp_ge_u32 s43, s41
    s_cselect_b32 s31, s31, s33
    s_mul_i32 s44, s31, 40960
    s_add_u32 s44, s44, 121634816
    ds_read_b64_tr_b16 v[40:41], v16 offset:4096
    ds_read_b64_tr_b16 v[42:43], v16 offset:4608
    ds_read_b64_tr_b16 v[44:45], v17 offset:4096
    ds_read_b64_tr_b16 v[46:47], v17 offset:4608
    ds_read_b64_tr_b16 v[48:49], v18 offset:4096
    ds_read_b64_tr_b16 v[50:51], v18 offset:4608
    ds_read_b64_tr_b16 v[52:53], v19 offset:4096
    ds_read_b64_tr_b16 v[54:55], v19 offset:4608
    s_waitcnt vmcnt(42) lgkmcnt(8)
    s_add_u32 s54, s44, 0
    s_add_u32 s55, s44, 20480
    v_mfma_f32_16x16x32_bf16 v[56:59], v[24:27], v[88:91], 0
    v_mfma_f32_16x16x32_bf16 v[60:63], v[24:27], v[92:95], 0
    v_mfma_f32_16x16x32_bf16 v[64:67], v[28:31], v[88:91], 0
    v_mfma_f32_16x16x32_bf16 v[68:71], v[28:31], v[92:95], 0
    v_mfma_f32_16x16x32_bf16 v[72:75], v[32:35], v[88:91], 0
    v_mfma_f32_16x16x32_bf16 v[76:79], v[32:35], v[92:95], 0
    v_mfma_f32_16x16x32_bf16 v[80:83], v[36:39], v[88:91], 0
    v_mfma_f32_16x16x32_bf16 v[84:87], v[36:39], v[92:95], 0
    buffer_load_dwordx4 v[88:91], v14, s[8:11], s54 offen offset:0
    buffer_load_dwordx4 v[92:95], v14, s[8:11], s55 offen offset:0
    ds_read_b64_tr_b16 v[24:25], v16 offset:8192
    ds_read_b64_tr_b16 v[26:27], v16 offset:8704
    ds_read_b64_tr_b16 v[28:29], v17 offset:8192
    ds_read_b64_tr_b16 v[30:31], v17 offset:8704
    ds_read_b64_tr_b16 v[32:33], v18 offset:8192
    ds_read_b64_tr_b16 v[34:35], v18 offset:8704
    ds_read_b64_tr_b16 v[36:37], v19 offset:8192
    ds_read_b64_tr_b16 v[38:39], v19 offset:8704
    s_waitcnt vmcnt(42) lgkmcnt(8)
    v_mfma_f32_16x16x32_bf16 v[56:59], v[40:43], v[96:99], v[56:59]
    v_mfma_f32_16x16x32_bf16 v[60:63], v[40:43], v[100:103], v[60:63]
    v_mfma_f32_16x16x32_bf16 v[64:67], v[44:47], v[96:99], v[64:67]
    v_mfma_f32_16x16x32_bf16 v[68:71], v[44:47], v[100:103], v[68:71]
    v_mfma_f32_16x16x32_bf16 v[72:75], v[48:51], v[96:99], v[72:75]
    v_mfma_f32_16x16x32_bf16 v[76:79], v[48:51], v[100:103], v[76:79]
    v_mfma_f32_16x16x32_bf16 v[80:83], v[52:55], v[96:99], v[80:83]
    v_mfma_f32_16x16x32_bf16 v[84:87], v[52:55], v[100:103], v[84:87]
    buffer_load_dwordx4 v[96:99], v14, s[8:11], s54 offen offset:1024
    buffer_load_dwordx4 v[100:103], v14, s[8:11], s55 offen offset:1024
    ds_read_b64_tr_b16 v[40:41], v16 offset:12288
    ds_read_b64_tr_b16 v[42:43], v16 offset:12800
    ds_read_b64_tr_b16 v[44:45], v17 offset:12288
    ds_read_b64_tr_b16 v[46:47], v17 offset:12800
    ds_read_b64_tr_b16 v[48:49], v18 offset:12288
    ds_read_b64_tr_b16 v[50:51], v18 offset:12800
    ds_read_b64_tr_b16 v[52:53], v19 offset:12288
    ds_read_b64_tr_b16 v[54:55], v19 offset:12800
    s_waitcnt vmcnt(42) lgkmcnt(8)
    v_mfma_f32_16x16x32_bf16 v[56:59], v[24:27], v[104:107], v[56:59]
    v_mfma_f32_16x16x32_bf16 v[60:63], v[24:27], v[108:111], v[60:63]
    v_mfma_f32_16x16x32_bf16 v[64:67], v[28:31], v[104:107], v[64:67]
    v_mfma_f32_16x16x32_bf16 v[68:71], v[28:31], v[108:111], v[68:71]
    v_mfma_f32_16x16x32_bf16 v[72:75], v[32:35], v[104:107], v[72:75]
    v_mfma_f32_16x16x32_bf16 v[76:79], v[32:35], v[108:111], v[76:79]
    v_mfma_f32_16x16x32_bf16 v[80:83], v[36:39], v[104:107], v[80:83]
    v_mfma_f32_16x16x32_bf16 v[84:87], v[36:39], v[108:111], v[84:87]
    buffer_load_dwordx4 v[104:107], v14, s[8:11], s54 offen offset:2048
    buffer_load_dwordx4 v[108:111], v14, s[8:11], s55 offen offset:2048
    ds_read_b64_tr_b16 v[24:25], v16 offset:16384
    ds_read_b64_tr_b16 v[26:27], v16 offset:16896
    ds_read_b64_tr_b16 v[28:29], v17 offset:16384
    ds_read_b64_tr_b16 v[30:31], v17 offset:16896
    ds_read_b64_tr_b16 v[32:33], v18 offset:16384
    ds_read_b64_tr_b16 v[34:35], v18 offset:16896
    ds_read_b64_tr_b16 v[36:37], v19 offset:16384
    ds_read_b64_tr_b16 v[38:39], v19 offset:16896
    s_waitcnt vmcnt(42) lgkmcnt(8)
    v_mfma_f32_16x16x32_bf16 v[56:59], v[40:43], v[112:115], v[56:59]
    v_mfma_f32_16x16x32_bf16 v[60:63], v[40:43], v[116:119], v[60:63]
    v_mfma_f32_16x16x32_bf16 v[64:67], v[44:47], v[112:115], v[64:67]
    v_mfma_f32_16x16x32_bf16 v[68:71], v[44:47], v[116:119], v[68:71]
    v_mfma_f32_16x16x32_bf16 v[72:75], v[48:51], v[112:115], v[72:75]
    v_mfma_f32_16x16x32_bf16 v[76:79], v[48:51], v[116:119], v[76:79]
    v_mfma_f32_16x16x32_bf16 v[80:83], v[52:55], v[112:115], v[80:83]
    v_mfma_f32_16x16x32_bf16 v[84:87], v[52:55], v[116:119], v[84:87]
    buffer_load_dwordx4 v[112:115], v14, s[8:11], s54 offen offset:3072
    buffer_load_dwordx4 v[116:119], v14, s[8:11], s55 offen offset:3072
    ds_read_b64_tr_b16 v[40:41], v16 offset:20480
    ds_read_b64_tr_b16 v[42:43], v16 offset:20992
    ds_read_b64_tr_b16 v[44:45], v17 offset:20480
    ds_read_b64_tr_b16 v[46:47], v17 offset:20992
    ds_read_b64_tr_b16 v[48:49], v18 offset:20480
    ds_read_b64_tr_b16 v[50:51], v18 offset:20992
    ds_read_b64_tr_b16 v[52:53], v19 offset:20480
    ds_read_b64_tr_b16 v[54:55], v19 offset:20992
    s_waitcnt vmcnt(42) lgkmcnt(8)
    s_add_u32 s54, s44, 4096
    s_add_u32 s55, s44, 24576
    v_mfma_f32_16x16x32_bf16 v[56:59], v[24:27], v[120:123], v[56:59]
    v_mfma_f32_16x16x32_bf16 v[60:63], v[24:27], v[124:127], v[60:63]
    v_mfma_f32_16x16x32_bf16 v[64:67], v[28:31], v[120:123], v[64:67]
    v_mfma_f32_16x16x32_bf16 v[68:71], v[28:31], v[124:127], v[68:71]
    v_mfma_f32_16x16x32_bf16 v[72:75], v[32:35], v[120:123], v[72:75]
    v_mfma_f32_16x16x32_bf16 v[76:79], v[32:35], v[124:127], v[76:79]
    v_mfma_f32_16x16x32_bf16 v[80:83], v[36:39], v[120:123], v[80:83]
    v_mfma_f32_16x16x32_bf16 v[84:87], v[36:39], v[124:127], v[84:87]
    buffer_load_dwordx4 v[120:123], v14, s[8:11], s54 offen offset:0
    buffer_load_dwordx4 v[124:127], v14, s[8:11], s55 offen offset:0
    ds_read_b64_tr_b16 v[24:25], v16 offset:24576
    ds_read_b64_tr_b16 v[26:27], v16 offset:25088
    ds_read_b64_tr_b16 v[28:29], v17 offset:24576
    ds_read_b64_tr_b16 v[30:31], v17 offset:25088
    ds_read_b64_tr_b16 v[32:33], v18 offset:24576
    ds_read_b64_tr_b16 v[34:35], v18 offset:25088
    ds_read_b64_tr_b16 v[36:37], v19 offset:24576
    ds_read_b64_tr_b16 v[38:39], v19 offset:25088
    s_waitcnt vmcnt(42) lgkmcnt(8)
    v_mfma_f32_16x16x32_bf16 v[56:59], v[40:43], v[128:131], v[56:59]
    v_mfma_f32_16x16x32_bf16 v[60:63], v[40:43], v[132:135], v[60:63]
    v_mfma_f32_16x16x32_bf16 v[64:67], v[44:47], v[128:131], v[64:67]
    v_mfma_f32_16x16x32_bf16 v[68:71], v[44:47], v[132:135], v[68:71]
    v_mfma_f32_16x16x32_bf16 v[72:75], v[48:51], v[128:131], v[72:75]
    v_mfma_f32_16x16x32_bf16 v[76:79], v[48:51], v[132:135], v[76:79]
    v_mfma_f32_16x16x32_bf16 v[80:83], v[52:55], v[128:131], v[80:83]
    v_mfma_f32_16x16x32_bf16 v[84:87], v[52:55], v[132:135], v[84:87]
    buffer_load_dwordx4 v[128:131], v14, s[8:11], s54 offen offset:1024
    buffer_load_dwordx4 v[132:135], v14, s[8:11], s55 offen offset:1024
    ds_read_b64_tr_b16 v[40:41], v16 offset:28672
    ds_read_b64_tr_b16 v[42:43], v16 offset:29184
    ds_read_b64_tr_b16 v[44:45], v17 offset:28672
    ds_read_b64_tr_b16 v[46:47], v17 offset:29184
    ds_read_b64_tr_b16 v[48:49], v18 offset:28672
    ds_read_b64_tr_b16 v[50:51], v18 offset:29184
    ds_read_b64_tr_b16 v[52:53], v19 offset:28672
    ds_read_b64_tr_b16 v[54:55], v19 offset:29184
    s_waitcnt vmcnt(12) lgkmcnt(8)
    s_mov_b64 exec, 1
    buffer_store_dword v8, v9, s[8:11], s46 offen sc1
    s_mov_b64 exec, -1
    v_mfma_f32_16x16x32_bf16 v[56:59], v[24:27], v[136:139], v[56:59]
    v_mfma_f32_16x16x32_bf16 v[60:63], v[24:27], v[140:143], v[60:63]
    v_mfma_f32_16x16x32_bf16 v[64:67], v[28:31], v[136:139], v[64:67]
    v_mfma_f32_16x16x32_bf16 v[68:71], v[28:31], v[140:143], v[68:71]
    v_mfma_f32_16x16x32_bf16 v[72:75], v[32:35], v[136:139], v[72:75]
    v_mfma_f32_16x16x32_bf16 v[76:79], v[32:35], v[140:143], v[76:79]
    v_mfma_f32_16x16x32_bf16 v[80:83], v[36:39], v[136:139], v[80:83]
    v_mfma_f32_16x16x32_bf16 v[84:87], v[36:39], v[140:143], v[84:87]
    buffer_load_dwordx4 v[136:139], v14, s[8:11], s54 offen offset:2048
    buffer_load_dwordx4 v[140:143], v14, s[8:11], s55 offen offset:2048
    ds_read_b64_tr_b16 v[24:25], v16 offset:32768
    ds_read_b64_tr_b16 v[26:27], v16 offset:33280
    ds_read_b64_tr_b16 v[28:29], v17 offset:32768
    ds_read_b64_tr_b16 v[30:31], v17 offset:33280
    ds_read_b64_tr_b16 v[32:33], v18 offset:32768
    ds_read_b64_tr_b16 v[34:35], v18 offset:33280
    ds_read_b64_tr_b16 v[36:37], v19 offset:32768
    ds_read_b64_tr_b16 v[38:39], v19 offset:33280
    s_waitcnt vmcnt(43) lgkmcnt(8)
    v_mfma_f32_16x16x32_bf16 v[56:59], v[40:43], v[144:147], v[56:59]
    v_mfma_f32_16x16x32_bf16 v[60:63], v[40:43], v[148:151], v[60:63]
    v_mfma_f32_16x16x32_bf16 v[64:67], v[44:47], v[144:147], v[64:67]
    v_mfma_f32_16x16x32_bf16 v[68:71], v[44:47], v[148:151], v[68:71]
    v_mfma_f32_16x16x32_bf16 v[72:75], v[48:51], v[144:147], v[72:75]
    v_mfma_f32_16x16x32_bf16 v[76:79], v[48:51], v[148:151], v[76:79]
    v_mfma_f32_16x16x32_bf16 v[80:83], v[52:55], v[144:147], v[80:83]
    v_mfma_f32_16x16x32_bf16 v[84:87], v[52:55], v[148:151], v[84:87]
    buffer_load_dwordx4 v[144:147], v14, s[8:11], s54 offen offset:3072
    buffer_load_dwordx4 v[148:151], v14, s[8:11], s55 offen offset:3072
    ds_read_b64_tr_b16 v[40:41], v16 offset:36864
    ds_read_b64_tr_b16 v[42:43], v16 offset:37376
    ds_read_b64_tr_b16 v[44:45], v17 offset:36864
    ds_read_b64_tr_b16 v[46:47], v17 offset:37376
    ds_read_b64_tr_b16 v[48:49], v18 offset:36864
    ds_read_b64_tr_b16 v[50:51], v18 offset:37376
    ds_read_b64_tr_b16 v[52:53], v19 offset:36864
    ds_read_b64_tr_b16 v[54:55], v19 offset:37376
    s_waitcnt vmcnt(43) lgkmcnt(8)
    s_add_u32 s54, s44, 8192
    s_add_u32 s55, s44, 28672
    v_mfma_f32_16x16x32_bf16 v[56:59], v[24:27], v[152:155], v[56:59]
    v_mfma_f32_16x16x32_bf16 v[60:63], v[24:27], v[156:159], v[60:63]
    v_mfma_f32_16x16x32_bf16 v[64:67], v[28:31], v[152:155], v[64:67]
    v_mfma_f32_16x16x32_bf16 v[68:71], v[28:31], v[156:159], v[68:71]
    v_mfma_f32_16x16x32_bf16 v[72:75], v[32:35], v[152:155], v[72:75]
    v_mfma_f32_16x16x32_bf16 v[76:79], v[32:35], v[156:159], v[76:79]
    v_mfma_f32_16x16x32_bf16 v[80:83], v[36:39], v[152:155], v[80:83]
    v_mfma_f32_16x16x32_bf16 v[84:87], v[36:39], v[156:159], v[84:87]
    buffer_load_dwordx4 v[152:155], v14, s[8:11], s54 offen offset:0
    buffer_load_dwordx4 v[156:159], v14, s[8:11], s55 offen offset:0
    ds_read_b64_tr_b16 v[24:25], v20 offset:0
    ds_read_b64_tr_b16 v[26:27], v20 offset:512
    ds_read_b64_tr_b16 v[28:29], v21 offset:0
    ds_read_b64_tr_b16 v[30:31], v21 offset:512
    ds_read_b64_tr_b16 v[32:33], v22 offset:0
    ds_read_b64_tr_b16 v[34:35], v22 offset:512
    ds_read_b64_tr_b16 v[36:37], v23 offset:0
    ds_read_b64_tr_b16 v[38:39], v23 offset:512
    s_waitcnt vmcnt(43) lgkmcnt(8)
    v_mfma_f32_16x16x32_bf16 v[56:59], v[40:43], v[160:163], v[56:59]
    v_mfma_f32_16x16x32_bf16 v[60:63], v[40:43], v[164:167], v[60:63]
    v_mfma_f32_16x16x32_bf16 v[64:67], v[44:47], v[160:163], v[64:67]
    v_mfma_f32_16x16x32_bf16 v[68:71], v[44:47], v[164:167], v[68:71]
    v_mfma_f32_16x16x32_bf16 v[72:75], v[48:51], v[160:163], v[72:75]
    v_mfma_f32_16x16x32_bf16 v[76:79], v[48:51], v[164:167], v[76:79]
    v_mfma_f32_16x16x32_bf16 v[80:83], v[52:55], v[160:163], v[80:83]
    v_mfma_f32_16x16x32_bf16 v[84:87], v[52:55], v[164:167], v[84:87]
    buffer_load_dwordx4 v[160:163], v14, s[8:11], s54 offen offset:1024
    buffer_load_dwordx4 v[164:167], v14, s[8:11], s55 offen offset:1024
    ds_read_b64_tr_b16 v[40:41], v20 offset:4096
    ds_read_b64_tr_b16 v[42:43], v20 offset:4608
    ds_read_b64_tr_b16 v[44:45], v21 offset:4096
    ds_read_b64_tr_b16 v[46:47], v21 offset:4608
    ds_read_b64_tr_b16 v[48:49], v22 offset:4096
    ds_read_b64_tr_b16 v[50:51], v22 offset:4608
    ds_read_b64_tr_b16 v[52:53], v23 offset:4096
    ds_read_b64_tr_b16 v[54:55], v23 offset:4608
    s_waitcnt vmcnt(43) lgkmcnt(8)
    v_mfma_f32_16x16x32_bf16 v[56:59], v[24:27], v[168:171], v[56:59]
    v_mfma_f32_16x16x32_bf16 v[60:63], v[24:27], v[172:175], v[60:63]
    v_mfma_f32_16x16x32_bf16 v[64:67], v[28:31], v[168:171], v[64:67]
    v_mfma_f32_16x16x32_bf16 v[68:71], v[28:31], v[172:175], v[68:71]
    v_mfma_f32_16x16x32_bf16 v[72:75], v[32:35], v[168:171], v[72:75]
    v_mfma_f32_16x16x32_bf16 v[76:79], v[32:35], v[172:175], v[76:79]
    v_mfma_f32_16x16x32_bf16 v[80:83], v[36:39], v[168:171], v[80:83]
    v_mfma_f32_16x16x32_bf16 v[84:87], v[36:39], v[172:175], v[84:87]
    buffer_load_dwordx4 v[168:171], v14, s[8:11], s54 offen offset:2048
    buffer_load_dwordx4 v[172:175], v14, s[8:11], s55 offen offset:2048
    ds_read_b64_tr_b16 v[24:25], v20 offset:8192
    ds_read_b64_tr_b16 v[26:27], v20 offset:8704
    ds_read_b64_tr_b16 v[28:29], v21 offset:8192
    ds_read_b64_tr_b16 v[30:31], v21 offset:8704
    ds_read_b64_tr_b16 v[32:33], v22 offset:8192
    ds_read_b64_tr_b16 v[34:35], v22 offset:8704
    ds_read_b64_tr_b16 v[36:37], v23 offset:8192
    ds_read_b64_tr_b16 v[38:39], v23 offset:8704
    s_waitcnt vmcnt(43) lgkmcnt(8)
    v_mfma_f32_16x16x32_bf16 v[56:59], v[40:43], v[176:179], v[56:59]
    v_mfma_f32_16x16x32_bf16 v[60:63], v[40:43], v[180:183], v[60:63]
    v_mfma_f32_16x16x32_bf16 v[64:67], v[44:47], v[176:179], v[64:67]
    v_mfma_f32_16x16x32_bf16 v[68:71], v[44:47], v[180:183], v[68:71]
    v_mfma_f32_16x16x32_bf16 v[72:75], v[48:51], v[176:179], v[72:75]
    v_mfma_f32_16x16x32_bf16 v[76:79], v[48:51], v[180:183], v[76:79]
    v_mfma_f32_16x16x32_bf16 v[80:83], v[52:55], v[176:179], v[80:83]
    v_mfma_f32_16x16x32_bf16 v[84:87], v[52:55], v[180:183], v[84:87]
    buffer_load_dwordx4 v[176:179], v14, s[8:11], s54 offen offset:3072
    buffer_load_dwordx4 v[180:183], v14, s[8:11], s55 offen offset:3072
    ds_read_b64_tr_b16 v[40:41], v20 offset:12288
    ds_read_b64_tr_b16 v[42:43], v20 offset:12800
    ds_read_b64_tr_b16 v[44:45], v21 offset:12288
    ds_read_b64_tr_b16 v[46:47], v21 offset:12800
    ds_read_b64_tr_b16 v[48:49], v22 offset:12288
    ds_read_b64_tr_b16 v[50:51], v22 offset:12800
    ds_read_b64_tr_b16 v[52:53], v23 offset:12288
    ds_read_b64_tr_b16 v[54:55], v23 offset:12800
    s_waitcnt vmcnt(43) lgkmcnt(8)
    s_add_u32 s54, s44, 12288
    s_add_u32 s55, s44, 32768
    v_mfma_f32_16x16x32_bf16 v[56:59], v[24:27], v[184:187], v[56:59]
    v_mfma_f32_16x16x32_bf16 v[60:63], v[24:27], v[188:191], v[60:63]
    v_mfma_f32_16x16x32_bf16 v[64:67], v[28:31], v[184:187], v[64:67]
    v_mfma_f32_16x16x32_bf16 v[68:71], v[28:31], v[188:191], v[68:71]
    v_mfma_f32_16x16x32_bf16 v[72:75], v[32:35], v[184:187], v[72:75]
    v_mfma_f32_16x16x32_bf16 v[76:79], v[32:35], v[188:191], v[76:79]
    v_mfma_f32_16x16x32_bf16 v[80:83], v[36:39], v[184:187], v[80:83]
    v_mfma_f32_16x16x32_bf16 v[84:87], v[36:39], v[188:191], v[84:87]
    buffer_load_dwordx4 v[184:187], v14, s[8:11], s54 offen offset:0
    buffer_load_dwordx4 v[188:191], v14, s[8:11], s55 offen offset:0
    ds_read_b64_tr_b16 v[24:25], v20 offset:16384
    ds_read_b64_tr_b16 v[26:27], v20 offset:16896
    ds_read_b64_tr_b16 v[28:29], v21 offset:16384
    ds_read_b64_tr_b16 v[30:31], v21 offset:16896
    ds_read_b64_tr_b16 v[32:33], v22 offset:16384
    ds_read_b64_tr_b16 v[34:35], v22 offset:16896
    ds_read_b64_tr_b16 v[36:37], v23 offset:16384
    ds_read_b64_tr_b16 v[38:39], v23 offset:16896
    s_waitcnt vmcnt(43) lgkmcnt(8)
    v_mfma_f32_16x16x32_bf16 v[56:59], v[40:43], v[192:195], v[56:59]
    v_mfma_f32_16x16x32_bf16 v[60:63], v[40:43], v[196:199], v[60:63]
    v_mfma_f32_16x16x32_bf16 v[64:67], v[44:47], v[192:195], v[64:67]
    v_mfma_f32_16x16x32_bf16 v[68:71], v[44:47], v[196:199], v[68:71]
    v_mfma_f32_16x16x32_bf16 v[72:75], v[48:51], v[192:195], v[72:75]
    v_mfma_f32_16x16x32_bf16 v[76:79], v[48:51], v[196:199], v[76:79]
    v_mfma_f32_16x16x32_bf16 v[80:83], v[52:55], v[192:195], v[80:83]
    v_mfma_f32_16x16x32_bf16 v[84:87], v[52:55], v[196:199], v[84:87]
    buffer_load_dwordx4 v[192:195], v14, s[8:11], s54 offen offset:1024
    buffer_load_dwordx4 v[196:199], v14, s[8:11], s55 offen offset:1024
    ds_read_b64_tr_b16 v[40:41], v20 offset:20480
    ds_read_b64_tr_b16 v[42:43], v20 offset:20992
    ds_read_b64_tr_b16 v[44:45], v21 offset:20480
    ds_read_b64_tr_b16 v[46:47], v21 offset:20992
    ds_read_b64_tr_b16 v[48:49], v22 offset:20480
    ds_read_b64_tr_b16 v[50:51], v22 offset:20992
    ds_read_b64_tr_b16 v[52:53], v23 offset:20480
    ds_read_b64_tr_b16 v[54:55], v23 offset:20992
    s_waitcnt vmcnt(43) lgkmcnt(8)
    v_mfma_f32_16x16x32_bf16 v[56:59], v[24:27], v[200:203], v[56:59]
    v_mfma_f32_16x16x32_bf16 v[60:63], v[24:27], v[204:207], v[60:63]
    v_mfma_f32_16x16x32_bf16 v[64:67], v[28:31], v[200:203], v[64:67]
    v_mfma_f32_16x16x32_bf16 v[68:71], v[28:31], v[204:207], v[68:71]
    v_mfma_f32_16x16x32_bf16 v[72:75], v[32:35], v[200:203], v[72:75]
    v_mfma_f32_16x16x32_bf16 v[76:79], v[32:35], v[204:207], v[76:79]
    v_mfma_f32_16x16x32_bf16 v[80:83], v[36:39], v[200:203], v[80:83]
    v_mfma_f32_16x16x32_bf16 v[84:87], v[36:39], v[204:207], v[84:87]
    buffer_load_dwordx4 v[200:203], v14, s[8:11], s54 offen offset:2048
    buffer_load_dwordx4 v[204:207], v14, s[8:11], s55 offen offset:2048
    ds_read_b64_tr_b16 v[24:25], v20 offset:24576
    ds_read_b64_tr_b16 v[26:27], v20 offset:25088
    ds_read_b64_tr_b16 v[28:29], v21 offset:24576
    ds_read_b64_tr_b16 v[30:31], v21 offset:25088
    ds_read_b64_tr_b16 v[32:33], v22 offset:24576
    ds_read_b64_tr_b16 v[34:35], v22 offset:25088
    ds_read_b64_tr_b16 v[36:37], v23 offset:24576
    ds_read_b64_tr_b16 v[38:39], v23 offset:25088
    s_waitcnt vmcnt(43) lgkmcnt(8)
    v_mfma_f32_16x16x32_bf16 v[56:59], v[40:43], v[208:211], v[56:59]
    v_mfma_f32_16x16x32_bf16 v[60:63], v[40:43], v[212:215], v[60:63]
    v_mfma_f32_16x16x32_bf16 v[64:67], v[44:47], v[208:211], v[64:67]
    v_mfma_f32_16x16x32_bf16 v[68:71], v[44:47], v[212:215], v[68:71]
    v_mfma_f32_16x16x32_bf16 v[72:75], v[48:51], v[208:211], v[72:75]
    v_mfma_f32_16x16x32_bf16 v[76:79], v[48:51], v[212:215], v[76:79]
    v_mfma_f32_16x16x32_bf16 v[80:83], v[52:55], v[208:211], v[80:83]
    v_mfma_f32_16x16x32_bf16 v[84:87], v[52:55], v[212:215], v[84:87]
    buffer_load_dwordx4 v[208:211], v14, s[8:11], s54 offen offset:3072
    buffer_load_dwordx4 v[212:215], v14, s[8:11], s55 offen offset:3072
    ds_read_b64_tr_b16 v[40:41], v20 offset:28672
    ds_read_b64_tr_b16 v[42:43], v20 offset:29184
    ds_read_b64_tr_b16 v[44:45], v21 offset:28672
    ds_read_b64_tr_b16 v[46:47], v21 offset:29184
    ds_read_b64_tr_b16 v[48:49], v22 offset:28672
    ds_read_b64_tr_b16 v[50:51], v22 offset:29184
    ds_read_b64_tr_b16 v[52:53], v23 offset:28672
    ds_read_b64_tr_b16 v[54:55], v23 offset:29184
    s_waitcnt vmcnt(43) lgkmcnt(8)
    s_add_u32 s54, s44, 16384
    s_add_u32 s55, s44, 36864
    v_mfma_f32_16x16x32_bf16 v[56:59], v[24:27], v[216:219], v[56:59]
    v_mfma_f32_16x16x32_bf16 v[60:63], v[24:27], v[220:223], v[60:63]
    v_mfma_f32_16x16x32_bf16 v[64:67], v[28:31], v[216:219], v[64:67]
    v_mfma_f32_16x16x32_bf16 v[68:71], v[28:31], v[220:223], v[68:71]
    v_mfma_f32_16x16x32_bf16 v[72:75], v[32:35], v[216:219], v[72:75]
    v_mfma_f32_16x16x32_bf16 v[76:79], v[32:35], v[220:223], v[76:79]
    v_mfma_f32_16x16x32_bf16 v[80:83], v[36:39], v[216:219], v[80:83]
    v_mfma_f32_16x16x32_bf16 v[84:87], v[36:39], v[220:223], v[84:87]
    buffer_load_dwordx4 v[216:219], v14, s[8:11], s54 offen offset:0
    buffer_load_dwordx4 v[220:223], v14, s[8:11], s55 offen offset:0
    ds_read_b64_tr_b16 v[24:25], v20 offset:32768
    ds_read_b64_tr_b16 v[26:27], v20 offset:33280
    ds_read_b64_tr_b16 v[28:29], v21 offset:32768
    ds_read_b64_tr_b16 v[30:31], v21 offset:33280
    ds_read_b64_tr_b16 v[32:33], v22 offset:32768
    ds_read_b64_tr_b16 v[34:35], v22 offset:33280
    ds_read_b64_tr_b16 v[36:37], v23 offset:32768
    ds_read_b64_tr_b16 v[38:39], v23 offset:33280
    s_waitcnt vmcnt(43) lgkmcnt(8)
    v_mfma_f32_16x16x32_bf16 v[56:59], v[40:43], v[224:227], v[56:59]
    v_mfma_f32_16x16x32_bf16 v[60:63], v[40:43], v[228:231], v[60:63]
    v_mfma_f32_16x16x32_bf16 v[64:67], v[44:47], v[224:227], v[64:67]
    v_mfma_f32_16x16x32_bf16 v[68:71], v[44:47], v[228:231], v[68:71]
    v_mfma_f32_16x16x32_bf16 v[72:75], v[48:51], v[224:227], v[72:75]
    v_mfma_f32_16x16x32_bf16 v[76:79], v[48:51], v[228:231], v[76:79]
    v_mfma_f32_16x16x32_bf16 v[80:83], v[52:55], v[224:227], v[80:83]
    v_mfma_f32_16x16x32_bf16 v[84:87], v[52:55], v[228:231], v[84:87]
    buffer_load_dwordx4 v[224:227], v14, s[8:11], s54 offen offset:1024
    buffer_load_dwordx4 v[228:231], v14, s[8:11], s55 offen offset:1024
    ds_read_b64_tr_b16 v[40:41], v20 offset:36864
    ds_read_b64_tr_b16 v[42:43], v20 offset:37376
    ds_read_b64_tr_b16 v[44:45], v21 offset:36864
    ds_read_b64_tr_b16 v[46:47], v21 offset:37376
    ds_read_b64_tr_b16 v[48:49], v22 offset:36864
    ds_read_b64_tr_b16 v[50:51], v22 offset:37376
    ds_read_b64_tr_b16 v[52:53], v23 offset:36864
    ds_read_b64_tr_b16 v[54:55], v23 offset:37376
    s_waitcnt vmcnt(43) lgkmcnt(8)
    v_mfma_f32_16x16x32_bf16 v[56:59], v[24:27], v[232:235], v[56:59]
    v_mfma_f32_16x16x32_bf16 v[60:63], v[24:27], v[236:239], v[60:63]
    v_mfma_f32_16x16x32_bf16 v[64:67], v[28:31], v[232:235], v[64:67]
    v_mfma_f32_16x16x32_bf16 v[68:71], v[28:31], v[236:239], v[68:71]
    v_mfma_f32_16x16x32_bf16 v[72:75], v[32:35], v[232:235], v[72:75]
    v_mfma_f32_16x16x32_bf16 v[76:79], v[32:35], v[236:239], v[76:79]
    v_mfma_f32_16x16x32_bf16 v[80:83], v[36:39], v[232:235], v[80:83]
    v_mfma_f32_16x16x32_bf16 v[84:87], v[36:39], v[236:239], v[84:87]
    buffer_load_dwordx4 v[232:235], v14, s[8:11], s54 offen offset:2048
    buffer_load_dwordx4 v[236:239], v14, s[8:11], s55 offen offset:2048
    s_waitcnt vmcnt(43) lgkmcnt(0)
    v_mfma_f32_16x16x32_bf16 v[56:59], v[40:43], v[240:243], v[56:59]
    v_mfma_f32_16x16x32_bf16 v[60:63], v[40:43], v[244:247], v[60:63]
    v_mfma_f32_16x16x32_bf16 v[64:67], v[44:47], v[240:243], v[64:67]
    v_mfma_f32_16x16x32_bf16 v[68:71], v[44:47], v[244:247], v[68:71]
    v_mfma_f32_16x16x32_bf16 v[72:75], v[48:51], v[240:243], v[72:75]
    v_mfma_f32_16x16x32_bf16 v[76:79], v[48:51], v[244:247], v[76:79]
    v_mfma_f32_16x16x32_bf16 v[80:83], v[52:55], v[240:243], v[80:83]
    v_mfma_f32_16x16x32_bf16 v[84:87], v[52:55], v[244:247], v[84:87]
    buffer_load_dwordx4 v[240:243], v14, s[8:11], s54 offen offset:3072
    buffer_load_dwordx4 v[244:247], v14, s[8:11], s55 offen offset:3072
    s_mov_b32 s46, s45
    s_add_u32 s32, s38, 4096
    s_nop 4
    v_cvt_pk_bf16_f32 v24, v56, v57
    v_cvt_pk_bf16_f32 v25, v58, v59
    v_cvt_pk_bf16_f32 v26, v64, v65
    v_cvt_pk_bf16_f32 v27, v66, v67
    buffer_store_dwordx4 v[24:27], v14, s[8:11], s38 offen offset:0 sc1
    v_cvt_pk_bf16_f32 v28, v60, v61
    v_cvt_pk_bf16_f32 v29, v62, v63
    v_cvt_pk_bf16_f32 v30, v68, v69
    v_cvt_pk_bf16_f32 v31, v70, v71
    buffer_store_dwordx4 v[28:31], v14, s[8:11], s32 offen offset:0 sc1
    v_cvt_pk_bf16_f32 v32, v72, v73
    v_cvt_pk_bf16_f32 v33, v74, v75
    v_cvt_pk_bf16_f32 v34, v80, v81
    v_cvt_pk_bf16_f32 v35, v82, v83
    buffer_store_dwordx4 v[32:35], v14, s[8:11], s38 offen offset:1024 sc1
    v_cvt_pk_bf16_f32 v36, v76, v77
    v_cvt_pk_bf16_f32 v37, v78, v79
    v_cvt_pk_bf16_f32 v38, v84, v85
    v_cvt_pk_bf16_f32 v39, v86, v87
    buffer_store_dwordx4 v[36:39], v14, s[8:11], s32 offen offset:1024 sc1
    s_cmp_ge_u32 s43, s41
    s_cbranch_scc1 Lpjend_p
    s_nop 1
    s_branch Lpj_122
Lpv_121:
    s_cmp_ge_u32 s97, 8
    s_cbranch_scc1 Lpj1_125
    s_cmp_lg_u32 s94, 0
    s_cbranch_scc1 Lpj1_125
    ds_read_b64_tr_b16 v[24:25], v16 offset:0
    ds_read_b64_tr_b16 v[26:27], v16 offset:512
    ds_read_b64_tr_b16 v[28:29], v17 offset:0
    ds_read_b64_tr_b16 v[30:31], v17 offset:512
    ds_read_b64_tr_b16 v[32:33], v18 offset:0
    ds_read_b64_tr_b16 v[34:35], v18 offset:512
    ds_read_b64_tr_b16 v[36:37], v19 offset:0
    ds_read_b64_tr_b16 v[38:39], v19 offset:512
    s_lshl_b32 s38, s31, 5
    s_add_u32 s38, s38, s99
    s_lshl_b32 s45, s38, 6
    s_add_u32 s45, s45, s42
    s_lshl_b32 s38, s38, 13
    s_lshl_b32 s33, s100, 24
    s_add_u32 s38, s38, s33
    s_lshl_b32 s33, s101, 12
    s_add_u32 s38, s38, s33
    s_add_u32 s43, s43, 1
    s_add_u32 s33, s31, 8
    s_cmp_ge_u32 s43, s41
    s_cselect_b32 s31, s31, s33
    s_mul_i32 s44, s31, 40960
    s_add_u32 s44, s44, 121634816
    ds_read_b64_tr_b16 v[40:41], v16 offset:4096
    ds_read_b64_tr_b16 v[42:43], v16 offset:4608
    ds_read_b64_tr_b16 v[44:45], v17 offset:4096
    ds_read_b64_tr_b16 v[46:47], v17 offset:4608
    ds_read_b64_tr_b16 v[48:49], v18 offset:4096
    ds_read_b64_tr_b16 v[50:51], v18 offset:4608
    ds_read_b64_tr_b16 v[52:53], v19 offset:4096
    ds_read_b64_tr_b16 v[54:55], v19 offset:4608
    s_waitcnt vmcnt(38) lgkmcnt(8)
    v_mfma_f32_16x16x32_bf16 v[56:59], v[88:91], v[24:27], 0
    v_mfma_f32_16x16x32_bf16 v[60:63], v[92:95], v[24:27], 0
    v_mfma_f32_16x16x32_bf16 v[64:67], v[88:91], v[28:31], 0
    v_mfma_f32_16x16x32_bf16 v[68:71], v[92:95], v[28:31], 0
    v_mfma_f32_16x16x32_bf16 v[72:75], v[88:91], v[32:35], 0
    v_mfma_f32_16x16x32_bf16 v[76:79], v[92:95], v[32:35], 0
    v_mfma_f32_16x16x32_bf16 v[80:83], v[88:91], v[36:39], 0
    v_mfma_f32_16x16x32_bf16 v[84:87], v[92:95], v[36:39], 0
    ds_read_b64_tr_b16 v[24:25], v16 offset:8192
    ds_read_b64_tr_b16 v[26:27], v16 offset:8704
    ds_read_b64_tr_b16 v[28:29], v17 offset:8192
    ds_read_b64_tr_b16 v[30:31], v17 offset:8704
    ds_read_b64_tr_b16 v[32:33], v18 offset:8192
    ds_read_b64_tr_b16 v[34:35], v18 offset:8704
    ds_read_b64_tr_b16 v[36:37], v19 offset:8192
    ds_read_b64_tr_b16 v[38:39], v19 offset:8704
    s_waitcnt vmcnt(36) lgkmcnt(8)
    v_mfma_f32_16x16x32_bf16 v[56:59], v[96:99], v[40:43], v[56:59]
    v_mfma_f32_16x16x32_bf16 v[60:63], v[100:103], v[40:43], v[60:63]
    v_mfma_f32_16x16x32_bf16 v[64:67], v[96:99], v[44:47], v[64:67]
    v_mfma_f32_16x16x32_bf16 v[68:71], v[100:103], v[44:47], v[68:71]
    v_mfma_f32_16x16x32_bf16 v[72:75], v[96:99], v[48:51], v[72:75]
    v_mfma_f32_16x16x32_bf16 v[76:79], v[100:103], v[48:51], v[76:79]
    v_mfma_f32_16x16x32_bf16 v[80:83], v[96:99], v[52:55], v[80:83]
    v_mfma_f32_16x16x32_bf16 v[84:87], v[100:103], v[52:55], v[84:87]
    ds_read_b64_tr_b16 v[40:41], v16 offset:12288
    ds_read_b64_tr_b16 v[42:43], v16 offset:12800
    ds_read_b64_tr_b16 v[44:45], v17 offset:12288
    ds_read_b64_tr_b16 v[46:47], v17 offset:12800
    ds_read_b64_tr_b16 v[48:49], v18 offset:12288
    ds_read_b64_tr_b16 v[50:51], v18 offset:12800
    ds_read_b64_tr_b16 v[52:53], v19 offset:12288
    ds_read_b64_tr_b16 v[54:55], v19 offset:12800
    s_waitcnt vmcnt(34) lgkmcnt(8)
    v_mfma_f32_16x16x32_bf16 v[56:59], v[104:107], v[24:27], v[56:59]
    v_mfma_f32_16x16x32_bf16 v[60:63], v[108:111], v[24:27], v[60:63]
    v_mfma_f32_16x16x32_bf16 v[64:67], v[104:107], v[28:31], v[64:67]
    v_mfma_f32_16x16x32_bf16 v[68:71], v[108:111], v[28:31], v[68:71]
    v_mfma_f32_16x16x32_bf16 v[72:75], v[104:107], v[32:35], v[72:75]
    v_mfma_f32_16x16x32_bf16 v[76:79], v[108:111], v[32:35], v[76:79]
    v_mfma_f32_16x16x32_bf16 v[80:83], v[104:107], v[36:39], v[80:83]
    v_mfma_f32_16x16x32_bf16 v[84:87], v[108:111], v[36:39], v[84:87]
    ds_read_b64_tr_b16 v[24:25], v16 offset:16384
    ds_read_b64_tr_b16 v[26:27], v16 offset:16896
    ds_read_b64_tr_b16 v[28:29], v17 offset:16384
    ds_read_b64_tr_b16 v[30:31], v17 offset:16896
    ds_read_b64_tr_b16 v[32:33], v18 offset:16384
    ds_read_b64_tr_b16 v[34:35], v18 offset:16896
    ds_read_b64_tr_b16 v[36:37], v19 offset:16384
    ds_read_b64_tr_b16 v[38:39], v19 offset:16896
    s_waitcnt vmcnt(32) lgkmcnt(8)
    v_mfma_f32_16x16x32_bf16 v[56:59], v[112:115], v[40:43], v[56:59]
    v_mfma_f32_16x16x32_bf16 v[60:63], v[116:119], v[40:43], v[60:63]
    v_mfma_f32_16x16x32_bf16 v[64:67], v[112:115], v[44:47], v[64:67]
    v_mfma_f32_16x16x32_bf16 v[68:71], v[116:119], v[44:47], v[68:71]
    v_mfma_f32_16x16x32_bf16 v[72:75], v[112:115], v[48:51], v[72:75]
    v_mfma_f32_16x16x32_bf16 v[76:79], v[116:119], v[48:51], v[76:79]
    v_mfma_f32_16x16x32_bf16 v[80:83], v[112:115], v[52:55], v[80:83]
    v_mfma_f32_16x16x32_bf16 v[84:87], v[116:119], v[52:55], v[84:87]
    ds_read_b64_tr_b16 v[40:41], v16 offset:20480
    ds_read_b64_tr_b16 v[42:43], v16 offset:20992
    ds_read_b64_tr_b16 v[44:45], v17 offset:20480
    ds_read_b64_tr_b16 v[46:47], v17 offset:20992
    ds_read_b64_tr_b16 v[48:49], v18 offset:20480
    ds_read_b64_tr_b16 v[50:51], v18 offset:20992
    ds_read_b64_tr_b16 v[52:53], v19 offset:20480
    ds_read_b64_tr_b16 v[54:55], v19 offset:20992
    s_waitcnt vmcnt(30) lgkmcnt(8)
    v_mfma_f32_16x16x32_bf16 v[56:59], v[120:123], v[24:27], v[56:59]
    v_mfma_f32_16x16x32_bf16 v[60:63], v[124:127], v[24:27], v[60:63]
    v_mfma_f32_16x16x32_bf16 v[64:67], v[120:123], v[28:31], v[64:67]
    v_mfma_f32_16x16x32_bf16 v[68:71], v[124:127], v[28:31], v[68:71]
    v_mfma_f32_16x16x32_bf16 v[72:75], v[120:123], v[32:35], v[72:75]
    v_mfma_f32_16x16x32_bf16 v[76:79], v[124:127], v[32:35], v[76:79]
    v_mfma_f32_16x16x32_bf16 v[80:83], v[120:123], v[36:39], v[80:83]
    v_mfma_f32_16x16x32_bf16 v[84:87], v[124:127], v[36:39], v[84:87]
    ds_read_b64_tr_b16 v[24:25], v16 offset:24576
    ds_read_b64_tr_b16 v[26:27], v16 offset:25088
    ds_read_b64_tr_b16 v[28:29], v17 offset:24576
    ds_read_b64_tr_b16 v[30:31], v17 offset:25088
    ds_read_b64_tr_b16 v[32:33], v18 offset:24576
    ds_read_b64_tr_b16 v[34:35], v18 offset:25088
    ds_read_b64_tr_b16 v[36:37], v19 offset:24576
    ds_read_b64_tr_b16 v[38:39], v19 offset:25088
    s_waitcnt vmcnt(28) lgkmcnt(8)
    v_mfma_f32_16x16x32_bf16 v[56:59], v[128:131], v[40:43], v[56:59]
    v_mfma_f32_16x16x32_bf16 v[60:63], v[132:135], v[40:43], v[60:63]
    v_mfma_f32_16x16x32_bf16 v[64:67], v[128:131], v[44:47], v[64:67]
    v_mfma_f32_16x16x32_bf16 v[68:71], v[132:135], v[44:47], v[68:71]
    v_mfma_f32_16x16x32_bf16 v[72:75], v[128:131], v[48:51], v[72:75]
    v_mfma_f32_16x16x32_bf16 v[76:79], v[132:135], v[48:51], v[76:79]
    v_mfma_f32_16x16x32_bf16 v[80:83], v[128:131], v[52:55], v[80:83]
    v_mfma_f32_16x16x32_bf16 v[84:87], v[132:135], v[52:55], v[84:87]
    ds_read_b64_tr_b16 v[40:41], v16 offset:28672
    ds_read_b64_tr_b16 v[42:43], v16 offset:29184
    ds_read_b64_tr_b16 v[44:45], v17 offset:28672
    ds_read_b64_tr_b16 v[46:47], v17 offset:29184
    ds_read_b64_tr_b16 v[48:49], v18 offset:28672
    ds_read_b64_tr_b16 v[50:51], v18 offset:29184
    ds_read_b64_tr_b16 v[52:53], v19 offset:28672
    ds_read_b64_tr_b16 v[54:55], v19 offset:29184
    s_waitcnt vmcnt(26) lgkmcnt(8)
    v_mfma_f32_16x16x32_bf16 v[56:59], v[136:139], v[24:27], v[56:59]
    v_mfma_f32_16x16x32_bf16 v[60:63], v[140:143], v[24:27], v[60:63]
    v_mfma_f32_16x16x32_bf16 v[64:67], v[136:139], v[28:31], v[64:67]
    v_mfma_f32_16x16x32_bf16 v[68:71], v[140:143], v[28:31], v[68:71]
    v_mfma_f32_16x16x32_bf16 v[72:75], v[136:139], v[32:35], v[72:75]
    v_mfma_f32_16x16x32_bf16 v[76:79], v[140:143], v[32:35], v[76:79]
    v_mfma_f32_16x16x32_bf16 v[80:83], v[136:139], v[36:39], v[80:83]
    v_mfma_f32_16x16x32_bf16 v[84:87], v[140:143], v[36:39], v[84:87]
    ds_read_b64_tr_b16 v[24:25], v16 offset:32768
    ds_read_b64_tr_b16 v[26:27], v16 offset:33280
    ds_read_b64_tr_b16 v[28:29], v17 offset:32768
    ds_read_b64_tr_b16 v[30:31], v17 offset:33280
    ds_read_b64_tr_b16 v[32:33], v18 offset:32768
    ds_read_b64_tr_b16 v[34:35], v18 offset:33280
    ds_read_b64_tr_b16 v[36:37], v19 offset:32768
    ds_read_b64_tr_b16 v[38:39], v19 offset:33280
    s_waitcnt vmcnt(24) lgkmcnt(8)
    v_mfma_f32_16x16x32_bf16 v[56:59], v[144:147], v[40:43], v[56:59]
    v_mfma_f32_16x16x32_bf16 v[60:63], v[148:151], v[40:43], v[60:63]
    v_mfma_f32_16x16x32_bf16 v[64:67], v[144:147], v[44:47], v[64:67]
    v_mfma_f32_16x16x32_bf16 v[68:71], v[148:151], v[44:47], v[68:71]
    v_mfma_f32_16x16x32_bf16 v[72:75], v[144:147], v[48:51], v[72:75]
    v_mfma_f32_16x16x32_bf16 v[76:79], v[148:151], v[48:51], v[76:79]
    v_mfma_f32_16x16x32_bf16 v[80:83], v[144:147], v[52:55], v[80:83]
    v_mfma_f32_16x16x32_bf16 v[84:87], v[148:151], v[52:55], v[84:87]
    ds_read_b64_tr_b16 v[40:41], v16 offset:36864
    ds_read_b64_tr_b16 v[42:43], v16 offset:37376
    ds_read_b64_tr_b16 v[44:45], v17 offset:36864
    ds_read_b64_tr_b16 v[46:47], v17 offset:37376
    ds_read_b64_tr_b16 v[48:49], v18 offset:36864
    ds_read_b64_tr_b16 v[50:51], v18 offset:37376
    ds_read_b64_tr_b16 v[52:53], v19 offset:36864
    ds_read_b64_tr_b16 v[54:55], v19 offset:37376
    s_waitcnt vmcnt(22) lgkmcnt(8)
    v_mfma_f32_16x16x32_bf16 v[56:59], v[152:155], v[24:27], v[56:59]
    v_mfma_f32_16x16x32_bf16 v[60:63], v[156:159], v[24:27], v[60:63]
    v_mfma_f32_16x16x32_bf16 v[64:67], v[152:155], v[28:31], v[64:67]
    v_mfma_f32_16x16x32_bf16 v[68:71], v[156:159], v[28:31], v[68:71]
    v_mfma_f32_16x16x32_bf16 v[72:75], v[152:155], v[32:35], v[72:75]
    v_mfma_f32_16x16x32_bf16 v[76:79], v[156:159], v[32:35], v[76:79]
    v_mfma_f32_16x16x32_bf16 v[80:83], v[152:155], v[36:39], v[80:83]
    v_mfma_f32_16x16x32_bf16 v[84:87], v[156:159], v[36:39], v[84:87]
    ds_read_b64_tr_b16 v[24:25], v20 offset:0
    ds_read_b64_tr_b16 v[26:27], v20 offset:512
    ds_read_b64_tr_b16 v[28:29], v21 offset:0
    ds_read_b64_tr_b16 v[30:31], v21 offset:512
    ds_read_b64_tr_b16 v[32:33], v22 offset:0
    ds_read_b64_tr_b16 v[34:35], v22 offset:512
    ds_read_b64_tr_b16 v[36:37], v23 offset:0
    ds_read_b64_tr_b16 v[38:39], v23 offset:512
    s_waitcnt vmcnt(20) lgkmcnt(8)
    v_mfma_f32_16x16x32_bf16 v[56:59], v[160:163], v[40:43], v[56:59]
    v_mfma_f32_16x16x32_bf16 v[60:63], v[164:167], v[40:43], v[60:63]
    v_mfma_f32_16x16x32_bf16 v[64:67], v[160:163], v[44:47], v[64:67]
    v_mfma_f32_16x16x32_bf16 v[68:71], v[164:167], v[44:47], v[68:71]
    v_mfma_f32_16x16x32_bf16 v[72:75], v[160:163], v[48:51], v[72:75]
    v_mfma_f32_16x16x32_bf16 v[76:79], v[164:167], v[48:51], v[76:79]
    v_mfma_f32_16x16x32_bf16 v[80:83], v[160:163], v[52:55], v[80:83]
    v_mfma_f32_16x16x32_bf16 v[84:87], v[164:167], v[52:55], v[84:87]
    ds_read_b64_tr_b16 v[40:41], v20 offset:4096
    ds_read_b64_tr_b16 v[42:43], v20 offset:4608
    ds_read_b64_tr_b16 v[44:45], v21 offset:4096
    ds_read_b64_tr_b16 v[46:47], v21 offset:4608
    ds_read_b64_tr_b16 v[48:49], v22 offset:4096
    ds_read_b64_tr_b16 v[50:51], v22 offset:4608
    ds_read_b64_tr_b16 v[52:53], v23 offset:4096
    ds_read_b64_tr_b16 v[54:55], v23 offset:4608
    s_waitcnt vmcnt(18) lgkmcnt(8)
    v_mfma_f32_16x16x32_bf16 v[56:59], v[168:171], v[24:27], v[56:59]
    v_mfma_f32_16x16x32_bf16 v[60:63], v[172:175], v[24:27], v[60:63]
    v_mfma_f32_16x16x32_bf16 v[64:67], v[168:171], v[28:31], v[64:67]
    v_mfma_f32_16x16x32_bf16 v[68:71], v[172:175], v[28:31], v[68:71]
    v_mfma_f32_16x16x32_bf16 v[72:75], v[168:171], v[32:35], v[72:75]
    v_mfma_f32_16x16x32_bf16 v[76:79], v[172:175], v[32:35], v[76:79]
    v_mfma_f32_16x16x32_bf16 v[80:83], v[168:171], v[36:39], v[80:83]
    v_mfma_f32_16x16x32_bf16 v[84:87], v[172:175], v[36:39], v[84:87]
    ds_read_b64_tr_b16 v[24:25], v20 offset:8192
    ds_read_b64_tr_b16 v[26:27], v20 offset:8704
    ds_read_b64_tr_b16 v[28:29], v21 offset:8192
    ds_read_b64_tr_b16 v[30:31], v21 offset:8704
    ds_read_b64_tr_b16 v[32:33], v22 offset:8192
    ds_read_b64_tr_b16 v[34:35], v22 offset:8704
    ds_read_b64_tr_b16 v[36:37], v23 offset:8192
    ds_read_b64_tr_b16 v[38:39], v23 offset:8704
    s_waitcnt vmcnt(16) lgkmcnt(8)
    v_mfma_f32_16x16x32_bf16 v[56:59], v[176:179], v[40:43], v[56:59]
    v_mfma_f32_16x16x32_bf16 v[60:63], v[180:183], v[40:43], v[60:63]
    v_mfma_f32_16x16x32_bf16 v[64:67], v[176:179], v[44:47], v[64:67]
    v_mfma_f32_16x16x32_bf16 v[68:71], v[180:183], v[44:47], v[68:71]
    v_mfma_f32_16x16x32_bf16 v[72:75], v[176:179], v[48:51], v[72:75]
    v_mfma_f32_16x16x32_bf16 v[76:79], v[180:183], v[48:51], v[76:79]
    v_mfma_f32_16x16x32_bf16 v[80:83], v[176:179], v[52:55], v[80:83]
    v_mfma_f32_16x16x32_bf16 v[84:87], v[180:183], v[52:55], v[84:87]
    ds_read_b64_tr_b16 v[40:41], v20 offset:12288
    ds_read_b64_tr_b16 v[42:43], v20 offset:12800
    ds_read_b64_tr_b16 v[44:45], v21 offset:12288
    ds_read_b64_tr_b16 v[46:47], v21 offset:12800
    ds_read_b64_tr_b16 v[48:49], v22 offset:12288
    ds_read_b64_tr_b16 v[50:51], v22 offset:12800
    ds_read_b64_tr_b16 v[52:53], v23 offset:12288
    ds_read_b64_tr_b16 v[54:55], v23 offset:12800
    s_waitcnt vmcnt(14) lgkmcnt(8)
    v_mfma_f32_16x16x32_bf16 v[56:59], v[184:187], v[24:27], v[56:59]
    v_mfma_f32_16x16x32_bf16 v[60:63], v[188:191], v[24:27], v[60:63]
    v_mfma_f32_16x16x32_bf16 v[64:67], v[184:187], v[28:31], v[64:67]
    v_mfma_f32_16x16x32_bf16 v[68:71], v[188:191], v[28:31], v[68:71]
    v_mfma_f32_16x16x32_bf16 v[72:75], v[184:187], v[32:35], v[72:75]
    v_mfma_f32_16x16x32_bf16 v[76:79], v[188:191], v[32:35], v[76:79]
    v_mfma_f32_16x16x32_bf16 v[80:83], v[184:187], v[36:39], v[80:83]
    v_mfma_f32_16x16x32_bf16 v[84:87], v[188:191], v[36:39], v[84:87]
    ds_read_b64_tr_b16 v[24:25], v20 offset:16384
    ds_read_b64_tr_b16 v[26:27], v20 offset:16896
    ds_read_b64_tr_b16 v[28:29], v21 offset:16384
    ds_read_b64_tr_b16 v[30:31], v21 offset:16896
    ds_read_b64_tr_b16 v[32:33], v22 offset:16384
    ds_read_b64_tr_b16 v[34:35], v22 offset:16896
    ds_read_b64_tr_b16 v[36:37], v23 offset:16384
    ds_read_b64_tr_b16 v[38:39], v23 offset:16896
    s_waitcnt vmcnt(12) lgkmcnt(8)
    v_mfma_f32_16x16x32_bf16 v[56:59], v[192:195], v[40:43], v[56:59]
    v_mfma_f32_16x16x32_bf16 v[60:63], v[196:199], v[40:43], v[60:63]
    v_mfma_f32_16x16x32_bf16 v[64:67], v[192:195], v[44:47], v[64:67]
    v_mfma_f32_16x16x32_bf16 v[68:71], v[196:199], v[44:47], v[68:71]
    v_mfma_f32_16x16x32_bf16 v[72:75], v[192:195], v[48:51], v[72:75]
    v_mfma_f32_16x16x32_bf16 v[76:79], v[196:199], v[48:51], v[76:79]
    v_mfma_f32_16x16x32_bf16 v[80:83], v[192:195], v[52:55], v[80:83]
    v_mfma_f32_16x16x32_bf16 v[84:87], v[196:199], v[52:55], v[84:87]
    ds_read_b64_tr_b16 v[40:41], v20 offset:20480
    ds_read_b64_tr_b16 v[42:43], v20 offset:20992
    ds_read_b64_tr_b16 v[44:45], v21 offset:20480
    ds_read_b64_tr_b16 v[46:47], v21 offset:20992
    ds_read_b64_tr_b16 v[48:49], v22 offset:20480
    ds_read_b64_tr_b16 v[50:51], v22 offset:20992
    ds_read_b64_tr_b16 v[52:53], v23 offset:20480
    ds_read_b64_tr_b16 v[54:55], v23 offset:20992
    s_waitcnt vmcnt(10) lgkmcnt(8)
    v_mfma_f32_16x16x32_bf16 v[56:59], v[200:203], v[24:27], v[56:59]
    v_mfma_f32_16x16x32_bf16 v[60:63], v[204:207], v[24:27], v[60:63]
    v_mfma_f32_16x16x32_bf16 v[64:67], v[200:203], v[28:31], v[64:67]
    v_mfma_f32_16x16x32_bf16 v[68:71], v[204:207], v[28:31], v[68:71]
    v_mfma_f32_16x16x32_bf16 v[72:75], v[200:203], v[32:35], v[72:75]
    v_mfma_f32_16x16x32_bf16 v[76:79], v[204:207], v[32:35], v[76:79]
    v_mfma_f32_16x16x32_bf16 v[80:83], v[200:203], v[36:39], v[80:83]
    v_mfma_f32_16x16x32_bf16 v[84:87], v[204:207], v[36:39], v[84:87]
    ds_read_b64_tr_b16 v[24:25], v20 offset:24576
    ds_read_b64_tr_b16 v[26:27], v20 offset:25088
    ds_read_b64_tr_b16 v[28:29], v21 offset:24576
    ds_read_b64_tr_b16 v[30:31], v21 offset:25088
    ds_read_b64_tr_b16 v[32:33], v22 offset:24576
    ds_read_b64_tr_b16 v[34:35], v22 offset:25088
    ds_read_b64_tr_b16 v[36:37], v23 offset:24576
    ds_read_b64_tr_b16 v[38:39], v23 offset:25088
    s_waitcnt vmcnt(8) lgkmcnt(8)
    v_mfma_f32_16x16x32_bf16 v[56:59], v[208:211], v[40:43], v[56:59]
    v_mfma_f32_16x16x32_bf16 v[60:63], v[212:215], v[40:43], v[60:63]
    v_mfma_f32_16x16x32_bf16 v[64:67], v[208:211], v[44:47], v[64:67]
    v_mfma_f32_16x16x32_bf16 v[68:71], v[212:215], v[44:47], v[68:71]
    v_mfma_f32_16x16x32_bf16 v[72:75], v[208:211], v[48:51], v[72:75]
    v_mfma_f32_16x16x32_bf16 v[76:79], v[212:215], v[48:51], v[76:79]
    v_mfma_f32_16x16x32_bf16 v[80:83], v[208:211], v[52:55], v[80:83]
    v_mfma_f32_16x16x32_bf16 v[84:87], v[212:215], v[52:55], v[84:87]
    ds_read_b64_tr_b16 v[40:41], v20 offset:28672
    ds_read_b64_tr_b16 v[42:43], v20 offset:29184
    ds_read_b64_tr_b16 v[44:45], v21 offset:28672
    ds_read_b64_tr_b16 v[46:47], v21 offset:29184
    ds_read_b64_tr_b16 v[48:49], v22 offset:28672
    ds_read_b64_tr_b16 v[50:51], v22 offset:29184
    ds_read_b64_tr_b16 v[52:53], v23 offset:28672
    ds_read_b64_tr_b16 v[54:55], v23 offset:29184
    s_waitcnt vmcnt(6) lgkmcnt(8)
    v_mfma_f32_16x16x32_bf16 v[56:59], v[216:219], v[24:27], v[56:59]
    v_mfma_f32_16x16x32_bf16 v[60:63], v[220:223], v[24:27], v[60:63]
    v_mfma_f32_16x16x32_bf16 v[64:67], v[216:219], v[28:31], v[64:67]
    v_mfma_f32_16x16x32_bf16 v[68:71], v[220:223], v[28:31], v[68:71]
    v_mfma_f32_16x16x32_bf16 v[72:75], v[216:219], v[32:35], v[72:75]
    v_mfma_f32_16x16x32_bf16 v[76:79], v[220:223], v[32:35], v[76:79]
    v_mfma_f32_16x16x32_bf16 v[80:83], v[216:219], v[36:39], v[80:83]
    v_mfma_f32_16x16x32_bf16 v[84:87], v[220:223], v[36:39], v[84:87]
    ds_read_b64_tr_b16 v[24:25], v20 offset:32768
    ds_read_b64_tr_b16 v[26:27], v20 offset:33280
    ds_read_b64_tr_b16 v[28:29], v21 offset:32768
    ds_read_b64_tr_b16 v[30:31], v21 offset:33280
    ds_read_b64_tr_b16 v[32:33], v22 offset:32768
    ds_read_b64_tr_b16 v[34:35], v22 offset:33280
    ds_read_b64_tr_b16 v[36:37], v23 offset:32768
    ds_read_b64_tr_b16 v[38:39], v23 offset:33280
    s_waitcnt vmcnt(4) lgkmcnt(8)
    v_mfma_f32_16x16x32_bf16 v[56:59], v[224:227], v[40:43], v[56:59]
    v_mfma_f32_16x16x32_bf16 v[60:63], v[228:231], v[40:43], v[60:63]
    v_mfma_f32_16x16x32_bf16 v[64:67], v[224:227], v[44:47], v[64:67]
    v_mfma_f32_16x16x32_bf16 v[68:71], v[228:231], v[44:47], v[68:71]
    v_mfma_f32_16x16x32_bf16 v[72:75], v[224:227], v[48:51], v[72:75]
    v_mfma_f32_16x16x32_bf16 v[76:79], v[228:231], v[48:51], v[76:79]
    v_mfma_f32_16x16x32_bf16 v[80:83], v[224:227], v[52:55], v[80:83]
    v_mfma_f32_16x16x32_bf16 v[84:87], v[228:231], v[52:55], v[84:87]
    ds_read_b64_tr_b16 v[40:41], v20 offset:36864
    ds_read_b64_tr_b16 v[42:43], v20 offset:37376
    ds_read_b64_tr_b16 v[44:45], v21 offset:36864
    ds_read_b64_tr_b16 v[46:47], v21 offset:37376
    ds_read_b64_tr_b16 v[48:49], v22 offset:36864
    ds_read_b64_tr_b16 v[50:51], v22 offset:37376
    ds_read_b64_tr_b16 v[52:53], v23 offset:36864
    ds_read_b64_tr_b16 v[54:55], v23 offset:37376
    s_waitcnt vmcnt(2) lgkmcnt(8)
    v_mfma_f32_16x16x32_bf16 v[56:59], v[232:235], v[24:27], v[56:59]
    v_mfma_f32_16x16x32_bf16 v[60:63], v[236:239], v[24:27], v[60:63]
    v_mfma_f32_16x16x32_bf16 v[64:67], v[232:235], v[28:31], v[64:67]
    v_mfma_f32_16x16x32_bf16 v[68:71], v[236:239], v[28:31], v[68:71]
    v_mfma_f32_16x16x32_bf16 v[72:75], v[232:235], v[32:35], v[72:75]
    v_mfma_f32_16x16x32_bf16 v[76:79], v[236:239], v[32:35], v[76:79]
    v_mfma_f32_16x16x32_bf16 v[80:83], v[232:235], v[36:39], v[80:83]
    v_mfma_f32_16x16x32_bf16 v[84:87], v[236:239], v[36:39], v[84:87]
    s_waitcnt vmcnt(0) lgkmcnt(0)
    v_mfma_f32_16x16x32_bf16 v[56:59], v[240:243], v[40:43], v[56:59]
    v_mfma_f32_16x16x32_bf16 v[60:63], v[244:247], v[40:43], v[60:63]
    v_mfma_f32_16x16x32_bf16 v[64:67], v[240:243], v[44:47], v[64:67]
    v_mfma_f32_16x16x32_bf16 v[68:71], v[244:247], v[44:47], v[68:71]
    v_mfma_f32_16x16x32_bf16 v[72:75], v[240:243], v[48:51], v[72:75]
    v_mfma_f32_16x16x32_bf16 v[76:79], v[244:247], v[48:51], v[76:79]
    v_mfma_f32_16x16x32_bf16 v[80:83], v[240:243], v[52:55], v[80:83]
    v_mfma_f32_16x16x32_bf16 v[84:87], v[244:247], v[52:55], v[84:87]
    s_add_u32 s32, s38, 4096
    s_nop 4
    v_cvt_pk_bf16_f32 v24, v56, v57
    v_cvt_pk_bf16_f32 v25, v58, v59
    v_cvt_pk_bf16_f32 v26, v60, v61
    v_cvt_pk_bf16_f32 v27, v62, v63
    buffer_store_dwordx4 v[24:27], v14, s[8:11], s38 offen offset:0 sc1
    v_cvt_pk_bf16_f32 v28, v64, v65
    v_cvt_pk_bf16_f32 v29, v66, v67
    v_cvt_pk_bf16_f32 v30, v68, v69
    v_cvt_pk_bf16_f32 v31, v70, v71
    buffer_store_dwordx4 v[28:31], v14, s[8:11], s38 offen offset:1024 sc1
    v_cvt_pk_bf16_f32 v32, v72, v73
    v_cvt_pk_bf16_f32 v33, v74, v75
    v_cvt_pk_bf16_f32 v34, v76, v77
    v_cvt_pk_bf16_f32 v35, v78, v79
    buffer_store_dwordx4 v[32:35], v14, s[8:11], s38 offen offset:2048 sc1
    v_cvt_pk_bf16_f32 v36, v80, v81
    v_cvt_pk_bf16_f32 v37, v82, v83
    v_cvt_pk_bf16_f32 v38, v84, v85
    v_cvt_pk_bf16_f32 v39, v86, v87
    buffer_store_dwordx4 v[36:39], v14, s[8:11], s38 offen offset:3072 sc1
    s_waitcnt vmcnt(0)
    s_mov_b64 exec, 1
    buffer_store_dword v8, v9, s[8:11], s45 offen sc1
    s_mov_b64 exec, -1
    s_mul_i32 s44, s31, 40960
    s_add_u32 s44, s44, 121634816
    s_add_u32 s33, s44, 0
    s_add_u32 s47, s44, 20480
    buffer_load_dwordx4 v[88:91], v14, s[8:11], s33 offen offset:0
    buffer_load_dwordx4 v[92:95], v14, s[8:11], s47 offen offset:0
    buffer_load_dwordx4 v[96:99], v14, s[8:11], s33 offen offset:1024
    buffer_load_dwordx4 v[100:103], v14, s[8:11], s47 offen offset:1024
    buffer_load_dwordx4 v[104:107], v14, s[8:11], s33 offen offset:2048
    buffer_load_dwordx4 v[108:111], v14, s[8:11], s47 offen offset:2048
    buffer_load_dwordx4 v[112:115], v14, s[8:11], s33 offen offset:3072
    buffer_load_dwordx4 v[116:119], v14, s[8:11], s47 offen offset:3072
    s_add_u32 s33, s44, 4096
    s_add_u32 s47, s44, 24576
    buffer_load_dwordx4 v[120:123], v14, s[8:11], s33 offen offset:0
    buffer_load_dwordx4 v[124:127], v14, s[8:11], s47 offen offset:0
    buffer_load_dwordx4 v[128:131], v14, s[8:11], s33 offen offset:1024
    buffer_load_dwordx4 v[132:135], v14, s[8:11], s47 offen offset:1024
    buffer_load_dwordx4 v[136:139], v14, s[8:11], s33 offen offset:2048
    buffer_load_dwordx4 v[140:143], v14, s[8:11], s47 offen offset:2048
    buffer_load_dwordx4 v[144:147], v14, s[8:11], s33 offen offset:3072
    buffer_load_dwordx4 v[148:151], v14, s[8:11], s47 offen offset:3072
    s_add_u32 s33, s44, 8192
    s_add_u32 s47, s44, 28672
    buffer_load_dwordx4 v[152:155], v14, s[8:11], s33 offen offset:0
    buffer_load_dwordx4 v[156:159], v14, s[8:11], s47 offen offset:0
    buffer_load_dwordx4 v[160:163], v14, s[8:11], s33 offen offset:1024
    buffer_load_dwordx4 v[164:167], v14, s[8:11], s47 offen offset:1024
    buffer_load_dwordx4 v[168:171], v14, s[8:11], s33 offen offset:2048
    buffer_load_dwordx4 v[172:175], v14, s[8:11], s47 offen offset:2048
    buffer_load_dwordx4 v[176:179], v14, s[8:11], s33 offen offset:3072
    buffer_load_dwordx4 v[180:183], v14, s[8:11], s47 offen offset:3072
    s_add_u32 s33, s44, 12288
    s_add_u32 s47, s44, 32768
    buffer_load_dwordx4 v[184:187], v14, s[8:11], s33 offen offset:0
    buffer_load_dwordx4 v[188:191], v14, s[8:11], s47 offen offset:0
    buffer_load_dwordx4 v[192:195], v14, s[8:11], s33 offen offset:1024
    buffer_load_dwordx4 v[196:199], v14, s[8:11], s47 offen offset:1024
    buffer_load_dwordx4 v[200:203], v14, s[8:11], s33 offen offset:2048
    buffer_load_dwordx4 v[204:207], v14, s[8:11], s47 offen offset:2048
    buffer_load_dwordx4 v[208:211], v14, s[8:11], s33 offen offset:3072
    buffer_load_dwordx4 v[212:215], v14, s[8:11], s47 offen offset:3072
    s_add_u32 s33, s44, 16384
    s_add_u32 s47, s44, 36864
    buffer_load_dwordx4 v[216:219], v14, s[8:11], s33 offen offset:0
    buffer_load_dwordx4 v[220:223], v14, s[8:11], s47 offen offset:0
    buffer_load_dwordx4 v[224:227], v14, s[8:11], s33 offen offset:1024
    buffer_load_dwordx4 v[228:231], v14, s[8:11], s47 offen offset:1024
    buffer_load_dwordx4 v[232:235], v14, s[8:11], s33 offen offset:2048
    buffer_load_dwordx4 v[236:239], v14, s[8:11], s47 offen offset:2048
    buffer_load_dwordx4 v[240:243], v14, s[8:11], s33 offen offset:3072
    buffer_load_dwordx4 v[244:247], v14, s[8:11], s47 offen offset:3072
Lpj1_125:
    buffer_load_dword v4, v9, s[8:11], s46 offen
    buffer_load_dword v5, v9, s[8:11], s46 offen
    buffer_load_dword v6, v9, s[8:11], s46 offen
    buffer_load_dword v7, v9, s[8:11], s46 offen
Lpj_124:
    ds_read_b64_tr_b16 v[24:25], v16 offset:0
    ds_read_b64_tr_b16 v[26:27], v16 offset:512
    ds_read_b64_tr_b16 v[28:29], v17 offset:0
    ds_read_b64_tr_b16 v[30:31], v17 offset:512
    ds_read_b64_tr_b16 v[32:33], v18 offset:0
    ds_read_b64_tr_b16 v[34:35], v18 offset:512
    ds_read_b64_tr_b16 v[36:37], v19 offset:0
    ds_read_b64_tr_b16 v[38:39], v19 offset:512
    s_lshl_b32 s38, s31, 5
    s_add_u32 s38, s38, s99
    s_lshl_b32 s45, s38, 6
    s_add_u32 s45, s45, s42
    s_lshl_b32 s38, s38, 13
    s_lshl_b32 s33, s100, 24
    s_add_u32 s38, s38, s33
    s_lshl_b32 s33, s101, 12
    s_add_u32 s38, s38, s33
    s_add_u32 s43, s43, 1
    s_add_u32 s33, s31, 8
    s_cmp_ge_u32 s43, s41
    s_cselect_b32 s31, s31, s33
    s_mul_i32 s44, s31, 40960
    s_add_u32 s44, s44, 121634816
    ds_read_b64_tr_b16 v[40:41], v16 offset:4096
    ds_read_b64_tr_b16 v[42:43], v16 offset:4608
    ds_read_b64_tr_b16 v[44:45], v17 offset:4096
    ds_read_b64_tr_b16 v[46:47], v17 offset:4608
    ds_read_b64_tr_b16 v[48:49], v18 offset:4096
    ds_read_b64_tr_b16 v[50:51], v18 offset:4608
    ds_read_b64_tr_b16 v[52:53], v19 offset:4096
    ds_read_b64_tr_b16 v[54:55], v19 offset:4608
    s_waitcnt vmcnt(42) lgkmcnt(8)
    s_add_u32 s54, s44, 0
    s_add_u32 s55, s44, 20480
    v_mfma_f32_16x16x32_bf16 v[56:59], v[88:91], v[24:27], 0
    v_mfma_f32_16x16x32_bf16 v[60:63], v[92:95], v[24:27], 0
    v_mfma_f32_16x16x32_bf16 v[64:67], v[88:91], v[28:31], 0
    v_mfma_f32_16x16x32_bf16 v[68:71], v[92:95], v[28:31], 0
    v_mfma_f32_16x16x32_bf16 v[72:75], v[88:91], v[32:35], 0
    v_mfma_f32_16x16x32_bf16 v[76:79], v[92:95], v[32:35], 0
    v_mfma_f32_16x16x32_bf16 v[80:83], v[88:91], v[36:39], 0
    v_mfma_f32_16x16x32_bf16 v[84:87], v[92:95], v[36:39], 0
    buffer_load_dwordx4 v[88:91], v14, s[8:11], s54 offen offset:0
    buffer_load_dwordx4 v[92:95], v14, s[8:11], s55 offen offset:0
    ds_read_b64_tr_b16 v[24:25], v16 offset:8192
    ds_read_b64_tr_b16 v[26:27], v16 offset:8704
    ds_read_b64_tr_b16 v[28:29], v17 offset:8192
    ds_read_b64_tr_b16 v[30:31], v17 offset:8704
    ds_read_b64_tr_b16 v[32:33], v18 offset:8192
    ds_read_b64_tr_b16 v[34:35], v18 offset:8704
    ds_read_b64_tr_b16 v[36:37], v19 offset:8192
    ds_read_b64_tr_b16 v[38:39], v19 offset:8704
    s_waitcnt vmcnt(42) lgkmcnt(8)
    v_mfma_f32_16x16x32_bf16 v[56:59], v[96:99], v[40:43], v[56:59]
    v_mfma_f32_16x16x32_bf16 v[60:63], v[100:103], v[40:43], v[60:63]
    v_mfma_f32_16x16x32_bf16 v[64:67], v[96:99], v[44:47], v[64:67]
    v_mfma_f32_16x16x32_bf16 v[68:71], v[100:103], v[44:47], v[68:71]
    v_mfma_f32_16x16x32_bf16 v[72:75], v[96:99], v[48:51], v[72:75]
    v_mfma_f32_16x16x32_bf16 v[76:79], v[100:103], v[48:51], v[76:79]
    v_mfma_f32_16x16x32_bf16 v[80:83], v[96:99], v[52:55], v[80:83]
    v_mfma_f32_16x16x32_bf16 v[84:87], v[100:103], v[52:55], v[84:87]
    buffer_load_dwordx4 v[96:99], v14, s[8:11], s54 offen offset:1024
    buffer_load_dwordx4 v[100:103], v14, s[8:11], s55 offen offset:1024
    ds_read_b64_tr_b16 v[40:41], v16 offset:12288
    ds_read_b64_tr_b16 v[42:43], v16 offset:12800
    ds_read_b64_tr_b16 v[44:45], v17 offset:12288
    ds_read_b64_tr_b16 v[46:47], v17 offset:12800
    ds_read_b64_tr_b16 v[48:49], v18 offset:12288
    ds_read_b64_tr_b16 v[50:51], v18 offset:12800
    ds_read_b64_tr_b16 v[52:53], v19 offset:12288
    ds_read_b64_tr_b16 v[54:55], v19 offset:12800
    s_waitcnt vmcnt(42) lgkmcnt(8)
    v_mfma_f32_16x16x32_bf16 v[56:59], v[104:107], v[24:27], v[56:59]
    v_mfma_f32_16x16x32_bf16 v[60:63], v[108:111], v[24:27], v[60:63]
    v_mfma_f32_16x16x32_bf16 v[64:67], v[104:107], v[28:31], v[64:67]
    v_mfma_f32_16x16x32_bf16 v[68:71], v[108:111], v[28:31], v[68:71]
    v_mfma_f32_16x16x32_bf16 v[72:75], v[104:107], v[32:35], v[72:75]
    v_mfma_f32_16x16x32_bf16 v[76:79], v[108:111], v[32:35], v[76:79]
    v_mfma_f32_16x16x32_bf16 v[80:83], v[104:107], v[36:39], v[80:83]
    v_mfma_f32_16x16x32_bf16 v[84:87], v[108:111], v[36:39], v[84:87]
    buffer_load_dwordx4 v[104:107], v14, s[8:11], s54 offen offset:2048
    buffer_load_dwordx4 v[108:111], v14, s[8:11], s55 offen offset:2048
    ds_read_b64_tr_b16 v[24:25], v16 offset:16384
    ds_read_b64_tr_b16 v[26:27], v16 offset:16896
    ds_read_b64_tr_b16 v[28:29], v17 offset:16384
    ds_read_b64_tr_b16 v[30:31], v17 offset:16896
    ds_read_b64_tr_b16 v[32:33], v18 offset:16384
    ds_read_b64_tr_b16 v[34:35], v18 offset:16896
    ds_read_b64_tr_b16 v[36:37], v19 offset:16384
    ds_read_b64_tr_b16 v[38:39], v19 offset:16896
    s_waitcnt vmcnt(42) lgkmcnt(8)
    v_mfma_f32_16x16x32_bf16 v[56:59], v[112:115], v[40:43], v[56:59]
    v_mfma_f32_16x16x32_bf16 v[60:63], v[116:119], v[40:43], v[60:63]
    v_mfma_f32_16x16x32_bf16 v[64:67], v[112:115], v[44:47], v[64:67]
    v_mfma_f32_16x16x32_bf16 v[68:71], v[116:119], v[44:47], v[68:71]
    v_mfma_f32_16x16x32_bf16 v[72:75], v[112:115], v[48:51], v[72:75]
    v_mfma_f32_16x16x32_bf16 v[76:79], v[116:119], v[48:51], v[76:79]
    v_mfma_f32_16x16x32_bf16 v[80:83], v[112:115], v[52:55], v[80:83]
    v_mfma_f32_16x16x32_bf16 v[84:87], v[116:119], v[52:55], v[84:87]
    buffer_load_dwordx4 v[112:115], v14, s[8:11], s54 offen offset:3072
    buffer_load_dwordx4 v[116:119], v14, s[8:11], s55 offen offset:3072
    ds_read_b64_tr_b16 v[40:41], v16 offset:20480
    ds_read_b64_tr_b16 v[42:43], v16 offset:20992
    ds_read_b64_tr_b16 v[44:45], v17 offset:20480
    ds_read_b64_tr_b16 v[46:47], v17 offset:20992
    ds_read_b64_tr_b16 v[48:49], v18 offset:20480
    ds_read_b64_tr_b16 v[50:51], v18 offset:20992
    ds_read_b64_tr_b16 v[52:53], v19 offset:20480
    ds_read_b64_tr_b16 v[54:55], v19 offset:20992
    s_waitcnt vmcnt(42) lgkmcnt(8)
    s_add_u32 s54, s44, 4096
    s_add_u32 s55, s44, 24576
    v_mfma_f32_16x16x32_bf16 v[56:59], v[120:123], v[24:27], v[56:59]
    v_mfma_f32_16x16x32_bf16 v[60:63], v[124:127], v[24:27], v[60:63]
    v_mfma_f32_16x16x32_bf16 v[64:67], v[120:123], v[28:31], v[64:67]
    v_mfma_f32_16x16x32_bf16 v[68:71], v[124:127], v[28:31], v[68:71]
    v_mfma_f32_16x16x32_bf16 v[72:75], v[120:123], v[32:35], v[72:75]
    v_mfma_f32_16x16x32_bf16 v[76:79], v[124:127], v[32:35], v[76:79]
    v_mfma_f32_16x16x32_bf16 v[80:83], v[120:123], v[36:39], v[80:83]
    v_mfma_f32_16x16x32_bf16 v[84:87], v[124:127], v[36:39], v[84:87]
    buffer_load_dwordx4 v[120:123], v14, s[8:11], s54 offen offset:0
    buffer_load_dwordx4 v[124:127], v14, s[8:11], s55 offen offset:0
    ds_read_b64_tr_b16 v[24:25], v16 offset:24576
    ds_read_b64_tr_b16 v[26:27], v16 offset:25088
    ds_read_b64_tr_b16 v[28:29], v17 offset:24576
    ds_read_b64_tr_b16 v[30:31], v17 offset:25088
    ds_read_b64_tr_b16 v[32:33], v18 offset:24576
    ds_read_b64_tr_b16 v[34:35], v18 offset:25088
    ds_read_b64_tr_b16 v[36:37], v19 offset:24576
    ds_read_b64_tr_b16 v[38:39], v19 offset:25088
    s_waitcnt vmcnt(42) lgkmcnt(8)
    v_mfma_f32_16x16x32_bf16 v[56:59], v[128:131], v[40:43], v[56:59]
    v_mfma_f32_16x16x32_bf16 v[60:63], v[132:135], v[40:43], v[60:63]
    v_mfma_f32_16x16x32_bf16 v[64:67], v[128:131], v[44:47], v[64:67]
    v_mfma_f32_16x16x32_bf16 v[68:71], v[132:135], v[44:47], v[68:71]
    v_mfma_f32_16x16x32_bf16 v[72:75], v[128:131], v[48:51], v[72:75]
    v_mfma_f32_16x16x32_bf16 v[76:79], v[132:135], v[48:51], v[76:79]
    v_mfma_f32_16x16x32_bf16 v[80:83], v[128:131], v[52:55], v[80:83]
    v_mfma_f32_16x16x32_bf16 v[84:87], v[132:135], v[52:55], v[84:87]
    buffer_load_dwordx4 v[128:131], v14, s[8:11], s54 offen offset:1024
    buffer_load_dwordx4 v[132:135], v14, s[8:11], s55 offen offset:1024
    ds_read_b64_tr_b16 v[40:41], v16 offset:28672
    ds_read_b64_tr_b16 v[42:43], v16 offset:29184
    ds_read_b64_tr_b16 v[44:45], v17 offset:28672
    ds_read_b64_tr_b16 v[46:47], v17 offset:29184
    ds_read_b64_tr_b16 v[48:49], v18 offset:28672
    ds_read_b64_tr_b16 v[50:51], v18 offset:29184
    ds_read_b64_tr_b16 v[52:53], v19 offset:28672
    ds_read_b64_tr_b16 v[54:55], v19 offset:29184
    s_waitcnt vmcnt(12) lgkmcnt(8)
    s_mov_b64 exec, 1
    buffer_store_dword v8, v9, s[8:11], s46 offen sc1
    s_mov_b64 exec, -1
    v_mfma_f32_16x16x32_bf16 v[56:59], v[136:139], v[24:27], v[56:59]
    v_mfma_f32_16x16x32_bf16 v[60:63], v[140:143], v[24:27], v[60:63]
    v_mfma_f32_16x16x32_bf16 v[64:67], v[136:139], v[28:31], v[64:67]
    v_mfma_f32_16x16x32_bf16 v[68:71], v[140:143], v[28:31], v[68:71]
    v_mfma_f32_16x16x32_bf16 v[72:75], v[136:139], v[32:35], v[72:75]
    v_mfma_f32_16x16x32_bf16 v[76:79], v[140:143], v[32:35], v[76:79]
    v_mfma_f32_16x16x32_bf16 v[80:83], v[136:139], v[36:39], v[80:83]
    v_mfma_f32_16x16x32_bf16 v[84:87], v[140:143], v[36:39], v[84:87]
    buffer_load_dwordx4 v[136:139], v14, s[8:11], s54 offen offset:2048
    buffer_load_dwordx4 v[140:143], v14, s[8:11], s55 offen offset:2048
    ds_read_b64_tr_b16 v[24:25], v16 offset:32768
    ds_read_b64_tr_b16 v[26:27], v16 offset:33280
    ds_read_b64_tr_b16 v[28:29], v17 offset:32768
    ds_read_b64_tr_b16 v[30:31], v17 offset:33280
    ds_read_b64_tr_b16 v[32:33], v18 offset:32768
    ds_read_b64_tr_b16 v[34:35], v18 offset:33280
    ds_read_b64_tr_b16 v[36:37], v19 offset:32768
    ds_read_b64_tr_b16 v[38:39], v19 offset:33280
    s_waitcnt vmcnt(43) lgkmcnt(8)
    v_mfma_f32_16x16x32_bf16 v[56:59], v[144:147], v[40:43], v[56:59]
    v_mfma_f32_16x16x32_bf16 v[60:63], v[148:151], v[40:43], v[60:63]
    v_mfma_f32_16x16x32_bf16 v[64:67], v[144:147], v[44:47], v[64:67]
    v_mfma_f32_16x16x32_bf16 v[68:71], v[148:151], v[44:47], v[68:71]
    v_mfma_f32_16x16x32_bf16 v[72:75], v[144:147], v[48:51], v[72:75]
    v_mfma_f32_16x16x32_bf16 v[76:79], v[148:151], v[48:51], v[76:79]
    v_mfma_f32_16x16x32_bf16 v[80:83], v[144:147], v[52:55], v[80:83]
    v_mfma_f32_16x16x32_bf16 v[84:87], v[148:151], v[52:55], v[84:87]
    buffer_load_dwordx4 v[144:147], v14, s[8:11], s54 offen offset:3072
    buffer_load_dwordx4 v[148:151], v14, s[8:11], s55 offen offset:3072
    ds_read_b64_tr_b16 v[40:41], v16 offset:36864
    ds_read_b64_tr_b16 v[42:43], v16 offset:37376
    ds_read_b64_tr_b16 v[44:45], v17 offset:36864
    ds_read_b64_tr_b16 v[46:47], v17 offset:37376
    ds_read_b64_tr_b16 v[48:49], v18 offset:36864
    ds_read_b64_tr_b16 v[50:51], v18 offset:37376
    ds_read_b64_tr_b16 v[52:53], v19 offset:36864
    ds_read_b64_tr_b16 v[54:55], v19 offset:37376
    s_waitcnt vmcnt(43) lgkmcnt(8)
    s_add_u32 s54, s44, 8192
    s_add_u32 s55, s44, 28672
    v_mfma_f32_16x16x32_bf16 v[56:59], v[152:155], v[24:27], v[56:59]
    v_mfma_f32_16x16x32_bf16 v[60:63], v[156:159], v[24:27], v[60:63]
    v_mfma_f32_16x16x32_bf16 v[64:67], v[152:155], v[28:31], v[64:67]
    v_mfma_f32_16x16x32_bf16 v[68:71], v[156:159], v[28:31], v[68:71]
    v_mfma_f32_16x16x32_bf16 v[72:75], v[152:155], v[32:35], v[72:75]
    v_mfma_f32_16x16x32_bf16 v[76:79], v[156:159], v[32:35], v[76:79]
    v_mfma_f32_16x16x32_bf16 v[80:83], v[152:155], v[36:39], v[80:83]
    v_mfma_f32_16x16x32_bf16 v[84:87], v[156:159], v[36:39], v[84:87]
    buffer_load_dwordx4 v[152:155], v14, s[8:11], s54 offen offset:0
    buffer_load_dwordx4 v[156:159], v14, s[8:11], s55 offen offset:0
    ds_read_b64_tr_b16 v[24:25], v20 offset:0
    ds_read_b64_tr_b16 v[26:27], v20 offset:512
    ds_read_b64_tr_b16 v[28:29], v21 offset:0
    ds_read_b64_tr_b16 v[30:31], v21 offset:512
    ds_read_b64_tr_b16 v[32:33], v22 offset:0
    ds_read_b64_tr_b16 v[34:35], v22 offset:512
    ds_read_b64_tr_b16 v[36:37], v23 offset:0
    ds_read_b64_tr_b16 v[38:39], v23 offset:512
    s_waitcnt vmcnt(43) lgkmcnt(8)
    v_mfma_f32_16x16x32_bf16 v[56:59], v[160:163], v[40:43], v[56:59]
    v_mfma_f32_16x16x32_bf16 v[60:63], v[164:167], v[40:43], v[60:63]
    v_mfma_f32_16x16x32_bf16 v[64:67], v[160:163], v[44:47], v[64:67]
    v_mfma_f32_16x16x32_bf16 v[68:71], v[164:167], v[44:47], v[68:71]
    v_mfma_f32_16x16x32_bf16 v[72:75], v[160:163], v[48:51], v[72:75]
    v_mfma_f32_16x16x32_bf16 v[76:79], v[164:167], v[48:51], v[76:79]
    v_mfma_f32_16x16x32_bf16 v[80:83], v[160:163], v[52:55], v[80:83]
    v_mfma_f32_16x16x32_bf16 v[84:87], v[164:167], v[52:55], v[84:87]
    buffer_load_dwordx4 v[160:163], v14, s[8:11], s54 offen offset:1024
    buffer_load_dwordx4 v[164:167], v14, s[8:11], s55 offen offset:1024
    ds_read_b64_tr_b16 v[40:41], v20 offset:4096
    ds_read_b64_tr_b16 v[42:43], v20 offset:4608
    ds_read_b64_tr_b16 v[44:45], v21 offset:4096
    ds_read_b64_tr_b16 v[46:47], v21 offset:4608
    ds_read_b64_tr_b16 v[48:49], v22 offset:4096
    ds_read_b64_tr_b16 v[50:51], v22 offset:4608
    ds_read_b64_tr_b16 v[52:53], v23 offset:4096
    ds_read_b64_tr_b16 v[54:55], v23 offset:4608
    s_waitcnt vmcnt(43) lgkmcnt(8)
    v_mfma_f32_16x16x32_bf16 v[56:59], v[168:171], v[24:27], v[56:59]
    v_mfma_f32_16x16x32_bf16 v[60:63], v[172:175], v[24:27], v[60:63]
    v_mfma_f32_16x16x32_bf16 v[64:67], v[168:171], v[28:31], v[64:67]
    v_mfma_f32_16x16x32_bf16 v[68:71], v[172:175], v[28:31], v[68:71]
    v_mfma_f32_16x16x32_bf16 v[72:75], v[168:171], v[32:35], v[72:75]
    v_mfma_f32_16x16x32_bf16 v[76:79], v[172:175], v[32:35], v[76:79]
    v_mfma_f32_16x16x32_bf16 v[80:83], v[168:171], v[36:39], v[80:83]
    v_mfma_f32_16x16x32_bf16 v[84:87], v[172:175], v[36:39], v[84:87]
    buffer_load_dwordx4 v[168:171], v14, s[8:11], s54 offen offset:2048
    buffer_load_dwordx4 v[172:175], v14, s[8:11], s55 offen offset:2048
    ds_read_b64_tr_b16 v[24:25], v20 offset:8192
    ds_read_b64_tr_b16 v[26:27], v20 offset:8704
    ds_read_b64_tr_b16 v[28:29], v21 offset:8192
    ds_read_b64_tr_b16 v[30:31], v21 offset:8704
    ds_read_b64_tr_b16 v[32:33], v22 offset:8192
    ds_read_b64_tr_b16 v[34:35], v22 offset:8704
    ds_read_b64_tr_b16 v[36:37], v23 offset:8192
    ds_read_b64_tr_b16 v[38:39], v23 offset:8704
    s_waitcnt vmcnt(43) lgkmcnt(8)
    v_mfma_f32_16x16x32_bf16 v[56:59], v[176:179], v[40:43], v[56:59]
    v_mfma_f32_16x16x32_bf16 v[60:63], v[180:183], v[40:43], v[60:63]
    v_mfma_f32_16x16x32_bf16 v[64:67], v[176:179], v[44:47], v[64:67]
    v_mfma_f32_16x16x32_bf16 v[68:71], v[180:183], v[44:47], v[68:71]
    v_mfma_f32_16x16x32_bf16 v[72:75], v[176:179], v[48:51], v[72:75]
    v_mfma_f32_16x16x32_bf16 v[76:79], v[180:183], v[48:51], v[76:79]
    v_mfma_f32_16x16x32_bf16 v[80:83], v[176:179], v[52:55], v[80:83]
    v_mfma_f32_16x16x32_bf16 v[84:87], v[180:183], v[52:55], v[84:87]
    buffer_load_dwordx4 v[176:179], v14, s[8:11], s54 offen offset:3072
    buffer_load_dwordx4 v[180:183], v14, s[8:11], s55 offen offset:3072
    ds_read_b64_tr_b16 v[40:41], v20 offset:12288
    ds_read_b64_tr_b16 v[42:43], v20 offset:12800
    ds_read_b64_tr_b16 v[44:45], v21 offset:12288
    ds_read_b64_tr_b16 v[46:47], v21 offset:12800
    ds_read_b64_tr_b16 v[48:49], v22 offset:12288
    ds_read_b64_tr_b16 v[50:51], v22 offset:12800
    ds_read_b64_tr_b16 v[52:53], v23 offset:12288
    ds_read_b64_tr_b16 v[54:55], v23 offset:12800
    s_waitcnt vmcnt(43) lgkmcnt(8)
    s_add_u32 s54, s44, 12288
    s_add_u32 s55, s44, 32768
    v_mfma_f32_16x16x32_bf16 v[56:59], v[184:187], v[24:27], v[56:59]
    v_mfma_f32_16x16x32_bf16 v[60:63], v[188:191], v[24:27], v[60:63]
    v_mfma_f32_16x16x32_bf16 v[64:67], v[184:187], v[28:31], v[64:67]
    v_mfma_f32_16x16x32_bf16 v[68:71], v[188:191], v[28:31], v[68:71]
    v_mfma_f32_16x16x32_bf16 v[72:75], v[184:187], v[32:35], v[72:75]
    v_mfma_f32_16x16x32_bf16 v[76:79], v[188:191], v[32:35], v[76:79]
    v_mfma_f32_16x16x32_bf16 v[80:83], v[184:187], v[36:39], v[80:83]
    v_mfma_f32_16x16x32_bf16 v[84:87], v[188:191], v[36:39], v[84:87]
    buffer_load_dwordx4 v[184:187], v14, s[8:11], s54 offen offset:0
    buffer_load_dwordx4 v[188:191], v14, s[8:11], s55 offen offset:0
    ds_read_b64_tr_b16 v[24:25], v20 offset:16384
    ds_read_b64_tr_b16 v[26:27], v20 offset:16896
    ds_read_b64_tr_b16 v[28:29], v21 offset:16384
    ds_read_b64_tr_b16 v[30:31], v21 offset:16896
    ds_read_b64_tr_b16 v[32:33], v22 offset:16384
    ds_read_b64_tr_b16 v[34:35], v22 offset:16896
    ds_read_b64_tr_b16 v[36:37], v23 offset:16384
    ds_read_b64_tr_b16 v[38:39], v23 offset:16896
    s_waitcnt vmcnt(43) lgkmcnt(8)
    v_mfma_f32_16x16x32_bf16 v[56:59], v[192:195], v[40:43], v[56:59]
    v_mfma_f32_16x16x32_bf16 v[60:63], v[196:199], v[40:43], v[60:63]
    v_mfma_f32_16x16x32_bf16 v[64:67], v[192:195], v[44:47], v[64:67]
    v_mfma_f32_16x16x32_bf16 v[68:71], v[196:199], v[44:47], v[68:71]
    v_mfma_f32_16x16x32_bf16 v[72:75], v[192:195], v[48:51], v[72:75]
    v_mfma_f32_16x16x32_bf16 v[76:79], v[196:199], v[48:51], v[76:79]
    v_mfma_f32_16x16x32_bf16 v[80:83], v[192:195], v[52:55], v[80:83]
    v_mfma_f32_16x16x32_bf16 v[84:87], v[196:199], v[52:55], v[84:87]
    buffer_load_dwordx4 v[192:195], v14, s[8:11], s54 offen offset:1024
    buffer_load_dwordx4 v[196:199], v14, s[8:11], s55 offen offset:1024
    ds_read_b64_tr_b16 v[40:41], v20 offset:20480
    ds_read_b64_tr_b16 v[42:43], v20 offset:20992
    ds_read_b64_tr_b16 v[44:45], v21 offset:20480
    ds_read_b64_tr_b16 v[46:47], v21 offset:20992
    ds_read_b64_tr_b16 v[48:49], v22 offset:20480
    ds_read_b64_tr_b16 v[50:51], v22 offset:20992
    ds_read_b64_tr_b16 v[52:53], v23 offset:20480
    ds_read_b64_tr_b16 v[54:55], v23 offset:20992
    s_waitcnt vmcnt(43) lgkmcnt(8)
    v_mfma_f32_16x16x32_bf16 v[56:59], v[200:203], v[24:27], v[56:59]
    v_mfma_f32_16x16x32_bf16 v[60:63], v[204:207], v[24:27], v[60:63]
    v_mfma_f32_16x16x32_bf16 v[64:67], v[200:203], v[28:31], v[64:67]
    v_mfma_f32_16x16x32_bf16 v[68:71], v[204:207], v[28:31], v[68:71]
    v_mfma_f32_16x16x32_bf16 v[72:75], v[200:203], v[32:35], v[72:75]
    v_mfma_f32_16x16x32_bf16 v[76:79], v[204:207], v[32:35], v[76:79]
    v_mfma_f32_16x16x32_bf16 v[80:83], v[200:203], v[36:39], v[80:83]
    v_mfma_f32_16x16x32_bf16 v[84:87], v[204:207], v[36:39], v[84:87]
    buffer_load_dwordx4 v[200:203], v14, s[8:11], s54 offen offset:2048
    buffer_load_dwordx4 v[204:207], v14, s[8:11], s55 offen offset:2048
    ds_read_b64_tr_b16 v[24:25], v20 offset:24576
    ds_read_b64_tr_b16 v[26:27], v20 offset:25088
    ds_read_b64_tr_b16 v[28:29], v21 offset:24576
    ds_read_b64_tr_b16 v[30:31], v21 offset:25088
    ds_read_b64_tr_b16 v[32:33], v22 offset:24576
    ds_read_b64_tr_b16 v[34:35], v22 offset:25088
    ds_read_b64_tr_b16 v[36:37], v23 offset:24576
    ds_read_b64_tr_b16 v[38:39], v23 offset:25088
    s_waitcnt vmcnt(43) lgkmcnt(8)
    v_mfma_f32_16x16x32_bf16 v[56:59], v[208:211], v[40:43], v[56:59]
    v_mfma_f32_16x16x32_bf16 v[60:63], v[212:215], v[40:43], v[60:63]
    v_mfma_f32_16x16x32_bf16 v[64:67], v[208:211], v[44:47], v[64:67]
    v_mfma_f32_16x16x32_bf16 v[68:71], v[212:215], v[44:47], v[68:71]
    v_mfma_f32_16x16x32_bf16 v[72:75], v[208:211], v[48:51], v[72:75]
    v_mfma_f32_16x16x32_bf16 v[76:79], v[212:215], v[48:51], v[76:79]
    v_mfma_f32_16x16x32_bf16 v[80:83], v[208:211], v[52:55], v[80:83]
    v_mfma_f32_16x16x32_bf16 v[84:87], v[212:215], v[52:55], v[84:87]
    buffer_load_dwordx4 v[208:211], v14, s[8:11], s54 offen offset:3072
    buffer_load_dwordx4 v[212:215], v14, s[8:11], s55 offen offset:3072
    ds_read_b64_tr_b16 v[40:41], v20 offset:28672
    ds_read_b64_tr_b16 v[42:43], v20 offset:29184
    ds_read_b64_tr_b16 v[44:45], v21 offset:28672
    ds_read_b64_tr_b16 v[46:47], v21 offset:29184
    ds_read_b64_tr_b16 v[48:49], v22 offset:28672
    ds_read_b64_tr_b16 v[50:51], v22 offset:29184
    ds_read_b64_tr_b16 v[52:53], v23 offset:28672
    ds_read_b64_tr_b16 v[54:55], v23 offset:29184
    s_waitcnt vmcnt(43) lgkmcnt(8)
    s_add_u32 s54, s44, 16384
    s_add_u32 s55, s44, 36864
    v_mfma_f32_16x16x32_bf16 v[56:59], v[216:219], v[24:27], v[56:59]
    v_mfma_f32_16x16x32_bf16 v[60:63], v[220:223], v[24:27], v[60:63]
    v_mfma_f32_16x16x32_bf16 v[64:67], v[216:219], v[28:31], v[64:67]
    v_mfma_f32_16x16x32_bf16 v[68:71], v[220:223], v[28:31], v[68:71]
    v_mfma_f32_16x16x32_bf16 v[72:75], v[216:219], v[32:35], v[72:75]
    v_mfma_f32_16x16x32_bf16 v[76:79], v[220:223], v[32:35], v[76:79]
    v_mfma_f32_16x16x32_bf16 v[80:83], v[216:219], v[36:39], v[80:83]
    v_mfma_f32_16x16x32_bf16 v[84:87], v[220:223], v[36:39], v[84:87]
    buffer_load_dwordx4 v[216:219], v14, s[8:11], s54 offen offset:0
    buffer_load_dwordx4 v[220:223], v14, s[8:11], s55 offen offset:0
    ds_read_b64_tr_b16 v[24:25], v20 offset:32768
    ds_read_b64_tr_b16 v[26:27], v20 offset:33280
    ds_read_b64_tr_b16 v[28:29], v21 offset:32768
    ds_read_b64_tr_b16 v[30:31], v21 offset:33280
    ds_read_b64_tr_b16 v[32:33], v22 offset:32768
    ds_read_b64_tr_b16 v[34:35], v22 offset:33280
    ds_read_b64_tr_b16 v[36:37], v23 offset:32768
    ds_read_b64_tr_b16 v[38:39], v23 offset:33280
    s_waitcnt vmcnt(43) lgkmcnt(8)
    v_mfma_f32_16x16x32_bf16 v[56:59], v[224:227], v[40:43], v[56:59]
    v_mfma_f32_16x16x32_bf16 v[60:63], v[228:231], v[40:43], v[60:63]
    v_mfma_f32_16x16x32_bf16 v[64:67], v[224:227], v[44:47], v[64:67]
    v_mfma_f32_16x16x32_bf16 v[68:71], v[228:231], v[44:47], v[68:71]
    v_mfma_f32_16x16x32_bf16 v[72:75], v[224:227], v[48:51], v[72:75]
    v_mfma_f32_16x16x32_bf16 v[76:79], v[228:231], v[48:51], v[76:79]
    v_mfma_f32_16x16x32_bf16 v[80:83], v[224:227], v[52:55], v[80:83]
    v_mfma_f32_16x16x32_bf16 v[84:87], v[228:231], v[52:55], v[84:87]
    buffer_load_dwordx4 v[224:227], v14, s[8:11], s54 offen offset:1024
    buffer_load_dwordx4 v[228:231], v14, s[8:11], s55 offen offset:1024
    ds_read_b64_tr_b16 v[40:41], v20 offset:36864
    ds_read_b64_tr_b16 v[42:43], v20 offset:37376
    ds_read_b64_tr_b16 v[44:45], v21 offset:36864
    ds_read_b64_tr_b16 v[46:47], v21 offset:37376
    ds_read_b64_tr_b16 v[48:49], v22 offset:36864
    ds_read_b64_tr_b16 v[50:51], v22 offset:37376
    ds_read_b64_tr_b16 v[52:53], v23 offset:36864
    ds_read_b64_tr_b16 v[54:55], v23 offset:37376
    s_waitcnt vmcnt(43) lgkmcnt(8)
    v_mfma_f32_16x16x32_bf16 v[56:59], v[232:235], v[24:27], v[56:59]
    v_mfma_f32_16x16x32_bf16 v[60:63], v[236:239], v[24:27], v[60:63]
    v_mfma_f32_16x16x32_bf16 v[64:67], v[232:235], v[28:31], v[64:67]
    v_mfma_f32_16x16x32_bf16 v[68:71], v[236:239], v[28:31], v[68:71]
    v_mfma_f32_16x16x32_bf16 v[72:75], v[232:235], v[32:35], v[72:75]
    v_mfma_f32_16x16x32_bf16 v[76:79], v[236:239], v[32:35], v[76:79]
    v_mfma_f32_16x16x32_bf16 v[80:83], v[232:235], v[36:39], v[80:83]
    v_mfma_f32_16x16x32_bf16 v[84:87], v[236:239], v[36:39], v[84:87]
    buffer_load_dwordx4 v[232:235], v14, s[8:11], s54 offen offset:2048
    buffer_load_dwordx4 v[236:239], v14, s[8:11], s55 offen offset:2048
    s_waitcnt vmcnt(43) lgkmcnt(0)
    v_mfma_f32_16x16x32_bf16 v[56:59], v[240:243], v[40:43], v[56:59]
    v_mfma_f32_16x16x32_bf16 v[60:63], v[244:247], v[40:43], v[60:63]
    v_mfma_f32_16x16x32_bf16 v[64:67], v[240:243], v[44:47], v[64:67]
    v_mfma_f32_16x16x32_bf16 v[68:71], v[244:247], v[44:47], v[68:71]
    v_mfma_f32_16x16x32_bf16 v[72:75], v[240:243], v[48:51], v[72:75]
    v_mfma_f32_16x16x32_bf16 v[76:79], v[244:247], v[48:51], v[76:79]
    v_mfma_f32_16x16x32_bf16 v[80:83], v[240:243], v[52:55], v[80:83]
    v_mfma_f32_16x16x32_bf16 v[84:87], v[244:247], v[52:55], v[84:87]
    buffer_load_dwordx4 v[240:243], v14, s[8:11], s54 offen offset:3072
    buffer_load_dwordx4 v[244:247], v14, s[8:11], s55 offen offset:3072
    s_mov_b32 s46, s45
    s_add_u32 s32, s38, 4096
    s_nop 4
    v_cvt_pk_bf16_f32 v24, v56, v57
    v_cvt_pk_bf16_f32 v25, v58, v59
    v_cvt_pk_bf16_f32 v26, v60, v61
    v_cvt_pk_bf16_f32 v27, v62, v63
    buffer_store_dwordx4 v[24:27], v14, s[8:11], s38 offen offset:0 sc1
    v_cvt_pk_bf16_f32 v28, v64, v65
    v_cvt_pk_bf16_f32 v29, v66, v67
    v_cvt_pk_bf16_f32 v30, v68, v69
    v_cvt_pk_bf16_f32 v31, v70, v71
    buffer_store_dwordx4 v[28:31], v14, s[8:11], s38 offen offset:1024 sc1
    v_cvt_pk_bf16_f32 v32, v72, v73
    v_cvt_pk_bf16_f32 v33, v74, v75
    v_cvt_pk_bf16_f32 v34, v76, v77
    v_cvt_pk_bf16_f32 v35, v78, v79
    buffer_store_dwordx4 v[32:35], v14, s[8:11], s38 offen offset:2048 sc1
    v_cvt_pk_bf16_f32 v36, v80, v81
    v_cvt_pk_bf16_f32 v37, v82, v83
    v_cvt_pk_bf16_f32 v38, v84, v85
    v_cvt_pk_bf16_f32 v39, v86, v87
    buffer_store_dwordx4 v[36:39], v14, s[8:11], s38 offen offset:3072 sc1
    s_cmp_ge_u32 s43, s41
    s_cbranch_scc1 Lpjend_p
    s_nop 1
    s_branch Lpj_124
Lpjend_p:
    s_waitcnt vmcnt(0)
    s_mov_b64 exec, 1
    buffer_store_dword v8, v9, s[8:11], s46 offen sc1
    s_mov_b64 exec, -1
    s_barrier
    s_add_u32 s94, s94, 1
    s_cmp_ge_u32 s94, 2
    s_cbranch_scc1 Lb_projd
    s_bfe_u32 s40, s98, 0x10001
    s_lshl_b32 s40, s40, 5
    s_mov_b32 s100, 0
    s_mov_b32 s41, 4
    s_lshl_b32 s42, s101, 2
    s_add_u32 s42, s42, 125839376
    s_branch Lb_proj
Lb_projd:
    s_cmp_ge_u32 s98, 25
    s_cbranch_scc1 Lb_att
    s_mov_b32 s95, s98
Lb_ssml:
    s_mul_i32 s99, s96, 40
    s_add_u32 s99, s99, s95
    s_load_dwordx16 s[32:47], s[0:1], 64
    v_and_b32 v1, 63, v0
    s_lshr_b32 s20, s97, 1
    s_and_b32 s21, s97, 1
    s_lshl_b32 s22, s99, 2
    v_lshrrev_b32 v2, 4, v1
    v_and_b32 v3, 15, v1
    s_add_u32 s23, s22, s20
    s_mul_i32 s24, s20, 33216
    v_lshrrev_b32 v4, 4, v0
    v_mul_u32_u24 v4, 20480, v4
    v_lshl_add_u32 v4, v3, 4, v4
    s_lshr_b32 s25, s22, 3
    s_lshl_b32 s25, s25, 8
    s_and_b32 s26, s22, 4
    s_lshl_b32 s26, s26, 1
    s_add_u32 s25, s25, s26
    s_add_u32 s25, s25, 121634816
    s_add_u32 s26, s25, 0
    buffer_load_dwordx2 v[200:201], v4, s[8:11], s26 offen
    s_add_u32 s26, s25, 655360
    buffer_load_dwordx2 v[202:203], v4, s[8:11], s26 offen
    s_add_u32 s26, s25, 1310720
    buffer_load_dwordx2 v[204:205], v4, s[8:11], s26 offen
    s_add_u32 s26, s25, 1966080
    buffer_load_dwordx2 v[206:207], v4, s[8:11], s26 offen
    v_lshlrev_b32 v4, 1, v1
    s_lshl_b32 s25, s23, 8
    s_lshl_b32 s26, s21, 7
    s_add_u32 s25, s25, s26
    s_waitcnt lgkmcnt(0)
    s_mov_b32 s16, s32
    s_and_b32 s17, s33, 0xffff
    s_mov_b32 s18, 163840
    s_mov_b32 s19, 0x00020000
    buffer_load_ushort v20, v4, s[16:19], s25 offen
    s_mov_b32 s16, s34
    s_and_b32 s17, s35, 0xffff
    s_mov_b32 s18, 163840
    s_mov_b32 s19, 0x00020000
    buffer_load_ushort v21, v4, s[16:19], s25 offen
    s_mov_b32 s16, s36
    s_and_b32 s17, s37, 0xffff
    s_mov_b32 s18, 163840
    s_mov_b32 s19, 0x00020000
    buffer_load_ushort v22, v4, s[16:19], s25 offen
    s_mov_b32 s16, s38
    s_and_b32 s17, s39, 0xffff
    s_mov_b32 s18, 163840
    s_mov_b32 s19, 0x00020000
    buffer_load_ushort v23, v4, s[16:19], s25 offen
    s_mov_b32 s16, s40
    s_and_b32 s17, s41, 0xffff
    s_mov_b32 s18, 163840
    s_mov_b32 s19, 0x00020000
    buffer_load_ushort v24, v4, s[16:19], s25 offen
    s_mov_b32 s16, s42
    s_and_b32 s17, s43, 0xffff
    s_mov_b32 s18, 163840
    s_mov_b32 s19, 0x00020000
    buffer_load_ushort v25, v4, s[16:19], s25 offen
    s_mov_b32 s16, s44
    s_and_b32 s17, s45, 0xffff
    s_mov_b32 s18, 1280
    s_mov_b32 s19, 0x00020000
    v_mov_b32 v5, 0
    s_lshl_b32 s25, s23, 1
    buffer_load_ushort v14, v5, s[16:19], s25 offen
    s_mov_b32 s16, s46
    s_and_b32 s17, s47, 0xffff
    s_mov_b32 s18, 1280
    s_mov_b32 s19, 0x00020000
    s_lshl_b32 s25, s22, 1
    buffer_load_dwordx2 v[208:209], v5, s[16:19], s25 offen
    v_mov_b32 v16, 0
    v_mov_b32 v17, 0
    v_mov_b32 v18, 0
    v_mov_b32 v19, 0
    v_lshlrev_b32 v6, 4, v1
    v_add_u32 v6, s24, v6
    s_mov_b64 exec, 0x1ff
    ds_write_b128 v6, v[16:19] offset:6144
    ds_write_b128 v6, v[16:19] offset:10912
    s_mov_b64 exec, 0xffff
    ds_write_b128 v6, v[16:19] offset:19776
    ds_write_b128 v6, v[16:19] offset:24160
    ds_write_b128 v6, v[16:19] offset:28544
    ds_write_b128 v6, v[16:19] offset:32928
    s_mov_b64 exec, -1
    s_waitcnt vmcnt(0) lgkmcnt(0)
    s_barrier
    v_lshlrev_b32 v14, 16, v14
    v_mul_f32 v14, 0x3fb8aa3b, v14
    v_exp_f32 v14, v14
    s_nop 0
    v_cvt_pk_bf16_f32 v14, v14, v14
    v_lshlrev_b32 v14, 16, v14
    v_lshlrev_b32 v20, 16, v20
    v_lshlrev_b32 v21, 16, v21
    v_lshlrev_b32 v22, 16, v22
    v_lshlrev_b32 v23, 16, v23
    v_lshlrev_b32 v24, 16, v24
    v_lshlrev_b32 v25, 16, v25
    v_mul_f32 v28, v14, v20
    v_mul_f32 v28, 0x3fb8aa3b, v28
    v_mul_f32 v29, v14, v21
    v_mul_f32 v29, 0x3e22f983, v29
    v_mul_f32 v22, v14, v22
    v_mul_f32 v23, v14, v23
    v_mul_f32 v30, v24, v22
    v_fma_f32 v30, -v25, v23, v30
    v_mul_f32 v31, v24, v23
    v_fma_f32 v31, v25, v22, v31
    v_mul_f32 v40, 0x43800000, v28
    v_mul_f32 v41, 0x43800000, v29
    v_exp_f32 v40, v40
    v_fract_f32 v41, v41
    v_cos_f32 v42, v41
    v_sin_f32 v43, v41
    s_nop 0
    v_mul_f32 v42, v42, v40
    v_mul_f32 v43, v43, v40
    v_mul_f32 v32, v30, v42
    v_fma_f32 v32, -v31, v43, v32
    v_mul_f32 v33, v30, v43
    v_fma_f32 v33, v31, v42, v33
    v_mul_f32 v40, 0x44800000, v28
    v_mul_f32 v41, 0x44800000, v29
    v_exp_f32 v40, v40
    v_fract_f32 v41, v41
    v_cos_f32 v42, v41
    v_sin_f32 v43, v41
    s_nop 0
    v_mul_f32 v42, v42, v40
    v_mul_f32 v43, v43, v40
    v_mul_f32 v34, v30, v42
    v_fma_f32 v34, -v31, v43, v34
    v_mul_f32 v35, v30, v43
    v_fma_f32 v35, v31, v42, v35
    v_lshlrev_b32 v7, 5, v1
    s_lshl_b32 s25, s21, 11
    s_add_u32 s25, s25, s24
    v_add_u32 v7, s25, v7
    ds_write_b128 v7, v[28:31] offset:0
    ds_write_b128 v7, v[32:35] offset:16
    v_sub_u32 v4, 2047, v0
    v_lshlrev_b32 v4, 1, v4
    v_add_u32 v4, 12608, v4
    ds_write_b16 v4, v200 offset:3072
    ds_write_b16 v4, v200 offset:7458
    ds_write_b16 v4, v200 offset:11844
    ds_write_b16 v4, v200 offset:16230
    ds_write_b16 v4, v202 offset:2048
    ds_write_b16 v4, v202 offset:6434
    ds_write_b16 v4, v202 offset:10820
    ds_write_b16 v4, v202 offset:15206
    ds_write_b16 v4, v204 offset:1024
    ds_write_b16 v4, v204 offset:5410
    ds_write_b16 v4, v204 offset:9796
    ds_write_b16 v4, v204 offset:14182
    ds_write_b16 v4, v206 offset:0
    ds_write_b16 v4, v206 offset:4386
    ds_write_b16 v4, v206 offset:8772
    ds_write_b16 v4, v206 offset:13158
    v_add_u32 v4, 33216, v4
    ds_write_b16_d16_hi v4, v200 offset:3072
    ds_write_b16_d16_hi v4, v200 offset:7458
    ds_write_b16_d16_hi v4, v200 offset:11844
    ds_write_b16_d16_hi v4, v200 offset:16230
    ds_write_b16_d16_hi v4, v202 offset:2048
    ds_write_b16_d16_hi v4, v202 offset:6434
    ds_write_b16_d16_hi v4, v202 offset:10820
    ds_write_b16_d16_hi v4, v202 offset:15206
    ds_write_b16_d16_hi v4, v204 offset:1024
    ds_write_b16_d16_hi v4, v204 offset:5410
    ds_write_b16_d16_hi v4, v204 offset:9796
    ds_write_b16_d16_hi v4, v204 offset:14182
    ds_write_b16_d16_hi v4, v206 offset:0
    ds_write_b16_d16_hi v4, v206 offset:4386
    ds_write_b16_d16_hi v4, v206 offset:8772
    ds_write_b16_d16_hi v4, v206 offset:13158
    v_add_u32 v4, 33216, v4
    ds_write_b16 v4, v201 offset:3072
    ds_write_b16 v4, v201 offset:7458
    ds_write_b16 v4, v201 offset:11844
    ds_write_b16 v4, v201 offset:16230
    ds_write_b16 v4, v203 offset:2048
    ds_write_b16 v4, v203 offset:6434
    ds_write_b16 v4, v203 offset:10820
    ds_write_b16 v4, v203 offset:15206
    ds_write_b16 v4, v205 offset:1024
    ds_write_b16 v4, v205 offset:5410
    ds_write_b16 v4, v205 offset:9796
    ds_write_b16 v4, v205 offset:14182
    ds_write_b16 v4, v207 offset:0
    ds_write_b16 v4, v207 offset:4386
    ds_write_b16 v4, v207 offset:8772
    ds_write_b16 v4, v207 offset:13158
    v_add_u32 v4, 33216, v4
    ds_write_b16_d16_hi v4, v201 offset:3072
    ds_write_b16_d16_hi v4, v201 offset:7458
    ds_write_b16_d16_hi v4, v201 offset:11844
    ds_write_b16_d16_hi v4, v201 offset:16230
    ds_write_b16_d16_hi v4, v203 offset:2048
    ds_write_b16_d16_hi v4, v203 offset:6434
    ds_write_b16_d16_hi v4, v203 offset:10820
    ds_write_b16_d16_hi v4, v203 offset:15206
    ds_write_b16_d16_hi v4, v205 offset:1024
    ds_write_b16_d16_hi v4, v205 offset:5410
    ds_write_b16_d16_hi v4, v205 offset:9796
    ds_write_b16_d16_hi v4, v205 offset:14182
    ds_write_b16_d16_hi v4, v207 offset:0
    ds_write_b16_d16_hi v4, v207 offset:4386
    ds_write_b16_d16_hi v4, v207 offset:8772
    ds_write_b16_d16_hi v4, v207 offset:13158
    v_cvt_f32_u32 v36, v3
    v_cmp_le_u32 s[28:29], 8, v3
    v_lshlrev_b32 v7, 5, v2
    v_add_u32 v7, s25, v7
    v_mov_b32 v64, 0
    v_mov_b32 v65, 0
    v_mov_b32 v66, 0
    v_mov_b32 v67, 0
    v_mov_b32 v68, 0
    v_mov_b32 v69, 0
    v_mov_b32 v70, 0
    v_mov_b32 v71, 0
    v_mov_b32 v72, 0
    v_mov_b32 v73, 0
    v_mov_b32 v74, 0
    v_mov_b32 v75, 0
    v_mov_b32 v76, 0
    v_mov_b32 v77, 0
    v_mov_b32 v78, 0
    v_mov_b32 v79, 0
    s_mov_b32 s27, 0
    s_waitcnt lgkmcnt(0)
    ds_read_b128 v[80:83], v7 offset:0
    ds_read_b128 v[84:87], v7 offset:16
Lskg_126:
    v_add_u32 v7, 128, v7
    s_waitcnt lgkmcnt(0)
    v_mul_f32 v40, v80, v36
    v_mul_f32 v41, v81, v36
    v_exp_f32 v40, v40
    v_fract_f32 v41, v41
    v_mov_b32 v30, v82
    v_mov_b32 v31, v83
    v_cos_f32 v90, v41
    v_sin_f32 v91, v41
    v_cndmask_b32 v32, v84, v82, s[28:29]
    v_cndmask_b32 v33, v85, v83, s[28:29]
    v_mov_b32 v34, v86
    v_mov_b32 v35, v87
    ds_read_b128 v[80:83], v7 offset:0
    ds_read_b128 v[84:87], v7 offset:16
    v_mul_f32 v90, v90, v40
    v_mul_f32 v91, v91, v40
    v_mul_f32 v92, v90, v90
    v_add_f32 v44, v90, v90
    v_fma_f32 v92, -v91, v91, v92
    v_mul_f32 v93, v44, v91
    v_mul_f32 v94, v92, v92
    v_add_f32 v44, v92, v92
    v_fma_f32 v94, -v93, v93, v94
    v_mul_f32 v95, v44, v93
    v_mul_f32 v96, v94, v94
    v_add_f32 v44, v94, v94
    v_fma_f32 v96, -v95, v95, v96
    v_mul_f32 v97, v44, v95
    v_mul_f32 v98, v96, v96
    v_add_f32 v44, v96, v96
    v_fma_f32 v98, -v97, v97, v98
    v_mul_f32 v99, v44, v97
    v_mul_f32 v100, v98, v98
    v_add_f32 v44, v98, v98
    v_fma_f32 v100, -v99, v99, v100
    v_mul_f32 v101, v44, v99
    v_mul_f32 v102, v100, v100
    v_add_f32 v44, v100, v100
    v_fma_f32 v102, -v101, v101, v102
    v_mul_f32 v103, v44, v101
    v_mul_f32 v104, v102, v102
    v_add_f32 v44, v102, v102
    v_fma_f32 v104, -v103, v103, v104
    v_mul_f32 v105, v44, v103
    v_cndmask_b32 v46, v100, v102, s[28:29]
    v_cndmask_b32 v47, v101, v103, s[28:29]
    v_mul_f32 v50, v30, v98
    v_mul_f32 v51, v30, v99
    v_fma_f32 v50, -v31, v99, v50
    v_fma_f32 v51, -v31, v98, -v51
    v_mul_f32 v52, v32, v46
    v_mul_f32 v53, v32, v47
    v_fma_f32 v52, -v33, v47, v52
    v_fma_f32 v53, -v33, v46, -v53
    v_mul_f32 v54, v34, v104
    v_mul_f32 v55, v34, v105
    v_fma_f32 v54, -v35, v105, v54
    v_fma_f32 v55, -v35, v104, -v55
    s_nop 1
    v_mfma_f32_16x16x4_f32 v[64:67], v50, v90, v[64:67]
    v_mfma_f32_16x16x4_f32 v[68:71], v52, v92, v[68:71]
    v_mfma_f32_16x16x4_f32 v[72:75], v52, v94, v[72:75]
    v_mfma_f32_16x16x4_f32 v[76:79], v54, v96, v[76:79]
    v_mfma_f32_16x16x4_f32 v[64:67], v51, v91, v[64:67]
    v_mfma_f32_16x16x4_f32 v[68:71], v53, v93, v[68:71]
    v_mfma_f32_16x16x4_f32 v[72:75], v53, v95, v[72:75]
    v_mfma_f32_16x16x4_f32 v[76:79], v55, v97, v[76:79]
    s_add_u32 s27, s27, 1
    s_cmp_lt_u32 s27, 16
    s_cbranch_scc1 Lskg_126
    s_waitcnt lgkmcnt(0)
    s_barrier
    s_nop 7
    v_mov_b32_dpp v68, v72 quad_perm:[0,1,2,3] row_mask:0xc bank_mask:0xf
    v_mov_b32_dpp v69, v73 quad_perm:[0,1,2,3] row_mask:0xc bank_mask:0xf
    v_mov_b32_dpp v70, v74 quad_perm:[0,1,2,3] row_mask:0xc bank_mask:0xf
    v_mov_b32_dpp v71, v75 quad_perm:[0,1,2,3] row_mask:0xc bank_mask:0xf
    v_lshl_add_u32 v7, v2, 6, v3
    v_lshlrev_b32 v7, 2, v7
    s_mul_i32 s25, s21, 3072
    s_add_u32 s25, s25, s24
    v_add_u32 v7, s25, v7
    ds_write_b32 v7, v64 offset:0
    ds_write_b32 v7, v65 offset:64
    ds_write_b32 v7, v66 offset:128
    ds_write_b32 v7, v67 offset:192
    ds_write_b32 v7, v68 offset:1024
    ds_write_b32 v7, v69 offset:1088
    ds_write_b32 v7, v70 offset:1152
    ds_write_b32 v7, v71 offset:1216
    ds_write_b32 v7, v76 offset:2048
    ds_write_b32 v7, v77 offset:2112
    ds_write_b32 v7, v78 offset:2176
    ds_write_b32 v7, v79 offset:2240
    s_waitcnt lgkmcnt(0)
    s_barrier
    v_lshlrev_b32 v8, 1, v1
    s_lshl_b32 s25, s21, 10
    v_add_u32 v8, s25, v8
    v_lshrrev_b32 v9, 5, v1
    v_mul_u32_u24 v9, 144, v9
    v_and_b32 v10, 31, v1
    v_lshl_add_u32 v9, v10, 2, v9
    s_mul_i32 s25, s21, 2304
    s_add_u32 s25, s25, s24
    v_add_u32 v9, s25, v9
    s_mov_b32 s27, 0
    s_mov_b32 s25, 17024
Lsex_127:
    v_add_u32 v10, 1, v8
    v_cvt_f32_u32 v11, v8
    v_cvt_f32_u32 v12, v10
    v_cvt_pk_bf16_f32 v11, v11, v12
    v_and_b32 v12, 0xffff, v11
    v_lshrrev_b32 v13, 16, v11
    v_subrev_u32 v12, s25, v12
    v_subrev_u32 v13, s25, v13
    v_cmp_gt_u32 vcc, 128, v8
    s_nop 1
    v_cndmask_b32 v12, v12, v8, vcc
    v_cndmask_b32 v13, v13, v10, vcc
    v_lshl_add_u32 v12, v12, 2, s24
    v_lshl_add_u32 v13, v13, 2, s24
    ds_read_b32 v14, v12 offset:0
    ds_read_b32 v15, v13 offset:0
    ds_read_b32 v16, v12 offset:3072
    ds_read_b32 v17, v13 offset:3072
    s_waitcnt lgkmcnt(0)
    v_add_f32 v14, v14, v16
    v_add_f32 v15, v15, v17
    v_cvt_pk_bf16_f32 v16, v14, v15
    v_lshlrev_b32 v17, 16, v16
    v_and_b32 v18, 0xffff0000, v16
    v_sub_f32 v14, v14, v17
    v_sub_f32 v15, v15, v18
    v_cvt_pk_bf16_f32 v17, v14, v15
    ds_write_b32 v9, v16 offset:6288
    ds_write_b32 v9, v17 offset:11056
    v_add_u32 v8, 128, v8
    v_add_u32 v9, 288, v9
    s_add_u32 s27, s27, 1
    s_cmp_lt_u32 s27, 8
    s_cbranch_scc1 Lsex_127
    s_waitcnt lgkmcnt(0)
    s_barrier
    v_add_u32 v6, 1, v3
    v_and_b32 v6, 3, v6
    v_lshlrev_b32 v4, 3, v2
    v_sub_u32 v4, v4, v3
    v_add_u32 v4, v4, v6
    v_lshlrev_b32 v4, 1, v4
    v_mul_u32_u24 v6, 4384, v6
    v_add_u32 v4, v4, v6
    s_lshl_b32 s25, s21, 10
    s_sub_u32 s25, s24, s25
    s_add_u32 s25, s25, 19678
    v_add_u32 v4, s25, v4
    v_lshlrev_b32 v7, 4, v2
    v_add_u32 v7, s24, v7
    v_add_u32 v7, 6144, v7
    s_lshl_b32 s25, s21, 3
    v_add_u32 v5, 1, v3
    v_subrev_u32 v5, s25, v5
    v_mov_b32 v120, 0
    v_mov_b32 v121, 0
    v_mov_b32 v122, 0
    v_mov_b32 v123, 0
    v_mov_b32 v124, 0
    v_mov_b32 v125, 0
    v_mov_b32 v126, 0
    v_mov_b32 v127, 0
    v_mov_b32 v128, 0
    v_mov_b32 v129, 0
    v_mov_b32 v130, 0
    v_mov_b32 v131, 0
    v_mov_b32 v132, 0
    v_mov_b32 v133, 0
    v_mov_b32 v134, 0
    v_mov_b32 v135, 0
    v_mov_b32 v136, 0
    v_mov_b32 v137, 0
    v_mov_b32 v138, 0
    v_mov_b32 v139, 0
    v_mov_b32 v140, 0
    v_mov_b32 v141, 0
    v_mov_b32 v142, 0
    v_mov_b32 v143, 0
    v_mov_b32 v144, 0
    v_mov_b32 v145, 0
    v_mov_b32 v146, 0
    v_mov_b32 v147, 0
    v_mov_b32 v148, 0
    v_mov_b32 v149, 0
    v_mov_b32 v150, 0
    v_mov_b32 v151, 0
    s_mov_b32 s26, 144
    s_cmp_eq_u32 s21, 1
    s_cbranch_scc1 Lsh1_128
    ds_read2_b64 v[8:11], v4 offset0:20 offset1:21
    ds_read2_b64 v[12:15], v4 offset0:16 offset1:17
    ds_read2_b64 v[16:19], v4 offset0:12 offset1:13
    ds_read2_b64 v[20:23], v4 offset0:8 offset1:9
    ds_read2_b64 v[24:27], v4 offset0:4 offset1:5
    ds_read2_b64 v[28:31], v4 offset0:0 offset1:1
    v_add_u32 v152, 0, v5
    v_max_i32 v152, 0, v152
    v_mad_u32_u24 v153, v152, s26, v7
    ds_read_b128 v[32:35], v153 offset:0
    ds_read_b128 v[36:39], v153 offset:4768
    ds_read_b128 v[40:43], v153 offset:64
    ds_read_b128 v[44:47], v153 offset:4832
    v_add_u32 v152, 16, v5
    v_max_i32 v152, 0, v152
    v_mad_u32_u24 v154, v152, s26, v7
    ds_read_b128 v[48:51], v154 offset:0
    ds_read_b128 v[52:55], v154 offset:4768
    ds_read_b128 v[56:59], v154 offset:64
    ds_read_b128 v[60:63], v154 offset:4832
    v_subrev_u32 v4, 128, v4
    v_subrev_u32 v5, 1, v5
    s_mov_b32 s27, 0
Lsc_130:
    ds_read2_b64 v[64:67], v4 offset0:20 offset1:21
    ds_read2_b64 v[68:71], v4 offset0:16 offset1:17
    ds_read2_b64 v[72:75], v4 offset0:12 offset1:13
    ds_read2_b64 v[76:79], v4 offset0:8 offset1:9
    ds_read2_b64 v[80:83], v4 offset0:4 offset1:5
    ds_read2_b64 v[84:87], v4 offset0:0 offset1:1
    v_add_u32 v152, 0, v5
    v_max_i32 v152, 0, v152
    v_mad_u32_u24 v153, v152, s26, v7
    ds_read_b128 v[88:91], v153 offset:0
    ds_read_b128 v[92:95], v153 offset:4768
    ds_read_b128 v[96:99], v153 offset:64
    ds_read_b128 v[100:103], v153 offset:4832
    v_add_u32 v152, 16, v5
    v_max_i32 v152, 0, v152
    v_mad_u32_u24 v154, v152, s26, v7
    ds_read_b128 v[104:107], v154 offset:0
    ds_read_b128 v[108:111], v154 offset:4768
    ds_read_b128 v[112:115], v154 offset:64
    ds_read_b128 v[116:119], v154 offset:4832
    v_subrev_u32 v4, 128, v4
    v_subrev_u32 v5, 1, v5
    s_waitcnt lgkmcnt(14)
    v_mfma_f32_16x16x32_bf16 v[120:123], v[16:19], v[32:35], v[120:123]
    v_mfma_f32_16x16x32_bf16 v[124:127], v[20:23], v[32:35], v[124:127]
    v_mfma_f32_16x16x32_bf16 v[128:131], v[24:27], v[32:35], v[128:131]
    v_mfma_f32_16x16x32_bf16 v[132:135], v[28:31], v[32:35], v[132:135]
    v_mfma_f32_16x16x32_bf16 v[136:139], v[16:19], v[48:51], v[136:139]
    v_mfma_f32_16x16x32_bf16 v[140:143], v[20:23], v[48:51], v[140:143]
    v_mfma_f32_16x16x32_bf16 v[144:147], v[24:27], v[48:51], v[144:147]
    v_mfma_f32_16x16x32_bf16 v[148:151], v[28:31], v[48:51], v[148:151]
    v_mfma_f32_16x16x32_bf16 v[120:123], v[16:19], v[36:39], v[120:123]
    v_mfma_f32_16x16x32_bf16 v[124:127], v[20:23], v[36:39], v[124:127]
    v_mfma_f32_16x16x32_bf16 v[128:131], v[24:27], v[36:39], v[128:131]
    v_mfma_f32_16x16x32_bf16 v[132:135], v[28:31], v[36:39], v[132:135]
    v_mfma_f32_16x16x32_bf16 v[136:139], v[16:19], v[52:55], v[136:139]
    v_mfma_f32_16x16x32_bf16 v[140:143], v[20:23], v[52:55], v[140:143]
    v_mfma_f32_16x16x32_bf16 v[144:147], v[24:27], v[52:55], v[144:147]
    v_mfma_f32_16x16x32_bf16 v[148:151], v[28:31], v[52:55], v[148:151]
    v_mfma_f32_16x16x32_bf16 v[120:123], v[8:11], v[40:43], v[120:123]
    v_mfma_f32_16x16x32_bf16 v[124:127], v[12:15], v[40:43], v[124:127]
    v_mfma_f32_16x16x32_bf16 v[128:131], v[16:19], v[40:43], v[128:131]
    v_mfma_f32_16x16x32_bf16 v[132:135], v[20:23], v[40:43], v[132:135]
    v_mfma_f32_16x16x32_bf16 v[136:139], v[8:11], v[56:59], v[136:139]
    v_mfma_f32_16x16x32_bf16 v[140:143], v[12:15], v[56:59], v[140:143]
    v_mfma_f32_16x16x32_bf16 v[144:147], v[16:19], v[56:59], v[144:147]
    v_mfma_f32_16x16x32_bf16 v[148:151], v[20:23], v[56:59], v[148:151]
    v_mfma_f32_16x16x32_bf16 v[120:123], v[8:11], v[44:47], v[120:123]
    v_mfma_f32_16x16x32_bf16 v[124:127], v[12:15], v[44:47], v[124:127]
    v_mfma_f32_16x16x32_bf16 v[128:131], v[16:19], v[44:47], v[128:131]
    v_mfma_f32_16x16x32_bf16 v[132:135], v[20:23], v[44:47], v[132:135]
    v_mfma_f32_16x16x32_bf16 v[136:139], v[8:11], v[60:63], v[136:139]
    v_mfma_f32_16x16x32_bf16 v[140:143], v[12:15], v[60:63], v[140:143]
    v_mfma_f32_16x16x32_bf16 v[144:147], v[16:19], v[60:63], v[144:147]
    v_mfma_f32_16x16x32_bf16 v[148:151], v[20:23], v[60:63], v[148:151]
    ds_read2_b64 v[8:11], v4 offset0:20 offset1:21
    ds_read2_b64 v[12:15], v4 offset0:16 offset1:17
    ds_read2_b64 v[16:19], v4 offset0:12 offset1:13
    ds_read2_b64 v[20:23], v4 offset0:8 offset1:9
    ds_read2_b64 v[24:27], v4 offset0:4 offset1:5
    ds_read2_b64 v[28:31], v4 offset0:0 offset1:1
    v_add_u32 v152, 0, v5
    v_max_i32 v152, 0, v152
    v_mad_u32_u24 v153, v152, s26, v7
    ds_read_b128 v[32:35], v153 offset:0
    ds_read_b128 v[36:39], v153 offset:4768
    ds_read_b128 v[40:43], v153 offset:64
    ds_read_b128 v[44:47], v153 offset:4832
    v_add_u32 v152, 16, v5
    v_max_i32 v152, 0, v152
    v_mad_u32_u24 v154, v152, s26, v7
    ds_read_b128 v[48:51], v154 offset:0
    ds_read_b128 v[52:55], v154 offset:4768
    ds_read_b128 v[56:59], v154 offset:64
    ds_read_b128 v[60:63], v154 offset:4832
    v_subrev_u32 v4, 128, v4
    v_subrev_u32 v5, 1, v5
    s_waitcnt lgkmcnt(14)
    v_mfma_f32_16x16x32_bf16 v[120:123], v[72:75], v[88:91], v[120:123]
    v_mfma_f32_16x16x32_bf16 v[124:127], v[76:79], v[88:91], v[124:127]
    v_mfma_f32_16x16x32_bf16 v[128:131], v[80:83], v[88:91], v[128:131]
    v_mfma_f32_16x16x32_bf16 v[132:135], v[84:87], v[88:91], v[132:135]
    v_mfma_f32_16x16x32_bf16 v[136:139], v[72:75], v[104:107], v[136:139]
    v_mfma_f32_16x16x32_bf16 v[140:143], v[76:79], v[104:107], v[140:143]
    v_mfma_f32_16x16x32_bf16 v[144:147], v[80:83], v[104:107], v[144:147]
    v_mfma_f32_16x16x32_bf16 v[148:151], v[84:87], v[104:107], v[148:151]
    v_mfma_f32_16x16x32_bf16 v[120:123], v[72:75], v[92:95], v[120:123]
    v_mfma_f32_16x16x32_bf16 v[124:127], v[76:79], v[92:95], v[124:127]
    v_mfma_f32_16x16x32_bf16 v[128:131], v[80:83], v[92:95], v[128:131]
    v_mfma_f32_16x16x32_bf16 v[132:135], v[84:87], v[92:95], v[132:135]
    v_mfma_f32_16x16x32_bf16 v[136:139], v[72:75], v[108:111], v[136:139]
    v_mfma_f32_16x16x32_bf16 v[140:143], v[76:79], v[108:111], v[140:143]
    v_mfma_f32_16x16x32_bf16 v[144:147], v[80:83], v[108:111], v[144:147]
    v_mfma_f32_16x16x32_bf16 v[148:151], v[84:87], v[108:111], v[148:151]
    v_mfma_f32_16x16x32_bf16 v[120:123], v[64:67], v[96:99], v[120:123]
    v_mfma_f32_16x16x32_bf16 v[124:127], v[68:71], v[96:99], v[124:127]
    v_mfma_f32_16x16x32_bf16 v[128:131], v[72:75], v[96:99], v[128:131]
    v_mfma_f32_16x16x32_bf16 v[132:135], v[76:79], v[96:99], v[132:135]
    v_mfma_f32_16x16x32_bf16 v[136:139], v[64:67], v[112:115], v[136:139]
    v_mfma_f32_16x16x32_bf16 v[140:143], v[68:71], v[112:115], v[140:143]
    v_mfma_f32_16x16x32_bf16 v[144:147], v[72:75], v[112:115], v[144:147]
    v_mfma_f32_16x16x32_bf16 v[148:151], v[76:79], v[112:115], v[148:151]
    v_mfma_f32_16x16x32_bf16 v[120:123], v[64:67], v[100:103], v[120:123]
    v_mfma_f32_16x16x32_bf16 v[124:127], v[68:71], v[100:103], v[124:127]
    v_mfma_f32_16x16x32_bf16 v[128:131], v[72:75], v[100:103], v[128:131]
    v_mfma_f32_16x16x32_bf16 v[132:135], v[76:79], v[100:103], v[132:135]
    v_mfma_f32_16x16x32_bf16 v[136:139], v[64:67], v[116:119], v[136:139]
    v_mfma_f32_16x16x32_bf16 v[140:143], v[68:71], v[116:119], v[140:143]
    v_mfma_f32_16x16x32_bf16 v[144:147], v[72:75], v[116:119], v[144:147]
    v_mfma_f32_16x16x32_bf16 v[148:151], v[76:79], v[116:119], v[148:151]
    s_add_u32 s27, s27, 2
    s_cmp_lt_u32 s27, 8
    s_cbranch_scc1 Lsc_130
    s_mov_b32 s27, 0
Lsc_131:
    ds_read2_b64 v[64:67], v4 offset0:20 offset1:21
    ds_read2_b64 v[68:71], v4 offset0:16 offset1:17
    ds_read2_b64 v[72:75], v4 offset0:12 offset1:13
    ds_read2_b64 v[76:79], v4 offset0:8 offset1:9
    ds_read2_b64 v[80:83], v4 offset0:4 offset1:5
    ds_read2_b64 v[84:87], v4 offset0:0 offset1:1
    v_add_u32 v152, 0, v5
    v_max_i32 v152, 0, v152
    v_mad_u32_u24 v153, v152, s26, v7
    ds_read_b128 v[88:91], v153 offset:0
    ds_read_b128 v[92:95], v153 offset:4768
    ds_read_b128 v[96:99], v153 offset:64
    ds_read_b128 v[100:103], v153 offset:4832
    v_subrev_u32 v4, 128, v4
    v_subrev_u32 v5, 1, v5
    s_waitcnt lgkmcnt(10)
    v_mfma_f32_16x16x32_bf16 v[120:123], v[16:19], v[32:35], v[120:123]
    v_mfma_f32_16x16x32_bf16 v[124:127], v[20:23], v[32:35], v[124:127]
    v_mfma_f32_16x16x32_bf16 v[128:131], v[24:27], v[32:35], v[128:131]
    v_mfma_f32_16x16x32_bf16 v[132:135], v[28:31], v[32:35], v[132:135]
    v_mfma_f32_16x16x32_bf16 v[120:123], v[16:19], v[36:39], v[120:123]
    v_mfma_f32_16x16x32_bf16 v[124:127], v[20:23], v[36:39], v[124:127]
    v_mfma_f32_16x16x32_bf16 v[128:131], v[24:27], v[36:39], v[128:131]
    v_mfma_f32_16x16x32_bf16 v[132:135], v[28:31], v[36:39], v[132:135]
    v_mfma_f32_16x16x32_bf16 v[120:123], v[8:11], v[40:43], v[120:123]
    v_mfma_f32_16x16x32_bf16 v[124:127], v[12:15], v[40:43], v[124:127]
    v_mfma_f32_16x16x32_bf16 v[128:131], v[16:19], v[40:43], v[128:131]
    v_mfma_f32_16x16x32_bf16 v[132:135], v[20:23], v[40:43], v[132:135]
    v_mfma_f32_16x16x32_bf16 v[120:123], v[8:11], v[44:47], v[120:123]
    v_mfma_f32_16x16x32_bf16 v[124:127], v[12:15], v[44:47], v[124:127]
    v_mfma_f32_16x16x32_bf16 v[128:131], v[16:19], v[44:47], v[128:131]
    v_mfma_f32_16x16x32_bf16 v[132:135], v[20:23], v[44:47], v[132:135]
    ds_read2_b64 v[8:11], v4 offset0:20 offset1:21
    ds_read2_b64 v[12:15], v4 offset0:16 offset1:17
    ds_read2_b64 v[16:19], v4 offset0:12 offset1:13
    ds_read2_b64 v[20:23], v4 offset0:8 offset1:9
    ds_read2_b64 v[24:27], v4 offset0:4 offset1:5
    ds_read2_b64 v[28:31], v4 offset0:0 offset1:1
    v_add_u32 v152, 0, v5
    v_max_i32 v152, 0, v152
    v_mad_u32_u24 v153, v152, s26, v7
    ds_read_b128 v[32:35], v153 offset:0
    ds_read_b128 v[36:39], v153 offset:4768
    ds_read_b128 v[40:43], v153 offset:64
    ds_read_b128 v[44:47], v153 offset:4832
    v_subrev_u32 v4, 128, v4
    v_subrev_u32 v5, 1, v5
    s_waitcnt lgkmcnt(10)
    v_mfma_f32_16x16x32_bf16 v[120:123], v[72:75], v[88:91], v[120:123]
    v_mfma_f32_16x16x32_bf16 v[124:127], v[76:79], v[88:91], v[124:127]
    v_mfma_f32_16x16x32_bf16 v[128:131], v[80:83], v[88:91], v[128:131]
    v_mfma_f32_16x16x32_bf16 v[132:135], v[84:87], v[88:91], v[132:135]
    v_mfma_f32_16x16x32_bf16 v[120:123], v[72:75], v[92:95], v[120:123]
    v_mfma_f32_16x16x32_bf16 v[124:127], v[76:79], v[92:95], v[124:127]
    v_mfma_f32_16x16x32_bf16 v[128:131], v[80:83], v[92:95], v[128:131]
    v_mfma_f32_16x16x32_bf16 v[132:135], v[84:87], v[92:95], v[132:135]
    v_mfma_f32_16x16x32_bf16 v[120:123], v[64:67], v[96:99], v[120:123]
    v_mfma_f32_16x16x32_bf16 v[124:127], v[68:71], v[96:99], v[124:127]
    v_mfma_f32_16x16x32_bf16 v[128:131], v[72:75], v[96:99], v[128:131]
    v_mfma_f32_16x16x32_bf16 v[132:135], v[76:79], v[96:99], v[132:135]
    v_mfma_f32_16x16x32_bf16 v[120:123], v[64:67], v[100:103], v[120:123]
    v_mfma_f32_16x16x32_bf16 v[124:127], v[68:71], v[100:103], v[124:127]
    v_mfma_f32_16x16x32_bf16 v[128:131], v[72:75], v[100:103], v[128:131]
    v_mfma_f32_16x16x32_bf16 v[132:135], v[76:79], v[100:103], v[132:135]
    s_add_u32 s27, s27, 2
    s_cmp_lt_u32 s27, 8
    s_cbranch_scc1 Lsc_131
    v_lshlrev_b32 v6, 4, v1
    v_add_u32 v6, s24, v6
    s_nop 4
    ds_write_b128 v6, v[136:139] offset:0
    ds_write_b128 v6, v[140:143] offset:1024
    ds_write_b128 v6, v[144:147] offset:2048
    ds_write_b128 v6, v[148:151] offset:3072
    s_waitcnt lgkmcnt(0)
    s_barrier
    s_branch Lsj_129
Lsh1_128:
    ds_read2_b64 v[8:11], v4 offset0:20 offset1:21
    ds_read2_b64 v[12:15], v4 offset0:16 offset1:17
    ds_read2_b64 v[16:19], v4 offset0:12 offset1:13
    ds_read2_b64 v[20:23], v4 offset0:8 offset1:9
    ds_read2_b64 v[24:27], v4 offset0:4 offset1:5
    ds_read2_b64 v[28:31], v4 offset0:0 offset1:1
    v_add_u32 v152, 16, v5
    v_max_i32 v152, 0, v152
    v_mad_u32_u24 v154, v152, s26, v7
    ds_read_b128 v[48:51], v154 offset:0
    ds_read_b128 v[52:55], v154 offset:4768
    ds_read_b128 v[56:59], v154 offset:64
    ds_read_b128 v[60:63], v154 offset:4832
    v_subrev_u32 v4, 128, v4
    v_subrev_u32 v5, 1, v5
    s_mov_b32 s27, 0
Lsc_132:
    ds_read2_b64 v[64:67], v4 offset0:20 offset1:21
    ds_read2_b64 v[68:71], v4 offset0:16 offset1:17
    ds_read2_b64 v[72:75], v4 offset0:12 offset1:13
    ds_read2_b64 v[76:79], v4 offset0:8 offset1:9
    ds_read2_b64 v[80:83], v4 offset0:4 offset1:5
    ds_read2_b64 v[84:87], v4 offset0:0 offset1:1
    v_add_u32 v152, 16, v5
    v_max_i32 v152, 0, v152
    v_mad_u32_u24 v154, v152, s26, v7
    ds_read_b128 v[104:107], v154 offset:0
    ds_read_b128 v[108:111], v154 offset:4768
    ds_read_b128 v[112:115], v154 offset:64
    ds_read_b128 v[116:119], v154 offset:4832
    v_subrev_u32 v4, 128, v4
    v_subrev_u32 v5, 1, v5
    s_waitcnt lgkmcnt(10)
    v_mfma_f32_16x16x32_bf16 v[136:139], v[16:19], v[48:51], v[136:139]
    v_mfma_f32_16x16x32_bf16 v[140:143], v[20:23], v[48:51], v[140:143]
    v_mfma_f32_16x16x32_bf16 v[144:147], v[24:27], v[48:51], v[144:147]
    v_mfma_f32_16x16x32_bf16 v[148:151], v[28:31], v[48:51], v[148:151]
    v_mfma_f32_16x16x32_bf16 v[136:139], v[16:19], v[52:55], v[136:139]
    v_mfma_f32_16x16x32_bf16 v[140:143], v[20:23], v[52:55], v[140:143]
    v_mfma_f32_16x16x32_bf16 v[144:147], v[24:27], v[52:55], v[144:147]
    v_mfma_f32_16x16x32_bf16 v[148:151], v[28:31], v[52:55], v[148:151]
    v_mfma_f32_16x16x32_bf16 v[136:139], v[8:11], v[56:59], v[136:139]
    v_mfma_f32_16x16x32_bf16 v[140:143], v[12:15], v[56:59], v[140:143]
    v_mfma_f32_16x16x32_bf16 v[144:147], v[16:19], v[56:59], v[144:147]
    v_mfma_f32_16x16x32_bf16 v[148:151], v[20:23], v[56:59], v[148:151]
    v_mfma_f32_16x16x32_bf16 v[136:139], v[8:11], v[60:63], v[136:139]
    v_mfma_f32_16x16x32_bf16 v[140:143], v[12:15], v[60:63], v[140:143]
    v_mfma_f32_16x16x32_bf16 v[144:147], v[16:19], v[60:63], v[144:147]
    v_mfma_f32_16x16x32_bf16 v[148:151], v[20:23], v[60:63], v[148:151]
    ds_read2_b64 v[8:11], v4 offset0:20 offset1:21
    ds_read2_b64 v[12:15], v4 offset0:16 offset1:17
    ds_read2_b64 v[16:19], v4 offset0:12 offset1:13
    ds_read2_b64 v[20:23], v4 offset0:8 offset1:9
    ds_read2_b64 v[24:27], v4 offset0:4 offset1:5
    ds_read2_b64 v[28:31], v4 offset0:0 offset1:1
    v_add_u32 v152, 16, v5
    v_max_i32 v152, 0, v152
    v_mad_u32_u24 v154, v152, s26, v7
    ds_read_b128 v[48:51], v154 offset:0
    ds_read_b128 v[52:55], v154 offset:4768
    ds_read_b128 v[56:59], v154 offset:64
    ds_read_b128 v[60:63], v154 offset:4832
    v_subrev_u32 v4, 128, v4
    v_subrev_u32 v5, 1, v5
    s_waitcnt lgkmcnt(10)
    v_mfma_f32_16x16x32_bf16 v[136:139], v[72:75], v[104:107], v[136:139]
    v_mfma_f32_16x16x32_bf16 v[140:143], v[76:79], v[104:107], v[140:143]
    v_mfma_f32_16x16x32_bf16 v[144:147], v[80:83], v[104:107], v[144:147]
    v_mfma_f32_16x16x32_bf16 v[148:151], v[84:87], v[104:107], v[148:151]
    v_mfma_f32_16x16x32_bf16 v[136:139], v[72:75], v[108:111], v[136:139]
    v_mfma_f32_16x16x32_bf16 v[140:143], v[76:79], v[108:111], v[140:143]
    v_mfma_f32_16x16x32_bf16 v[144:147], v[80:83], v[108:111], v[144:147]
    v_mfma_f32_16x16x32_bf16 v[148:151], v[84:87], v[108:111], v[148:151]
    v_mfma_f32_16x16x32_bf16 v[136:139], v[64:67], v[112:115], v[136:139]
    v_mfma_f32_16x16x32_bf16 v[140:143], v[68:71], v[112:115], v[140:143]
    v_mfma_f32_16x16x32_bf16 v[144:147], v[72:75], v[112:115], v[144:147]
    v_mfma_f32_16x16x32_bf16 v[148:151], v[76:79], v[112:115], v[148:151]
    v_mfma_f32_16x16x32_bf16 v[136:139], v[64:67], v[116:119], v[136:139]
    v_mfma_f32_16x16x32_bf16 v[140:143], v[68:71], v[116:119], v[140:143]
    v_mfma_f32_16x16x32_bf16 v[144:147], v[72:75], v[116:119], v[144:147]
    v_mfma_f32_16x16x32_bf16 v[148:151], v[76:79], v[116:119], v[148:151]
    s_add_u32 s27, s27, 2
    s_cmp_lt_u32 s27, 24
    s_cbranch_scc1 Lsc_132
    v_lshlrev_b32 v6, 4, v1
    v_add_u32 v6, s24, v6
    s_waitcnt lgkmcnt(0)
    s_barrier
    ds_read_b128 v[120:123], v6 offset:0
    ds_read_b128 v[124:127], v6 offset:1024
    ds_read_b128 v[128:131], v6 offset:2048
    ds_read_b128 v[132:135], v6 offset:3072
    s_waitcnt lgkmcnt(0)
    v_add_f32 v120, v120, v136
    v_add_f32 v121, v121, v137
    v_add_f32 v122, v122, v138
    v_add_f32 v123, v123, v139
    v_add_f32 v124, v124, v140
    v_add_f32 v125, v125, v141
    v_add_f32 v126, v126, v142
    v_add_f32 v127, v127, v143
    v_add_f32 v128, v128, v144
    v_add_f32 v129, v129, v145
    v_add_f32 v130, v130, v146
    v_add_f32 v131, v131, v147
    v_add_f32 v132, v132, v148
    v_add_f32 v133, v133, v149
    v_add_f32 v134, v134, v150
    v_add_f32 v135, v135, v151
Lsj_129:
    v_mul_u32_u24 v4, 544, v3
    v_lshl_add_u32 v4, v2, 5, v4
    s_lshl_b32 s25, s20, 1
    s_mul_i32 s26, s21, 8704
    s_add_u32 s25, s25, s26
    s_add_u32 s25, s25, 132864
    v_add_u32 v4, s25, v4
    v_cvt_pk_bf16_f32 v8, v120, v121
    v_cvt_pk_bf16_f32 v9, v122, v123
    ds_write_b16 v4, v8 offset:0
    ds_write_b16_d16_hi v4, v8 offset:8
    ds_write_b16 v4, v9 offset:16
    ds_write_b16_d16_hi v4, v9 offset:24
    v_cvt_pk_bf16_f32 v8, v124, v125
    v_cvt_pk_bf16_f32 v9, v126, v127
    ds_write_b16 v4, v8 offset:128
    ds_write_b16_d16_hi v4, v8 offset:136
    ds_write_b16 v4, v9 offset:144
    ds_write_b16_d16_hi v4, v9 offset:152
    v_cvt_pk_bf16_f32 v8, v128, v129
    v_cvt_pk_bf16_f32 v9, v130, v131
    ds_write_b16 v4, v8 offset:256
    ds_write_b16_d16_hi v4, v8 offset:264
    ds_write_b16 v4, v9 offset:272
    ds_write_b16_d16_hi v4, v9 offset:280
    v_cvt_pk_bf16_f32 v8, v132, v133
    v_cvt_pk_bf16_f32 v9, v134, v135
    ds_write_b16 v4, v8 offset:384
    ds_write_b16_d16_hi v4, v8 offset:392
    ds_write_b16 v4, v9 offset:400
    ds_write_b16_d16_hi v4, v9 offset:408
    s_waitcnt lgkmcnt(0)
    s_barrier
    s_mul_i32 s25, s97, 544
    s_add_u32 s25, s25, 132864
    v_lshlrev_b32 v4, 3, v1
    v_add_u32 v4, s25, v4
    ds_read_b64 v[8:9], v4 offset:0
    ds_read_b64 v[10:11], v4 offset:4352
    ds_read_b64 v[12:13], v4 offset:8704
    ds_read_b64 v[14:15], v4 offset:13056
    v_lshlrev_b32 v114, 16, v208
    v_and_b32 v115, 0xffff0000, v208
    v_lshlrev_b32 v116, 16, v209
    v_and_b32 v117, 0xffff0000, v209
    v_lshlrev_b32 v4, 3, v0
    s_lshl_b32 s25, s99, 14
    s_add_u32 s25, s25, 83886080
    s_waitcnt lgkmcnt(0)
    v_lshlrev_b32 v30, 16, v200
    v_and_b32 v31, 0xffff0000, v200
    v_mul_f32 v30, v30, v114
    v_mul_f32 v31, v31, v115
    v_cvt_pk_bf16_f32 v30, v30, v31
    v_and_b32 v31, 0xffff0000, v30
    v_lshlrev_b32 v30, 16, v30
    v_lshlrev_b32 v32, 16, v8
    v_and_b32 v33, 0xffff0000, v8
    v_add_f32 v30, v30, v32
    v_add_f32 v31, v31, v33
    v_cvt_pk_bf16_f32 v8, v30, v31
    v_lshlrev_b32 v30, 16, v201
    v_and_b32 v31, 0xffff0000, v201
    v_mul_f32 v30, v30, v116
    v_mul_f32 v31, v31, v117
    v_cvt_pk_bf16_f32 v30, v30, v31
    v_and_b32 v31, 0xffff0000, v30
    v_lshlrev_b32 v30, 16, v30
    v_lshlrev_b32 v32, 16, v9
    v_and_b32 v33, 0xffff0000, v9
    v_add_f32 v30, v30, v32
    v_add_f32 v31, v31, v33
    v_cvt_pk_bf16_f32 v9, v30, v31
    s_add_u32 s26, s25, 0
    buffer_store_dwordx2 v[8:9], v4, s[8:11], s26 offen sc1
    v_lshlrev_b32 v30, 16, v202
    v_and_b32 v31, 0xffff0000, v202
    v_mul_f32 v30, v30, v114
    v_mul_f32 v31, v31, v115
    v_cvt_pk_bf16_f32 v30, v30, v31
    v_and_b32 v31, 0xffff0000, v30
    v_lshlrev_b32 v30, 16, v30
    v_lshlrev_b32 v32, 16, v10
    v_and_b32 v33, 0xffff0000, v10
    v_add_f32 v30, v30, v32
    v_add_f32 v31, v31, v33
    v_cvt_pk_bf16_f32 v10, v30, v31
    v_lshlrev_b32 v30, 16, v203
    v_and_b32 v31, 0xffff0000, v203
    v_mul_f32 v30, v30, v116
    v_mul_f32 v31, v31, v117
    v_cvt_pk_bf16_f32 v30, v30, v31
    v_and_b32 v31, 0xffff0000, v30
    v_lshlrev_b32 v30, 16, v30
    v_lshlrev_b32 v32, 16, v11
    v_and_b32 v33, 0xffff0000, v11
    v_add_f32 v30, v30, v32
    v_add_f32 v31, v31, v33
    v_cvt_pk_bf16_f32 v11, v30, v31
    s_add_u32 s26, s25, 4096
    buffer_store_dwordx2 v[10:11], v4, s[8:11], s26 offen sc1
    v_lshlrev_b32 v30, 16, v204
    v_and_b32 v31, 0xffff0000, v204
    v_mul_f32 v30, v30, v114
    v_mul_f32 v31, v31, v115
    v_cvt_pk_bf16_f32 v30, v30, v31
    v_and_b32 v31, 0xffff0000, v30
    v_lshlrev_b32 v30, 16, v30
    v_lshlrev_b32 v32, 16, v12
    v_and_b32 v33, 0xffff0000, v12
    v_add_f32 v30, v30, v32
    v_add_f32 v31, v31, v33
    v_cvt_pk_bf16_f32 v12, v30, v31
    v_lshlrev_b32 v30, 16, v205
    v_and_b32 v31, 0xffff0000, v205
    v_mul_f32 v30, v30, v116
    v_mul_f32 v31, v31, v117
    v_cvt_pk_bf16_f32 v30, v30, v31
    v_and_b32 v31, 0xffff0000, v30
    v_lshlrev_b32 v30, 16, v30
    v_lshlrev_b32 v32, 16, v13
    v_and_b32 v33, 0xffff0000, v13
    v_add_f32 v30, v30, v32
    v_add_f32 v31, v31, v33
    v_cvt_pk_bf16_f32 v13, v30, v31
    s_add_u32 s26, s25, 8192
    buffer_store_dwordx2 v[12:13], v4, s[8:11], s26 offen sc1
    v_lshlrev_b32 v30, 16, v206
    v_and_b32 v31, 0xffff0000, v206
    v_mul_f32 v30, v30, v114
    v_mul_f32 v31, v31, v115
    v_cvt_pk_bf16_f32 v30, v30, v31
    v_and_b32 v31, 0xffff0000, v30
    v_lshlrev_b32 v30, 16, v30
    v_lshlrev_b32 v32, 16, v14
    v_and_b32 v33, 0xffff0000, v14
    v_add_f32 v30, v30, v32
    v_add_f32 v31, v31, v33
    v_cvt_pk_bf16_f32 v14, v30, v31
    v_lshlrev_b32 v30, 16, v207
    v_and_b32 v31, 0xffff0000, v207
    v_mul_f32 v30, v30, v116
    v_mul_f32 v31, v31, v117
    v_cvt_pk_bf16_f32 v30, v30, v31
    v_and_b32 v31, 0xffff0000, v30
    v_lshlrev_b32 v30, 16, v30
    v_lshlrev_b32 v32, 16, v15
    v_and_b32 v33, 0xffff0000, v15
    v_add_f32 v30, v30, v32
    v_add_f32 v31, v31, v33
    v_cvt_pk_bf16_f32 v15, v30, v31
    s_add_u32 s26, s25, 12288
    buffer_store_dwordx2 v[14:15], v4, s[8:11], s26 offen sc1
    s_lshl_b32 s25, s96, 7
    s_add_u32 s25, s25, 125830144
    s_waitcnt vmcnt(0)
    s_barrier
    s_cmp_lg_u32 s97, 0
    s_cbranch_scc1 Lsig_133
    v_mov_b32 v250, 1
    v_mov_b32 v251, 0
    s_mov_b64 exec, 1
    buffer_atomic_add v250, v251, s[8:11], s25 offen
    s_mov_b64 exec, -1
Lsig_133:
    s_add_u32 s95, s95, 25
    s_cmp_lt_u32 s95, 40
    s_cbranch_scc1 Lb_ssml
    s_load_dwordx2 s[6:7], s[0:1], 40
    s_load_dwordx2 s[32:33], s[0:1], 136
    s_mul_i32 s21, s98, 52
    s_lshr_b32 s21, s21, 8
    s_mul_i32 s25, s21, 5
    s_sub_u32 s24, s98, s25
    s_mul_i32 s30, s96, 320
    s_lshl_b32 s25, s21, 6
    s_add_u32 s30, s30, s25
    v_and_b32 v1, 63, v0
    v_lshrrev_b32 v2, 4, v1
    v_and_b32 v3, 15, v1
    v_lshlrev_b32 v4, 4, v1
    v_lshrrev_b32 v12, 2, v1
    v_mul_u32_u24 v12, 1280, v12
    v_and_b32 v13, 3, v1
    v_lshl_add_u32 v12, v13, 4, v12
    s_mul_i32 s25, s97, 655360
    s_add_u32 s25, s25, s30
    s_lshl_b32 s34, s97, 14
    v_lshrrev_b32 v10, 2, v3
    v_lshl_add_u32 v10, v2, 2, v10
    v_lshlrev_b32 v10, 6, v10
    v_and_b32 v13, 3, v3
    v_lshl_add_u32 v10, v13, 4, v10
    v_add_u32 v10, s34, v10
    s_waitcnt lgkmcnt(0)
    s_mov_b32 s12, s6
    s_and_b32 s13, s7, 0xffff
    s_mov_b32 s14, 5242880
    s_mov_b32 s15, 0x00020000
    s_mov_b32 s16, s32
    s_and_b32 s17, s33, 0xffff
    s_mov_b32 s18, 2621440
    s_mov_b32 s19, 0x00020000
    s_add_u32 m0, s34, 0
    s_add_u32 s26, s25, 0
    buffer_load_dwordx4 v12, s[12:15], s26 offen lds
    s_add_u32 m0, s34, 1024
    s_add_u32 s26, s25, 20480
    buffer_load_dwordx4 v12, s[12:15], s26 offen lds
    s_add_u32 m0, s34, 2048
    s_add_u32 s26, s25, 40960
    buffer_load_dwordx4 v12, s[12:15], s26 offen lds
    s_add_u32 m0, s34, 3072
    s_add_u32 s26, s25, 61440
    buffer_load_dwordx4 v12, s[12:15], s26 offen lds
    s_add_u32 m0, s34, 4096
    s_add_u32 s26, s25, 81920
    buffer_load_dwordx4 v12, s[12:15], s26 offen lds
    s_add_u32 m0, s34, 5120
    s_add_u32 s26, s25, 102400
    buffer_load_dwordx4 v12, s[12:15], s26 offen lds
    s_add_u32 m0, s34, 6144
    s_add_u32 s26, s25, 122880
    buffer_load_dwordx4 v12, s[12:15], s26 offen lds
    s_add_u32 m0, s34, 7168
    s_add_u32 s26, s25, 143360
    buffer_load_dwordx4 v12, s[12:15], s26 offen lds
    s_add_u32 m0, s34, 8192
    s_add_u32 s26, s25, 163840
    buffer_load_dwordx4 v12, s[12:15], s26 offen lds
    s_add_u32 m0, s34, 9216
    s_add_u32 s26, s25, 184320
    buffer_load_dwordx4 v12, s[12:15], s26 offen lds
    s_add_u32 m0, s34, 10240
    s_add_u32 s26, s25, 204800
    buffer_load_dwordx4 v12, s[12:15], s26 offen lds
    s_add_u32 m0, s34, 11264
    s_add_u32 s26, s25, 225280
    buffer_load_dwordx4 v12, s[12:15], s26 offen lds
    s_add_u32 m0, s34, 12288
    s_add_u32 s26, s25, 245760
    buffer_load_dwordx4 v12, s[12:15], s26 offen lds
    s_add_u32 m0, s34, 13312
    s_add_u32 s26, s25, 266240
    buffer_load_dwordx4 v12, s[12:15], s26 offen lds
    s_add_u32 m0, s34, 14336
    s_add_u32 s26, s25, 286720
    buffer_load_dwordx4 v12, s[12:15], s26 offen lds
    s_add_u32 m0, s34, 15360
    s_add_u32 s26, s25, 307200
    buffer_load_dwordx4 v12, s[12:15], s26 offen lds
    s_waitcnt vmcnt(0)
    ds_read_b64_tr_b16 v[120:121], v10 offset:0
    ds_read_b64_tr_b16 v[122:123], v10 offset:1024
    ds_read_b64_tr_b16 v[124:125], v10 offset:8
    ds_read_b64_tr_b16 v[126:127], v10 offset:1032
    ds_read_b64_tr_b16 v[128:129], v10 offset:2048
    ds_read_b64_tr_b16 v[130:131], v10 offset:3072
    ds_read_b64_tr_b16 v[132:133], v10 offset:2056
    ds_read_b64_tr_b16 v[134:135], v10 offset:3080
    ds_read_b64_tr_b16 v[136:137], v10 offset:4096
    ds_read_b64_tr_b16 v[138:139], v10 offset:5120
    ds_read_b64_tr_b16 v[140:141], v10 offset:4104
    ds_read_b64_tr_b16 v[142:143], v10 offset:5128
    ds_read_b64_tr_b16 v[144:145], v10 offset:6144
    ds_read_b64_tr_b16 v[146:147], v10 offset:7168
    ds_read_b64_tr_b16 v[148:149], v10 offset:6152
    ds_read_b64_tr_b16 v[150:151], v10 offset:7176
    ds_read_b64_tr_b16 v[152:153], v10 offset:8192
    ds_read_b64_tr_b16 v[154:155], v10 offset:9216
    ds_read_b64_tr_b16 v[156:157], v10 offset:8200
    ds_read_b64_tr_b16 v[158:159], v10 offset:9224
    ds_read_b64_tr_b16 v[160:161], v10 offset:10240
    ds_read_b64_tr_b16 v[162:163], v10 offset:11264
    ds_read_b64_tr_b16 v[164:165], v10 offset:10248
    ds_read_b64_tr_b16 v[166:167], v10 offset:11272
    ds_read_b64_tr_b16 v[168:169], v10 offset:12288
    ds_read_b64_tr_b16 v[170:171], v10 offset:13312
    ds_read_b64_tr_b16 v[172:173], v10 offset:12296
    ds_read_b64_tr_b16 v[174:175], v10 offset:13320
    ds_read_b64_tr_b16 v[176:177], v10 offset:14336
    ds_read_b64_tr_b16 v[178:179], v10 offset:15360
    ds_read_b64_tr_b16 v[180:181], v10 offset:14344
    ds_read_b64_tr_b16 v[182:183], v10 offset:15368
    s_waitcnt lgkmcnt(0)
    s_add_u32 m0, s34, 0
    s_add_u32 s26, s25, 327680
    buffer_load_dwordx4 v12, s[12:15], s26 offen lds
    s_add_u32 m0, s34, 1024
    s_add_u32 s26, s25, 348160
    buffer_load_dwordx4 v12, s[12:15], s26 offen lds
    s_add_u32 m0, s34, 2048
    s_add_u32 s26, s25, 368640
    buffer_load_dwordx4 v12, s[12:15], s26 offen lds
    s_add_u32 m0, s34, 3072
    s_add_u32 s26, s25, 389120
    buffer_load_dwordx4 v12, s[12:15], s26 offen lds
    s_add_u32 m0, s34, 4096
    s_add_u32 s26, s25, 409600
    buffer_load_dwordx4 v12, s[12:15], s26 offen lds
    s_add_u32 m0, s34, 5120
    s_add_u32 s26, s25, 430080
    buffer_load_dwordx4 v12, s[12:15], s26 offen lds
    s_add_u32 m0, s34, 6144
    s_add_u32 s26, s25, 450560
    buffer_load_dwordx4 v12, s[12:15], s26 offen lds
    s_add_u32 m0, s34, 7168
    s_add_u32 s26, s25, 471040
    buffer_load_dwordx4 v12, s[12:15], s26 offen lds
    s_add_u32 m0, s34, 8192
    s_add_u32 s26, s25, 491520
    buffer_load_dwordx4 v12, s[12:15], s26 offen lds
    s_add_u32 m0, s34, 9216
    s_add_u32 s26, s25, 512000
    buffer_load_dwordx4 v12, s[12:15], s26 offen lds
    s_add_u32 m0, s34, 10240
    s_add_u32 s26, s25, 532480
    buffer_load_dwordx4 v12, s[12:15], s26 offen lds
    s_add_u32 m0, s34, 11264
    s_add_u32 s26, s25, 552960
    buffer_load_dwordx4 v12, s[12:15], s26 offen lds
    s_add_u32 m0, s34, 12288
    s_add_u32 s26, s25, 573440
    buffer_load_dwordx4 v12, s[12:15], s26 offen lds
    s_add_u32 m0, s34, 13312
    s_add_u32 s26, s25, 593920
    buffer_load_dwordx4 v12, s[12:15], s26 offen lds
    s_add_u32 m0, s34, 14336
    s_add_u32 s26, s25, 614400
    buffer_load_dwordx4 v12, s[12:15], s26 offen lds
    s_add_u32 m0, s34, 15360
    s_add_u32 s26, s25, 634880
    buffer_load_dwordx4 v12, s[12:15], s26 offen lds
    s_waitcnt vmcnt(0)
    ds_read_b64_tr_b16 v[184:185], v10 offset:0
    ds_read_b64_tr_b16 v[186:187], v10 offset:1024
    ds_read_b64_tr_b16 v[188:189], v10 offset:8
    ds_read_b64_tr_b16 v[190:191], v10 offset:1032
    ds_read_b64_tr_b16 v[192:193], v10 offset:2048
    ds_read_b64_tr_b16 v[194:195], v10 offset:3072
    ds_read_b64_tr_b16 v[196:197], v10 offset:2056
    ds_read_b64_tr_b16 v[198:199], v10 offset:3080
    ds_read_b64_tr_b16 v[200:201], v10 offset:4096
    ds_read_b64_tr_b16 v[202:203], v10 offset:5120
    ds_read_b64_tr_b16 v[204:205], v10 offset:4104
    ds_read_b64_tr_b16 v[206:207], v10 offset:5128
    ds_read_b64_tr_b16 v[208:209], v10 offset:6144
    ds_read_b64_tr_b16 v[210:211], v10 offset:7168
    ds_read_b64_tr_b16 v[212:213], v10 offset:6152
    ds_read_b64_tr_b16 v[214:215], v10 offset:7176
    ds_read_b64_tr_b16 v[216:217], v10 offset:8192
    ds_read_b64_tr_b16 v[218:219], v10 offset:9216
    ds_read_b64_tr_b16 v[220:221], v10 offset:8200
    ds_read_b64_tr_b16 v[222:223], v10 offset:9224
    ds_read_b64_tr_b16 v[224:225], v10 offset:10240
    ds_read_b64_tr_b16 v[226:227], v10 offset:11264
    ds_read_b64_tr_b16 v[228:229], v10 offset:10248
    ds_read_b64_tr_b16 v[230:231], v10 offset:11272
    ds_read_b64_tr_b16 v[232:233], v10 offset:12288
    ds_read_b64_tr_b16 v[234:235], v10 offset:13312
    ds_read_b64_tr_b16 v[236:237], v10 offset:12296
    ds_read_b64_tr_b16 v[238:239], v10 offset:13320
    ds_read_b64_tr_b16 v[240:241], v10 offset:14336
    ds_read_b64_tr_b16 v[242:243], v10 offset:15360
    ds_read_b64_tr_b16 v[244:245], v10 offset:14344
    ds_read_b64_tr_b16 v[246:247], v10 offset:15368
    s_waitcnt lgkmcnt(0)
    s_lshl_b32 s25, s97, 11
    v_add_u32 v5, s25, v4
    s_lshl_b32 s25, s96, 7
    s_add_u32 s25, s25, 125830144
    s_cmp_lg_u32 s97, 0
    s_cbranch_scc1 Lwg_134
    v_mov_b32 v251, 0
    s_mov_b32 s92, 0
    s_mov_b64 exec, 1
Lwf_135:
    buffer_load_dword v250, v251, s[8:11], s25 offen sc1
    s_waitcnt vmcnt(0)
    v_readfirstlane_b32 s93, v250
    s_add_u32 s92, s92, 1
    s_cmp_ge_u32 s93, 40
    s_cbranch_scc1 Lwfd_136
    s_sleep 32
    s_cmp_lt_u32 s92, 200000
    s_cbranch_scc1 Lwf_135
Lwfd_136:
    s_mov_b64 exec, -1
Lwg_134:
    s_barrier
Lb_opjl:
    s_lshr_b32 s25, s24, 1
    s_lshl_b32 s29, s25, 3
    s_lshl_b32 s25, s25, 7
    s_add_u32 s25, s25, 125831168
    s_lshl_b32 s26, s24, 4
    v_add_u32 v14, s26, v3
    v_lshlrev_b32 v15, 3, v14
    s_mov_b32 s26, 88080384
    buffer_load_dwordx2 v[32:33], v15, s[8:11], s26 offen
    v_mul_u32_u24 v14, 1280, v14
    v_add_u32 v14, s30, v14
    v_lshl_add_u32 v14, v2, 4, v14
    v_lshl_add_u32 v15, v2, 15, v15
    s_lshl_b32 s26, s30, 11
    s_add_u32 s26, s26, 83886080
    buffer_load_dwordx2 v[36:37], v15, s[8:11], s26 offen sc1
    s_add_u32 s26, s26, 16384
    buffer_load_dwordx2 v[38:39], v15, s[8:11], s26 offen sc1
    s_cmp_lg_u32 s97, 0
    s_cbranch_scc1 Lw4_137
    v_lshlrev_b32 v251, 2, v0
    s_mov_b32 s92, 0
    s_mov_b64 exec, 15
Lw4p_138:
    buffer_load_dword v250, v251, s[8:11], s25 offen sc1
    s_waitcnt vmcnt(0)
    v_cmp_eq_u32 vcc, 0, v250
    s_add_u32 s92, s92, 1
    s_cbranch_vccz Lw4d_139
    s_sleep 5
    s_cmp_lt_u32 s92, 200000
    s_cbranch_scc1 Lw4p_138
Lw4d_139:
    s_mov_b64 exec, -1
Lw4_137:
    s_barrier
    s_add_u32 s29, s29, s97
    s_lshl_b32 s29, s29, 15
    s_and_b32 s26, s24, 1
    s_lshl_b32 s26, s26, 12
    s_add_u32 s29, s29, s26
    s_add_u32 s29, s29, 100663296
    s_add_u32 s34, s29, 0
    buffer_load_dwordx4 v[40:43], v4, s[8:11], s34 offen offset:0
    buffer_load_dwordx4 v[44:47], v4, s[8:11], s34 offen offset:1024
    buffer_load_dwordx4 v[48:51], v4, s[8:11], s34 offen offset:2048
    buffer_load_dwordx4 v[52:55], v4, s[8:11], s34 offen offset:3072
    s_add_u32 s34, s29, 8192
    buffer_load_dwordx4 v[56:59], v4, s[8:11], s34 offen offset:0
    buffer_load_dwordx4 v[60:63], v4, s[8:11], s34 offen offset:1024
    buffer_load_dwordx4 v[64:67], v4, s[8:11], s34 offen offset:2048
    buffer_load_dwordx4 v[68:71], v4, s[8:11], s34 offen offset:3072
    s_add_u32 s34, s29, 16384
    buffer_load_dwordx4 v[72:75], v4, s[8:11], s34 offen offset:0
    buffer_load_dwordx4 v[76:79], v4, s[8:11], s34 offen offset:1024
    buffer_load_dwordx4 v[80:83], v4, s[8:11], s34 offen offset:2048
    buffer_load_dwordx4 v[84:87], v4, s[8:11], s34 offen offset:3072
    s_add_u32 s34, s29, 24576
    buffer_load_dwordx4 v[88:91], v4, s[8:11], s34 offen offset:0
    buffer_load_dwordx4 v[92:95], v4, s[8:11], s34 offen offset:1024
    buffer_load_dwordx4 v[96:99], v4, s[8:11], s34 offen offset:2048
    buffer_load_dwordx4 v[100:103], v4, s[8:11], s34 offen offset:3072
    s_waitcnt vmcnt(12)
    v_mfma_f32_16x16x32_bf16 v[16:19], v[120:123], v[40:43], 0
    v_mfma_f32_16x16x32_bf16 v[20:23], v[124:127], v[40:43], 0
    v_mfma_f32_16x16x32_bf16 v[16:19], v[128:131], v[44:47], v[16:19]
    v_mfma_f32_16x16x32_bf16 v[20:23], v[132:135], v[44:47], v[20:23]
    v_mfma_f32_16x16x32_bf16 v[16:19], v[136:139], v[48:51], v[16:19]
    v_mfma_f32_16x16x32_bf16 v[20:23], v[140:143], v[48:51], v[20:23]
    v_mfma_f32_16x16x32_bf16 v[16:19], v[144:147], v[52:55], v[16:19]
    v_mfma_f32_16x16x32_bf16 v[20:23], v[148:151], v[52:55], v[20:23]
    s_waitcnt vmcnt(8)
    v_mfma_f32_16x16x32_bf16 v[16:19], v[152:155], v[56:59], v[16:19]
    v_mfma_f32_16x16x32_bf16 v[20:23], v[156:159], v[56:59], v[20:23]
    v_mfma_f32_16x16x32_bf16 v[16:19], v[160:163], v[60:63], v[16:19]
    v_mfma_f32_16x16x32_bf16 v[20:23], v[164:167], v[60:63], v[20:23]
    v_mfma_f32_16x16x32_bf16 v[16:19], v[168:171], v[64:67], v[16:19]
    v_mfma_f32_16x16x32_bf16 v[20:23], v[172:175], v[64:67], v[20:23]
    v_mfma_f32_16x16x32_bf16 v[16:19], v[176:179], v[68:71], v[16:19]
    v_mfma_f32_16x16x32_bf16 v[20:23], v[180:183], v[68:71], v[20:23]
    s_waitcnt vmcnt(4)
    v_mfma_f32_16x16x32_bf16 v[16:19], v[184:187], v[72:75], v[16:19]
    v_mfma_f32_16x16x32_bf16 v[20:23], v[188:191], v[72:75], v[20:23]
    v_mfma_f32_16x16x32_bf16 v[16:19], v[192:195], v[76:79], v[16:19]
    v_mfma_f32_16x16x32_bf16 v[20:23], v[196:199], v[76:79], v[20:23]
    v_mfma_f32_16x16x32_bf16 v[16:19], v[200:203], v[80:83], v[16:19]
    v_mfma_f32_16x16x32_bf16 v[20:23], v[204:207], v[80:83], v[20:23]
    v_mfma_f32_16x16x32_bf16 v[16:19], v[208:211], v[84:87], v[16:19]
    v_mfma_f32_16x16x32_bf16 v[20:23], v[212:215], v[84:87], v[20:23]
    s_waitcnt vmcnt(0)
    v_mfma_f32_16x16x32_bf16 v[16:19], v[216:219], v[88:91], v[16:19]
    v_mfma_f32_16x16x32_bf16 v[20:23], v[220:223], v[88:91], v[20:23]
    v_mfma_f32_16x16x32_bf16 v[16:19], v[224:227], v[92:95], v[16:19]
    v_mfma_f32_16x16x32_bf16 v[20:23], v[228:231], v[92:95], v[20:23]
    v_mfma_f32_16x16x32_bf16 v[16:19], v[232:235], v[96:99], v[16:19]
    v_mfma_f32_16x16x32_bf16 v[20:23], v[236:239], v[96:99], v[20:23]
    v_mfma_f32_16x16x32_bf16 v[16:19], v[240:243], v[100:103], v[16:19]
    v_mfma_f32_16x16x32_bf16 v[20:23], v[244:247], v[100:103], v[20:23]
    s_nop 7
    ds_write_b128 v5, v[16:19] offset:0
    ds_write_b128 v5, v[20:23] offset:1024
    s_waitcnt lgkmcnt(0)
    s_barrier
    s_cmp_lg_u32 s97, 1
    s_cbranch_scc1 Lb_opjn
    ds_read_b128 v[40:43], v4 offset:0
    ds_read_b128 v[44:47], v4 offset:1024
    ds_read_b128 v[48:51], v4 offset:2048
    ds_read_b128 v[52:55], v4 offset:3072
    ds_read_b128 v[56:59], v4 offset:4096
    ds_read_b128 v[60:63], v4 offset:5120
    ds_read_b128 v[64:67], v4 offset:6144
    ds_read_b128 v[68:71], v4 offset:7168
    ds_read_b128 v[72:75], v4 offset:8192
    ds_read_b128 v[76:79], v4 offset:9216
    ds_read_b128 v[80:83], v4 offset:10240
    ds_read_b128 v[84:87], v4 offset:11264
    ds_read_b128 v[88:91], v4 offset:12288
    ds_read_b128 v[92:95], v4 offset:13312
    ds_read_b128 v[96:99], v4 offset:14336
    ds_read_b128 v[100:103], v4 offset:15360
    s_waitcnt lgkmcnt(0)
    v_add_f32 v40, v40, v72
    v_add_f32 v41, v41, v73
    v_add_f32 v42, v42, v74
    v_add_f32 v43, v43, v75
    v_add_f32 v44, v44, v76
    v_add_f32 v45, v45, v77
    v_add_f32 v46, v46, v78
    v_add_f32 v47, v47, v79
    v_add_f32 v48, v48, v80
    v_add_f32 v49, v49, v81
    v_add_f32 v50, v50, v82
    v_add_f32 v51, v51, v83
    v_add_f32 v52, v52, v84
    v_add_f32 v53, v53, v85
    v_add_f32 v54, v54, v86
    v_add_f32 v55, v55, v87
    v_add_f32 v56, v56, v88
    v_add_f32 v57, v57, v89
    v_add_f32 v58, v58, v90
    v_add_f32 v59, v59, v91
    v_add_f32 v60, v60, v92
    v_add_f32 v61, v61, v93
    v_add_f32 v62, v62, v94
    v_add_f32 v63, v63, v95
    v_add_f32 v64, v64, v96
    v_add_f32 v65, v65, v97
    v_add_f32 v66, v66, v98
    v_add_f32 v67, v67, v99
    v_add_f32 v68, v68, v100
    v_add_f32 v69, v69, v101
    v_add_f32 v70, v70, v102
    v_add_f32 v71, v71, v103
    v_add_f32 v40, v40, v56
    v_add_f32 v41, v41, v57
    v_add_f32 v42, v42, v58
    v_add_f32 v43, v43, v59
    v_add_f32 v44, v44, v60
    v_add_f32 v45, v45, v61
    v_add_f32 v46, v46, v62
    v_add_f32 v47, v47, v63
    v_add_f32 v48, v48, v64
    v_add_f32 v49, v49, v65
    v_add_f32 v50, v50, v66
    v_add_f32 v51, v51, v67
    v_add_f32 v52, v52, v68
    v_add_f32 v53, v53, v69
    v_add_f32 v54, v54, v70
    v_add_f32 v55, v55, v71
    v_add_f32 v40, v40, v48
    v_add_f32 v41, v41, v49
    v_add_f32 v42, v42, v50
    v_add_f32 v43, v43, v51
    v_add_f32 v44, v44, v52
    v_add_f32 v45, v45, v53
    v_add_f32 v46, v46, v54
    v_add_f32 v47, v47, v55
    v_cvt_pk_bf16_f32 v110, v40, v41
    v_lshlrev_b32 v111, 16, v110
    v_and_b32 v112, 0xffff0000, v110
    v_mul_f32 v111, v32, v111
    v_mul_f32 v112, v32, v112
    v_cvt_pk_bf16_f32 v110, v111, v112
    v_lshlrev_b32 v113, 16, v36
    v_and_b32 v114, 0xffff0000, v36
    v_mul_f32 v113, v33, v113
    v_mul_f32 v114, v33, v114
    v_cvt_pk_bf16_f32 v113, v113, v114
    v_lshlrev_b32 v111, 16, v110
    v_and_b32 v112, 0xffff0000, v110
    v_and_b32 v114, 0xffff0000, v113
    v_lshlrev_b32 v113, 16, v113
    v_add_f32 v111, v111, v113
    v_add_f32 v112, v112, v114
    v_cvt_pk_bf16_f32 v116, v111, v112
    v_cvt_pk_bf16_f32 v110, v42, v43
    v_lshlrev_b32 v111, 16, v110
    v_and_b32 v112, 0xffff0000, v110
    v_mul_f32 v111, v32, v111
    v_mul_f32 v112, v32, v112
    v_cvt_pk_bf16_f32 v110, v111, v112
    v_lshlrev_b32 v113, 16, v37
    v_and_b32 v114, 0xffff0000, v37
    v_mul_f32 v113, v33, v113
    v_mul_f32 v114, v33, v114
    v_cvt_pk_bf16_f32 v113, v113, v114
    v_lshlrev_b32 v111, 16, v110
    v_and_b32 v112, 0xffff0000, v110
    v_and_b32 v114, 0xffff0000, v113
    v_lshlrev_b32 v113, 16, v113
    v_add_f32 v111, v111, v113
    v_add_f32 v112, v112, v114
    v_cvt_pk_bf16_f32 v117, v111, v112
    v_cvt_pk_bf16_f32 v110, v44, v45
    v_lshlrev_b32 v111, 16, v110
    v_and_b32 v112, 0xffff0000, v110
    v_mul_f32 v111, v32, v111
    v_mul_f32 v112, v32, v112
    v_cvt_pk_bf16_f32 v110, v111, v112
    v_lshlrev_b32 v113, 16, v38
    v_and_b32 v114, 0xffff0000, v38
    v_mul_f32 v113, v33, v113
    v_mul_f32 v114, v33, v114
    v_cvt_pk_bf16_f32 v113, v113, v114
    v_lshlrev_b32 v111, 16, v110
    v_and_b32 v112, 0xffff0000, v110
    v_and_b32 v114, 0xffff0000, v113
    v_lshlrev_b32 v113, 16, v113
    v_add_f32 v111, v111, v113
    v_add_f32 v112, v112, v114
    v_cvt_pk_bf16_f32 v118, v111, v112
    v_cvt_pk_bf16_f32 v110, v46, v47
    v_lshlrev_b32 v111, 16, v110
    v_and_b32 v112, 0xffff0000, v110
    v_mul_f32 v111, v32, v111
    v_mul_f32 v112, v32, v112
    v_cvt_pk_bf16_f32 v110, v111, v112
    v_lshlrev_b32 v113, 16, v39
    v_and_b32 v114, 0xffff0000, v39
    v_mul_f32 v113, v33, v113
    v_mul_f32 v114, v33, v114
    v_cvt_pk_bf16_f32 v113, v113, v114
    v_lshlrev_b32 v111, 16, v110
    v_and_b32 v112, 0xffff0000, v110
    v_and_b32 v114, 0xffff0000, v113
    v_lshlrev_b32 v113, 16, v113
    v_add_f32 v111, v111, v113
    v_add_f32 v112, v112, v114
    v_cvt_pk_bf16_f32 v119, v111, v112
    v_mov_b32 v115, v14
    buffer_store_dwordx4 v[116:119], v115, s[16:19], 0 offen
Lb_opjn:
    s_add_u32 s24, s24, 5
    s_cmp_lt_u32 s24, 128
    s_cbranch_scc1 Lb_opjl
    s_branch Lmain_end
Lb_att:
    s_sub_u32 s99, s98, 25
    v_and_b32 v1, 63, v0
    v_lshlrev_b32 v2, 3, v1
    v_lshrrev_b32 v3, 4, v1
    v_and_b32 v4, 15, v1
    v_cmp_le_u32 s[28:29], 32, v1
    v_lshlrev_b32 v3, 2, v3
    v_add_u32 v5, 0, v3
    v_cmp_le_u32 s[20:21], v5, v4
    v_add_u32 v5, 1, v3
    v_cmp_le_u32 s[22:23], v5, v4
    v_add_u32 v5, 2, v3
    v_cmp_le_u32 s[24:25], v5, v4
    v_add_u32 v5, 3, v3
    v_cmp_le_u32 s[26:27], v5, v4
    v_lshlrev_b32 v1, 4, v1
    v_mov_b32 v7, 0xf149f2ca
    s_mov_b32 s14, 0x3db504f3
    s_mov_b32 s15, 0x3fb8aa3b
Lb_attl:
    s_lshl_b32 s6, s96, 3
    s_add_u32 s6, s6, s97
    s_lshl_b32 s7, s99, 5
    s_add_u32 s6, s6, s7
    s_lshl_b32 s30, s6, 6
    s_add_u32 s30, s30, 125839360
    v_and_b32 v251, 63, v0
    v_lshlrev_b32 v251, 2, v251
    s_mov_b32 s92, 0
    s_mov_b64 exec, 0x3f
Lb_attw1:
    buffer_load_dword v250, v251, s[8:11], s30 offen sc1
    s_waitcnt vmcnt(0)
    v_cmp_eq_u32 vcc, 0, v250
    s_add_u32 s92, s92, 1
    s_cbranch_vccz Lb_attw1d
    s_sleep 16
    s_cmp_lt_u32 s92, 200000
    s_cbranch_scc1 Lb_attw1
Lb_attw1d:
    s_mov_b64 exec, -1
    s_lshl_b32 s16, s6, 13
    s_add_u32 s12, s16, 0
    s_add_u32 s13, s12, 4096
    buffer_load_dwordx4 v[44:47], v1, s[8:11], s12 offen offset:0
    buffer_load_dwordx4 v[48:51], v1, s[8:11], s12 offen offset:1024
    buffer_load_dwordx4 v[52:55], v1, s[8:11], s12 offen offset:2048
    buffer_load_dwordx4 v[56:59], v1, s[8:11], s12 offen offset:3072
    buffer_load_dwordx4 v[60:63], v1, s[8:11], s13 offen offset:0
    buffer_load_dwordx4 v[64:67], v1, s[8:11], s13 offen offset:1024
    buffer_load_dwordx4 v[68:71], v1, s[8:11], s13 offen offset:2048
    buffer_load_dwordx4 v[72:75], v1, s[8:11], s13 offen offset:3072
    s_add_u32 s12, s16, 16777216
    s_add_u32 s13, s12, 4096
    buffer_load_dwordx4 v[76:79], v1, s[8:11], s12 offen offset:0
    buffer_load_dwordx4 v[80:83], v1, s[8:11], s12 offen offset:1024
    buffer_load_dwordx4 v[84:87], v1, s[8:11], s12 offen offset:2048
    buffer_load_dwordx4 v[88:91], v1, s[8:11], s12 offen offset:3072
    buffer_load_dwordx4 v[92:95], v1, s[8:11], s13 offen offset:0
    buffer_load_dwordx4 v[96:99], v1, s[8:11], s13 offen offset:1024
    buffer_load_dwordx4 v[100:103], v1, s[8:11], s13 offen offset:2048
    buffer_load_dwordx4 v[104:107], v1, s[8:11], s13 offen offset:3072
    s_add_u32 s12, s16, 33554432
    s_add_u32 s13, s12, 4096
    buffer_load_dwordx4 v[124:127], v1, s[8:11], s12 offen offset:0
    buffer_load_dwordx4 v[128:131], v1, s[8:11], s12 offen offset:1024
    buffer_load_dwordx4 v[132:135], v1, s[8:11], s12 offen offset:2048
    buffer_load_dwordx4 v[136:139], v1, s[8:11], s12 offen offset:3072
    buffer_load_dwordx4 v[140:143], v1, s[8:11], s13 offen offset:0
    buffer_load_dwordx4 v[144:147], v1, s[8:11], s13 offen offset:1024
    buffer_load_dwordx4 v[148:151], v1, s[8:11], s13 offen offset:2048
    buffer_load_dwordx4 v[152:155], v1, s[8:11], s13 offen offset:3072
    s_mov_b32 s92, 0
    s_mov_b64 exec, 0xf00
Lb_attw2:
    buffer_load_dword v250, v251, s[8:11], s30 offen sc1
    s_waitcnt vmcnt(0)
    v_cmp_eq_u32 vcc, 0, v250
    s_add_u32 s92, s92, 1
    s_cbranch_vccz Lb_attw2d
    s_sleep 5
    s_cmp_lt_u32 s92, 200000
    s_cbranch_scc1 Lb_attw2
Lb_attw2d:
    s_mov_b64 exec, -1
    s_lshl_b32 s12, s6, 12
    s_add_u32 s13, s12, 58720256
    s_add_u32 s12, s12, 50331648
    buffer_load_dwordx4 v[108:111], v1, s[8:11], s12 offen offset:0
    buffer_load_dwordx4 v[112:115], v1, s[8:11], s12 offen offset:1024
    buffer_load_dwordx4 v[116:119], v1, s[8:11], s12 offen offset:2048
    buffer_load_dwordx4 v[120:123], v1, s[8:11], s12 offen offset:3072
    buffer_load_dwordx2 v[156:157], v2, s[8:11], s13 offen offset:0
    buffer_load_dwordx2 v[158:159], v2, s[8:11], s13 offen offset:512
    buffer_load_dwordx2 v[160:161], v2, s[8:11], s13 offen offset:1024
    buffer_load_dwordx2 v[162:163], v2, s[8:11], s13 offen offset:1536
    buffer_load_dwordx2 v[164:165], v2, s[8:11], s13 offen offset:2048
    buffer_load_dwordx2 v[166:167], v2, s[8:11], s13 offen offset:2560
    buffer_load_dwordx2 v[168:169], v2, s[8:11], s13 offen offset:3072
    buffer_load_dwordx2 v[170:171], v2, s[8:11], s13 offen offset:3584
    s_waitcnt vmcnt(8)
    v_mfma_f32_16x16x32_bf16 v[8:11], v[108:111], v[44:47], 0
    v_mfma_f32_16x16x32_bf16 v[12:15], v[76:79], v[44:47], 0
    v_mfma_f32_16x16x32_bf16 v[16:19], v[108:111], v[60:63], 0
    v_mfma_f32_16x16x32_bf16 v[20:23], v[76:79], v[60:63], 0
    v_mfma_f32_16x16x32_bf16 v[24:27], v[92:95], v[60:63], 0
    v_mfma_f32_16x16x32_bf16 v[8:11], v[112:115], v[48:51], v[8:11]
    v_mfma_f32_16x16x32_bf16 v[12:15], v[80:83], v[48:51], v[12:15]
    v_mfma_f32_16x16x32_bf16 v[16:19], v[112:115], v[64:67], v[16:19]
    v_mfma_f32_16x16x32_bf16 v[20:23], v[80:83], v[64:67], v[20:23]
    v_mfma_f32_16x16x32_bf16 v[24:27], v[96:99], v[64:67], v[24:27]
    v_mfma_f32_16x16x32_bf16 v[8:11], v[116:119], v[52:55], v[8:11]
    v_mfma_f32_16x16x32_bf16 v[12:15], v[84:87], v[52:55], v[12:15]
    v_mfma_f32_16x16x32_bf16 v[16:19], v[116:119], v[68:71], v[16:19]
    v_mfma_f32_16x16x32_bf16 v[20:23], v[84:87], v[68:71], v[20:23]
    v_mfma_f32_16x16x32_bf16 v[24:27], v[100:103], v[68:71], v[24:27]
    v_mfma_f32_16x16x32_bf16 v[8:11], v[120:123], v[56:59], v[8:11]
    v_mfma_f32_16x16x32_bf16 v[12:15], v[88:91], v[56:59], v[12:15]
    v_mfma_f32_16x16x32_bf16 v[16:19], v[120:123], v[72:75], v[16:19]
    v_mfma_f32_16x16x32_bf16 v[20:23], v[88:91], v[72:75], v[20:23]
    v_mfma_f32_16x16x32_bf16 v[24:27], v[104:107], v[72:75], v[24:27]
    s_nop 7
    v_cvt_pk_bf16_f32 v3, v8, v9
    v_lshlrev_b32 v8, 16, v3
    v_and_b32 v9, 0xffff0000, v3
    v_mul_f32 v8, s14, v8
    v_mul_f32 v9, s14, v9
    v_cvt_pk_bf16_f32 v3, v8, v9
    v_lshlrev_b32 v8, 16, v3
    v_and_b32 v9, 0xffff0000, v3
    v_cvt_pk_bf16_f32 v3, v10, v11
    v_lshlrev_b32 v10, 16, v3
    v_and_b32 v11, 0xffff0000, v3
    v_mul_f32 v10, s14, v10
    v_mul_f32 v11, s14, v11
    v_cvt_pk_bf16_f32 v3, v10, v11
    v_lshlrev_b32 v10, 16, v3
    v_and_b32 v11, 0xffff0000, v3
    v_cvt_pk_bf16_f32 v3, v12, v13
    v_lshlrev_b32 v12, 16, v3
    v_and_b32 v13, 0xffff0000, v3
    v_mul_f32 v12, s14, v12
    v_mul_f32 v13, s14, v13
    v_cvt_pk_bf16_f32 v3, v12, v13
    v_lshlrev_b32 v12, 16, v3
    v_and_b32 v13, 0xffff0000, v3
    v_cvt_pk_bf16_f32 v3, v14, v15
    v_lshlrev_b32 v14, 16, v3
    v_and_b32 v15, 0xffff0000, v3
    v_mul_f32 v14, s14, v14
    v_mul_f32 v15, s14, v15
    v_cvt_pk_bf16_f32 v3, v14, v15
    v_lshlrev_b32 v14, 16, v3
    v_and_b32 v15, 0xffff0000, v3
    v_cvt_pk_bf16_f32 v3, v16, v17
    v_lshlrev_b32 v16, 16, v3
    v_and_b32 v17, 0xffff0000, v3
    v_mul_f32 v16, s14, v16
    v_mul_f32 v17, s14, v17
    v_cvt_pk_bf16_f32 v3, v16, v17
    v_lshlrev_b32 v16, 16, v3
    v_and_b32 v17, 0xffff0000, v3
    v_cvt_pk_bf16_f32 v3, v18, v19
    v_lshlrev_b32 v18, 16, v3
    v_and_b32 v19, 0xffff0000, v3
    v_mul_f32 v18, s14, v18
    v_mul_f32 v19, s14, v19
    v_cvt_pk_bf16_f32 v3, v18, v19
    v_lshlrev_b32 v18, 16, v3
    v_and_b32 v19, 0xffff0000, v3
    v_cvt_pk_bf16_f32 v3, v20, v21
    v_lshlrev_b32 v20, 16, v3
    v_and_b32 v21, 0xffff0000, v3
    v_mul_f32 v20, s14, v20
    v_mul_f32 v21, s14, v21
    v_cvt_pk_bf16_f32 v3, v20, v21
    v_lshlrev_b32 v20, 16, v3
    v_and_b32 v21, 0xffff0000, v3
    v_cvt_pk_bf16_f32 v3, v22, v23
    v_lshlrev_b32 v22, 16, v3
    v_and_b32 v23, 0xffff0000, v3
    v_mul_f32 v22, s14, v22
    v_mul_f32 v23, s14, v23
    v_cvt_pk_bf16_f32 v3, v22, v23
    v_lshlrev_b32 v22, 16, v3
    v_and_b32 v23, 0xffff0000, v3
    v_cvt_pk_bf16_f32 v3, v24, v25
    v_lshlrev_b32 v24, 16, v3
    v_and_b32 v25, 0xffff0000, v3
    v_mul_f32 v24, s14, v24
    v_mul_f32 v25, s14, v25
    v_cvt_pk_bf16_f32 v3, v24, v25
    v_lshlrev_b32 v24, 16, v3
    v_and_b32 v25, 0xffff0000, v3
    v_cvt_pk_bf16_f32 v3, v26, v27
    v_lshlrev_b32 v26, 16, v3
    v_and_b32 v27, 0xffff0000, v3
    v_mul_f32 v26, s14, v26
    v_mul_f32 v27, s14, v27
    v_cvt_pk_bf16_f32 v3, v26, v27
    v_lshlrev_b32 v26, 16, v3
    v_and_b32 v27, 0xffff0000, v3
    v_cndmask_b32 v8, v7, v8, s[28:29]
    v_cndmask_b32 v12, v7, v12, s[20:21]
    v_cndmask_b32 v9, v7, v9, s[28:29]
    v_cndmask_b32 v13, v7, v13, s[22:23]
    v_cndmask_b32 v10, v7, v10, s[28:29]
    v_cndmask_b32 v14, v7, v14, s[24:25]
    v_cndmask_b32 v11, v7, v11, s[28:29]
    v_cndmask_b32 v15, v7, v15, s[26:27]
    v_cndmask_b32 v16, v7, v16, s[28:29]
    v_cndmask_b32 v24, v7, v24, s[20:21]
    v_cndmask_b32 v17, v7, v17, s[28:29]
    v_cndmask_b32 v25, v7, v25, s[22:23]
    v_cndmask_b32 v18, v7, v18, s[28:29]
    v_cndmask_b32 v26, v7, v26, s[24:25]
    v_cndmask_b32 v19, v7, v19, s[28:29]
    v_cndmask_b32 v27, v7, v27, s[26:27]
    v_max3_f32 v5, v8, v9, v10
    v_max3_f32 v5, v5, v11, v12
    v_max3_f32 v5, v5, v13, v14
    v_max_f32 v5, v5, v15
    v_mov_b32 v3, v5
    s_nop 1
    v_permlane32_swap_b32 v5, v3
    v_max_f32 v5, v5, v3
    v_mov_b32 v3, v5
    s_nop 1
    v_permlane16_swap_b32 v5, v3
    v_max_f32 v5, v5, v3
    v_sub_f32 v8, v8, v5
    v_mul_f32 v8, s15, v8
    v_exp_f32 v8, v8
    v_sub_f32 v9, v9, v5
    v_mul_f32 v9, s15, v9
    v_exp_f32 v9, v9
    v_sub_f32 v10, v10, v5
    v_mul_f32 v10, s15, v10
    v_exp_f32 v10, v10
    v_sub_f32 v11, v11, v5
    v_mul_f32 v11, s15, v11
    v_exp_f32 v11, v11
    v_sub_f32 v12, v12, v5
    v_mul_f32 v12, s15, v12
    v_exp_f32 v12, v12
    v_sub_f32 v13, v13, v5
    v_mul_f32 v13, s15, v13
    v_exp_f32 v13, v13
    v_sub_f32 v14, v14, v5
    v_mul_f32 v14, s15, v14
    v_exp_f32 v14, v14
    v_sub_f32 v15, v15, v5
    v_mul_f32 v15, s15, v15
    v_exp_f32 v15, v15
    s_nop 0
    v_add_f32 v6, v8, v9
    v_add_f32 v6, v6, v10
    v_add_f32 v6, v6, v11
    v_add_f32 v6, v6, v12
    v_add_f32 v6, v6, v13
    v_add_f32 v6, v6, v14
    v_add_f32 v6, v6, v15
    v_mov_b32 v3, v6
    s_nop 1
    v_permlane32_swap_b32 v6, v3
    v_add_f32 v6, v6, v3
    v_mov_b32 v3, v6
    s_nop 1
    v_permlane16_swap_b32 v6, v3
    v_add_f32 v6, v6, v3
    v_rcp_f32 v6, v6
    s_nop 0
    v_mul_f32 v8, v8, v6
    v_mul_f32 v9, v9, v6
    v_mul_f32 v10, v10, v6
    v_mul_f32 v11, v11, v6
    v_mul_f32 v12, v12, v6
    v_mul_f32 v13, v13, v6
    v_mul_f32 v14, v14, v6
    v_mul_f32 v15, v15, v6
    v_cvt_pk_bf16_f32 v32, v8, v9
    v_cvt_pk_bf16_f32 v33, v10, v11
    v_cvt_pk_bf16_f32 v28, v12, v13
    v_cvt_pk_bf16_f32 v29, v14, v15
    v_mov_b32 v30, 0
    v_mov_b32 v31, 0
    v_max3_f32 v5, v16, v17, v18
    v_max3_f32 v5, v5, v19, v20
    v_max3_f32 v5, v5, v21, v22
    v_max3_f32 v5, v5, v23, v24
    v_max3_f32 v5, v5, v25, v26
    v_max_f32 v5, v5, v27
    v_mov_b32 v3, v5
    s_nop 1
    v_permlane32_swap_b32 v5, v3
    v_max_f32 v5, v5, v3
    v_mov_b32 v3, v5
    s_nop 1
    v_permlane16_swap_b32 v5, v3
    v_max_f32 v5, v5, v3
    v_sub_f32 v16, v16, v5
    v_mul_f32 v16, s15, v16
    v_exp_f32 v16, v16
    v_sub_f32 v17, v17, v5
    v_mul_f32 v17, s15, v17
    v_exp_f32 v17, v17
    v_sub_f32 v18, v18, v5
    v_mul_f32 v18, s15, v18
    v_exp_f32 v18, v18
    v_sub_f32 v19, v19, v5
    v_mul_f32 v19, s15, v19
    v_exp_f32 v19, v19
    v_sub_f32 v20, v20, v5
    v_mul_f32 v20, s15, v20
    v_exp_f32 v20, v20
    v_sub_f32 v21, v21, v5
    v_mul_f32 v21, s15, v21
    v_exp_f32 v21, v21
    v_sub_f32 v22, v22, v5
    v_mul_f32 v22, s15, v22
    v_exp_f32 v22, v22
    v_sub_f32 v23, v23, v5
    v_mul_f32 v23, s15, v23
    v_exp_f32 v23, v23
    v_sub_f32 v24, v24, v5
    v_mul_f32 v24, s15, v24
    v_exp_f32 v24, v24
    v_sub_f32 v25, v25, v5
    v_mul_f32 v25, s15, v25
    v_exp_f32 v25, v25
    v_sub_f32 v26, v26, v5
    v_mul_f32 v26, s15, v26
    v_exp_f32 v26, v26
    v_sub_f32 v27, v27, v5
    v_mul_f32 v27, s15, v27
    v_exp_f32 v27, v27
    s_nop 0
    v_add_f32 v6, v16, v17
    v_add_f32 v6, v6, v18
    v_add_f32 v6, v6, v19
    v_add_f32 v6, v6, v20
    v_add_f32 v6, v6, v21
    v_add_f32 v6, v6, v22
    v_add_f32 v6, v6, v23
    v_add_f32 v6, v6, v24
    v_add_f32 v6, v6, v25
    v_add_f32 v6, v6, v26
    v_add_f32 v6, v6, v27
    v_mov_b32 v3, v6
    s_nop 1
    v_permlane32_swap_b32 v6, v3
    v_add_f32 v6, v6, v3
    v_mov_b32 v3, v6
    s_nop 1
    v_permlane16_swap_b32 v6, v3
    v_add_f32 v6, v6, v3
    v_rcp_f32 v6, v6
    s_nop 0
    v_mul_f32 v16, v16, v6
    v_mul_f32 v17, v17, v6
    v_mul_f32 v18, v18, v6
    v_mul_f32 v19, v19, v6
    v_mul_f32 v20, v20, v6
    v_mul_f32 v21, v21, v6
    v_mul_f32 v22, v22, v6
    v_mul_f32 v23, v23, v6
    v_mul_f32 v24, v24, v6
    v_mul_f32 v25, v25, v6
    v_mul_f32 v26, v26, v6
    v_mul_f32 v27, v27, v6
    v_cvt_pk_bf16_f32 v40, v16, v17
    v_cvt_pk_bf16_f32 v41, v18, v19
    v_cvt_pk_bf16_f32 v36, v20, v21
    v_cvt_pk_bf16_f32 v37, v22, v23
    v_cvt_pk_bf16_f32 v38, v24, v25
    v_cvt_pk_bf16_f32 v39, v26, v27
    s_waitcnt vmcnt(0)
    v_mfma_f32_16x16x32_bf16 v[44:47], v[124:127], v[28:31], 0
    v_mfma_f32_16x16x32_bf16 v[48:51], v[124:127], v[36:39], 0
    v_mfma_f32_16x16x32_bf16 v[52:55], v[128:131], v[28:31], 0
    v_mfma_f32_16x16x32_bf16 v[56:59], v[128:131], v[36:39], 0
    v_mfma_f32_16x16x32_bf16 v[60:63], v[132:135], v[28:31], 0
    v_mfma_f32_16x16x32_bf16 v[64:67], v[132:135], v[36:39], 0
    v_mfma_f32_16x16x32_bf16 v[68:71], v[136:139], v[28:31], 0
    v_mfma_f32_16x16x32_bf16 v[72:75], v[136:139], v[36:39], 0
    v_mfma_f32_16x16x32_bf16 v[76:79], v[140:143], v[28:31], 0
    v_mfma_f32_16x16x32_bf16 v[80:83], v[140:143], v[36:39], 0
    v_mfma_f32_16x16x32_bf16 v[84:87], v[144:147], v[28:31], 0
    v_mfma_f32_16x16x32_bf16 v[88:91], v[144:147], v[36:39], 0
    v_mfma_f32_16x16x32_bf16 v[92:95], v[148:151], v[28:31], 0
    v_mfma_f32_16x16x32_bf16 v[96:99], v[148:151], v[36:39], 0
    v_mfma_f32_16x16x32_bf16 v[100:103], v[152:155], v[28:31], 0
    v_mfma_f32_16x16x32_bf16 v[104:107], v[152:155], v[36:39], 0
    v_mfma_f32_16x16x16_bf16 v[44:47], v[156:157], v[32:33], v[44:47]
    v_mfma_f32_16x16x16_bf16 v[48:51], v[156:157], v[40:41], v[48:51]
    v_mfma_f32_16x16x16_bf16 v[52:55], v[158:159], v[32:33], v[52:55]
    v_mfma_f32_16x16x16_bf16 v[56:59], v[158:159], v[40:41], v[56:59]
    v_mfma_f32_16x16x16_bf16 v[60:63], v[160:161], v[32:33], v[60:63]
    v_mfma_f32_16x16x16_bf16 v[64:67], v[160:161], v[40:41], v[64:67]
    v_mfma_f32_16x16x16_bf16 v[68:71], v[162:163], v[32:33], v[68:71]
    v_mfma_f32_16x16x16_bf16 v[72:75], v[162:163], v[40:41], v[72:75]
    v_mfma_f32_16x16x16_bf16 v[76:79], v[164:165], v[32:33], v[76:79]
    v_mfma_f32_16x16x16_bf16 v[80:83], v[164:165], v[40:41], v[80:83]
    v_mfma_f32_16x16x16_bf16 v[84:87], v[166:167], v[32:33], v[84:87]
    v_mfma_f32_16x16x16_bf16 v[88:91], v[166:167], v[40:41], v[88:91]
    v_mfma_f32_16x16x16_bf16 v[92:95], v[168:169], v[32:33], v[92:95]
    v_mfma_f32_16x16x16_bf16 v[96:99], v[168:169], v[40:41], v[96:99]
    v_mfma_f32_16x16x16_bf16 v[100:103], v[170:171], v[32:33], v[100:103]
    v_mfma_f32_16x16x16_bf16 v[104:107], v[170:171], v[40:41], v[104:107]
    s_add_u32 s12, s16, 100663296
    s_add_u32 s13, s12, 4096
    s_nop 7
    v_cvt_pk_bf16_f32 v124, v44, v45
    v_cvt_pk_bf16_f32 v125, v46, v47
    v_cvt_pk_bf16_f32 v126, v52, v53
    v_cvt_pk_bf16_f32 v127, v54, v55
    buffer_store_dwordx4 v[124:127], v1, s[8:11], s12 offen offset:0 sc1
    v_cvt_pk_bf16_f32 v128, v60, v61
    v_cvt_pk_bf16_f32 v129, v62, v63
    v_cvt_pk_bf16_f32 v130, v68, v69
    v_cvt_pk_bf16_f32 v131, v70, v71
    buffer_store_dwordx4 v[128:131], v1, s[8:11], s12 offen offset:1024 sc1
    v_cvt_pk_bf16_f32 v132, v76, v77
    v_cvt_pk_bf16_f32 v133, v78, v79
    v_cvt_pk_bf16_f32 v134, v84, v85
    v_cvt_pk_bf16_f32 v135, v86, v87
    buffer_store_dwordx4 v[132:135], v1, s[8:11], s12 offen offset:2048 sc1
    v_cvt_pk_bf16_f32 v136, v92, v93
    v_cvt_pk_bf16_f32 v137, v94, v95
    v_cvt_pk_bf16_f32 v138, v100, v101
    v_cvt_pk_bf16_f32 v139, v102, v103
    buffer_store_dwordx4 v[136:139], v1, s[8:11], s12 offen offset:3072 sc1
    v_cvt_pk_bf16_f32 v140, v48, v49
    v_cvt_pk_bf16_f32 v141, v50, v51
    v_cvt_pk_bf16_f32 v142, v56, v57
    v_cvt_pk_bf16_f32 v143, v58, v59
    buffer_store_dwordx4 v[140:143], v1, s[8:11], s13 offen offset:0 sc1
    v_cvt_pk_bf16_f32 v144, v64, v65
    v_cvt_pk_bf16_f32 v145, v66, v67
    v_cvt_pk_bf16_f32 v146, v72, v73
    v_cvt_pk_bf16_f32 v147, v74, v75
    buffer_store_dwordx4 v[144:147], v1, s[8:11], s13 offen offset:1024 sc1
    v_cvt_pk_bf16_f32 v148, v80, v81
    v_cvt_pk_bf16_f32 v149, v82, v83
    v_cvt_pk_bf16_f32 v150, v88, v89
    v_cvt_pk_bf16_f32 v151, v90, v91
    buffer_store_dwordx4 v[148:151], v1, s[8:11], s13 offen offset:2048 sc1
    v_cvt_pk_bf16_f32 v152, v96, v97
    v_cvt_pk_bf16_f32 v153, v98, v99
    v_cvt_pk_bf16_f32 v154, v104, v105
    v_cvt_pk_bf16_f32 v155, v106, v107
    buffer_store_dwordx4 v[152:155], v1, s[8:11], s13 offen offset:3072 sc1
    s_lshl_b32 s12, s99, 5
    s_add_u32 s12, s12, s96
    s_lshl_b32 s12, s12, 2
    s_add_u32 s12, s12, 125831168
    s_waitcnt vmcnt(0)
    s_barrier
    s_cmp_lg_u32 s97, 0
    s_cbranch_scc1 Lsig_140
    v_mov_b32 v250, 1
    v_mov_b32 v251, 0
    s_mov_b64 exec, 1
    buffer_store_dword v250, v251, s[8:11], s12 offen sc1
    s_mov_b64 exec, -1
Lsig_140:
    s_add_u32 s99, s99, 7
    s_cmp_lt_u32 s99, 64
    s_cbranch_scc1 Lb_attl
Lmain_end:
    s_endpgm
.set CODE_BYTES, Lmain_end-gated_mix__memory_aug_recurrent_mem_tr__ssm_conv_s4__prompt_kernel-64
.section .rodata,"a"
.p2align 6
.amdhsa_kernel gated_mix__memory_aug_recurrent_mem_tr__ssm_conv_s4__prompt_kernel
  .amdhsa_next_free_vgpr 256
  .amdhsa_next_free_sgpr 102
  .amdhsa_accum_offset 256
  .amdhsa_group_segment_fixed_size 0
  .amdhsa_kernarg_size 160
  .amdhsa_user_sgpr_count 2
  .amdhsa_user_sgpr_kernarg_segment_ptr 1
  .amdhsa_system_sgpr_workgroup_id_x 1
  .amdhsa_float_denorm_mode_32 3
.end_amdhsa_kernel
```
